```python
import torch

def _softmax(x, axis=-1):
    return torch.softmax(x, dim=axis)
def _gelu(x):
    return torch.nn.functional.gelu(x, approximate="tanh")
def _silu(x):
    return torch.nn.functional.silu(x)
def _sigmoid(x):
    return torch.sigmoid(x)
def _layernorm(x, axis=-1, eps=1e-5):
    m = x.mean(dim=axis, keepdim=True)
    v = x.var(dim=axis, keepdim=True, unbiased=False)
    return (x - m) / torch.sqrt(v + eps)
def _scatter_add(tgt, idx, src, axis=0):
    return tgt.clone().index_add_(axis, idx, src)
def _segment_sum(src, seg, n):
    out = torch.zeros((n,) + src.shape[1:], dtype=src.dtype)
    return out.index_add_(0, seg, src)
def _pad(x, pw):
    flat = tuple(v for pair in reversed(pw) for v in pair)
    return torch.nn.functional.pad(x, flat)

kernel_name = 'parallel_sum__sliding_block__mixer_token_mlp__prompt'

def setup_inputs():

    _w = (lambda a: (lambda t: t.to(torch.bfloat16) if t.is_floating_point() else t)(torch.as_tensor(a)))
    def _A_setup():
        B, S, D = 1, 2048, 1024
        return {
            "x": _w((lambda *s: torch.randn(*s, dtype=torch.bfloat16) * 0.05)(B, S, D)),
            "wqkv": _w((lambda *s: torch.randn(*s, dtype=torch.bfloat16) * 0.05)(D, 3 * D)),
            "wo": _w((lambda *s: torch.randn(*s, dtype=torch.bfloat16) * 0.05)(D, D)),
        }
    _A_in = _A_setup()

    def _B_setup():
        B, S, D, F = 1, 2048, 1024, 3584
        return {
            "x": _w((lambda *s: torch.randn(*s, dtype=torch.bfloat16) * 0.05)(B, S, D)),
            "w1": _w((lambda *s: torch.randn(*s, dtype=torch.bfloat16) * 3.2)(S, F) * (S ** -0.5)),
            "b1": _w((lambda *s: torch.randn(*s, dtype=torch.bfloat16) * 3.2)(F) * 0.02),
            "w2": _w((lambda *s: torch.randn(*s, dtype=torch.bfloat16) * 0.4)(F, S) * (F ** -0.5)),
            "b2": _w((lambda *s: torch.randn(*s, dtype=torch.bfloat16) * 0.4)(S) * 0.02),
        }
    _B_in = _B_setup()

    return {
        "A_x": _A_in["x"],
        "A_wqkv": _A_in["wqkv"],
        "A_wo": _A_in["wo"],
        "B_x": _B_in["x"],
        "B_w1": _B_in["w1"],
        "B_b1": _B_in["b1"],
        "B_w2": _B_in["w2"],
        "B_b2": _B_in["b2"],
    }

def reference(A_x, A_wqkv, A_wo, B_x, B_w1, B_b1, B_w2, B_b2):
    def _A_ref(x, wqkv, wo):
        B, S, D = x.shape
        H = 32; Dh = D // H; W = 256
        qkv = (lambda x, *d: x.permute(*d))((x @ wqkv).reshape(B, S, 3, H, Dh), 2, 0, 3, 1, 4)
        q, k, v = qkv[0], qkv[1], qkv[2]
        scores = torch.einsum("bhqd,bhkd->bhqk", q, k) * (Dh ** -0.5)
        idx = torch.arange(S)
        mask = (idx[:, None] - idx[None, :] >= 0) & (idx[:, None] - idx[None, :] < W)
        scores = torch.where(mask[None, None], scores, -1e9)
        p = _softmax(scores, axis=-1)
        o = torch.einsum("bhqk,bhkd->bhqd", p, v)
        return (lambda x, *d: x.permute(*d))(o, 0, 2, 1, 3).reshape(B, S, D) @ wo

    def _B_ref(x, w1, b1, w2, b2):
        B, S, D = x.shape
        h = _layernorm(x, axis=-1)
        u = torch.einsum("bsd,sf->bdf", h, w1) + b1
        u = _gelu(u)
        y = torch.einsum("bdf,fs->bds", u, w2) + b2
        return (lambda x, *d: x.permute(*d))(y, 0, 2, 1)

    x = A_x
    xn = _layernorm(x, axis=-1)
    return x + _A_ref(xn, A_wqkv, A_wo) + _B_ref(xn, B_w1, B_b1, B_w2, B_b2)
```

```asm
; @launch kernel=parallel_sum__sliding_block__mixer_token_mlp__prompt_kernel grid=(256,1,1) block=(512,1,1) lds=162880
.amdgcn_target "amdgcn-amd-amdhsa--gfx950"
.text
.globl parallel_sum__sliding_block__mixer_token_mlp__prompt_kernel
.p2align 8
.type parallel_sum__sliding_block__mixer_token_mlp__prompt_kernel,@function
parallel_sum__sliding_block__mixer_token_mlp__prompt_kernel:
    s_cmp_ge_u32 s2, 256
    s_cbranch_scc1 L_parallel_sum__sliding_block__mixer_token_mlp__prompt_kernel_end
    s_load_dwordx2 s[28:29], s[0:1], 80
    s_load_dwordx2 s[30:31], s[0:1], 8
    s_load_dwordx2 s[32:33], s[0:1], 32
    s_load_dwordx2 s[34:35], s[0:1], 40
    s_load_dwordx2 s[72:73], s[0:1], 0
    s_load_dwordx2 s[74:75], s[0:1], 72
    v_and_b32 v1, 63, v0
    v_lshrrev_b32 v13, 6, v0
    s_nop 0
    v_readfirstlane_b32 s16, v13
    v_mov_b32 v10, 0
    v_mov_b32 v11, 0
    v_mov_b32 v12, 159744
    ds_write_b64 v12, v[10:11]
    ds_write_b64 v12, v[10:11] offset:8
    s_and_b32 s36, s2, 7
    s_lshr_b32 s37, s2, 3
    s_sub_u32 s40, s37, 14
    s_cmp_ge_u32 s40, 16
    s_cbranch_scc1 L_parallel_sum__sliding_block__mixer_token_mlp__prompt_kernel_lnw
    s_mov_b32 s37, s40
    s_and_b32 s38, s36, 1
    s_lshl_b32 s38, s38, 2
    s_and_b32 s39, s37, 3
    s_add_u32 s38, s38, s39
    s_lshr_b32 s39, s36, 1
    s_lshl_b32 s39, s39, 2
    s_lshr_b32 s40, s37, 2
    s_add_u32 s39, s39, s40
    s_sub_u32 s69, s2, 112
    s_lshr_b32 s24, s16, 1
    s_and_b32 s25, s16, 1
    v_lshlrev_b32 v2, 4, v1
    s_lshl_b32 s19, s16, 12
    s_cmp_eq_u32 s16, 7
    s_cbranch_scc1 L_parallel_sum__sliding_block__mixer_token_mlp__prompt_kernel_c2
    s_cmp_ge_u32 s16, 4
    s_cbranch_scc1 L_parallel_sum__sliding_block__mixer_token_mlp__prompt_kernel_c1
    v_lshrrev_b32 v16, 4, v1
    v_and_b32 v17, 7, v1
    v_xor_b32 v17, v17, v16
    v_xor_b32 v18, 4, v17
    v_lshrrev_b32 v16, 3, v1
    v_lshlrev_b32 v16, 11, v16
    v_lshl_add_u32 v17, v17, 4, v16
    v_lshl_add_u32 v18, v18, 4, v16
    v_add_u32 v3, 0, v17
    v_add_u32 v4, 15360, v18
    v_add_u32 v5, 30720, v17
    v_add_u32 v6, 46080, v18
    s_lshl_b32 s17, s38, 2
    s_add_u32 s17, s17, s16
    s_lshl_b32 s17, s17, 17
    s_lshl_b32 s19, s16, 13
    s_mov_b32 s18, 0
    s_waitcnt lgkmcnt(0)
    s_mov_b32 s4, s72
    s_and_b32 s5, s73, 0xffff
    s_mov_b32 s6, 4194304
    s_mov_b32 s7, 0x20000
    s_add_u32 m0, s19, s18
    s_nop 0
    buffer_load_dwordx4 v3, s[4:7], s17 offen offset:0 lds
    buffer_load_dwordx4 v4, s[4:7], s17 offen offset:1024 lds
    buffer_load_dwordx4 v5, s[4:7], s17 offen offset:2048 lds
    buffer_load_dwordx4 v6, s[4:7], s17 offen offset:3072 lds
    s_add_u32 s17, s17, 65536
    s_add_u32 s18, s18, 4096
    s_add_u32 m0, s19, s18
    s_nop 0
    buffer_load_dwordx4 v3, s[4:7], s17 offen offset:0 lds
    buffer_load_dwordx4 v4, s[4:7], s17 offen offset:1024 lds
    buffer_load_dwordx4 v5, s[4:7], s17 offen offset:2048 lds
    buffer_load_dwordx4 v6, s[4:7], s17 offen offset:3072 lds
    s_sub_u32 s17, s17, 65408
    s_add_u32 s18, s18, 28672
    s_cmp_eq_u32 s18, 98304
    s_cselect_b32 s18, 0, s18
    s_add_u32 m0, s19, s18
    s_nop 0
    buffer_load_dwordx4 v3, s[4:7], s17 offen offset:0 lds
    buffer_load_dwordx4 v4, s[4:7], s17 offen offset:1024 lds
    buffer_load_dwordx4 v5, s[4:7], s17 offen offset:2048 lds
    buffer_load_dwordx4 v6, s[4:7], s17 offen offset:3072 lds
    s_add_u32 s17, s17, 65536
    s_add_u32 s18, s18, 4096
    s_add_u32 m0, s19, s18
    s_nop 0
    buffer_load_dwordx4 v3, s[4:7], s17 offen offset:0 lds
    buffer_load_dwordx4 v4, s[4:7], s17 offen offset:1024 lds
    buffer_load_dwordx4 v5, s[4:7], s17 offen offset:2048 lds
    buffer_load_dwordx4 v6, s[4:7], s17 offen offset:3072 lds
    s_sub_u32 s17, s17, 65408
    s_add_u32 s18, s18, 28672
    s_cmp_eq_u32 s18, 98304
    s_cselect_b32 s18, 0, s18
    s_add_u32 m0, s19, s18
    s_nop 0
    buffer_load_dwordx4 v3, s[4:7], s17 offen offset:0 lds
    buffer_load_dwordx4 v4, s[4:7], s17 offen offset:1024 lds
    buffer_load_dwordx4 v5, s[4:7], s17 offen offset:2048 lds
    buffer_load_dwordx4 v6, s[4:7], s17 offen offset:3072 lds
    s_add_u32 s17, s17, 65536
    s_add_u32 s18, s18, 4096
    v_lshrrev_b32 v16, 4, v1
    v_and_b32 v17, 15, v1
    v_lshlrev_b32 v17, 4, v17
    v_lshl_add_u32 v17, v16, 9, v17
    s_lshl_b32 s27, s24, 11
    v_add_u32 v7, s27, v17
    s_sub_u32 s27, 14336, s27
    v_add_u32 v8, s27, v17
    v_bfe_u32 v18, v1, 2, 2
    v_lshlrev_b32 v17, 10, v16
    v_lshl_add_u32 v17, v18, 7, v17
    v_and_b32 v19, 3, v1
    v_lshl_add_u32 v17, v19, 3, v17
    v_add_u32 v17, 16384, v17
    v_lshrrev_b32 v18, 1, v18
    v_and_b32 v16, 1, v16
    v_lshl_add_u32 v16, v16, 1, v18
    s_lshl_b32 s27, s25, 1
    s_add_u32 s3, s27, 0
    v_xor_b32 v18, s3, v16
    v_lshl_add_u32 v9, v18, 5, v17
    s_add_u32 s3, s27, 1
    v_xor_b32 v18, s3, v16
    v_lshl_add_u32 v10, v18, 5, v17
    v_add_u32 v9, 81920, v9
    v_add_u32 v10, 81920, v10
    v_bfe_u32 v16, v1, 1, 3
    v_lshrrev_b32 v17, 4, v1
    v_xor_b32 v17, v17, v16
    v_and_b32 v16, 15, v1
    v_lshlrev_b32 v16, 7, v16
    v_lshl_add_u32 v16, v17, 4, v16
    v_xor_b32 v17, 64, v16
    s_lshl_b32 s27, s24, 12
    v_add_u32 v7, s27, v16
    v_add_u32 v11, s27, v17
    s_sub_u32 s27, 28672, s27
    v_add_u32 v8, s27, v16
    v_add_u32 v12, s27, v17
    s_mov_b32 s26, 0
    s_mov_b32 s54, 4294901760
    s_mov_b32 s55, 0
    v_mov_b32 v96, 0
    v_mov_b32 v97, 0
    v_mov_b32 v98, 0
    v_mov_b32 v99, 0
    v_mov_b32 v100, 0
    v_mov_b32 v101, 0
    v_mov_b32 v102, 0
    v_mov_b32 v103, 0
    v_mov_b32 v104, 0
    v_mov_b32 v105, 0
    v_mov_b32 v106, 0
    v_mov_b32 v107, 0
    v_mov_b32 v108, 0
    v_mov_b32 v109, 0
    v_mov_b32 v110, 0
    v_mov_b32 v111, 0
    v_mov_b32 v112, 0
    v_mov_b32 v113, 0
    v_mov_b32 v114, 0
    v_mov_b32 v115, 0
    v_mov_b32 v116, 0
    v_mov_b32 v117, 0
    v_mov_b32 v118, 0
    v_mov_b32 v119, 0
    v_mov_b32 v120, 0
    v_mov_b32 v121, 0
    v_mov_b32 v122, 0
    v_mov_b32 v123, 0
    v_mov_b32 v124, 0
    v_mov_b32 v125, 0
    v_mov_b32 v126, 0
    v_mov_b32 v127, 0
    v_mov_b32 v128, 0
    v_mov_b32 v129, 0
    v_mov_b32 v130, 0
    v_mov_b32 v131, 0
    v_mov_b32 v132, 0
    v_mov_b32 v133, 0
    v_mov_b32 v134, 0
    v_mov_b32 v135, 0
    v_mov_b32 v136, 0
    v_mov_b32 v137, 0
    v_mov_b32 v138, 0
    v_mov_b32 v139, 0
    v_mov_b32 v140, 0
    v_mov_b32 v141, 0
    v_mov_b32 v142, 0
    v_mov_b32 v143, 0
    v_mov_b32 v144, 0
    v_mov_b32 v145, 0
    v_mov_b32 v146, 0
    v_mov_b32 v147, 0
    v_mov_b32 v148, 0
    v_mov_b32 v149, 0
    v_mov_b32 v150, 0
    v_mov_b32 v151, 0
    v_mov_b32 v152, 0
    v_mov_b32 v153, 0
    v_mov_b32 v154, 0
    v_mov_b32 v155, 0
    v_mov_b32 v156, 0
    v_mov_b32 v157, 0
    v_mov_b32 v158, 0
    v_mov_b32 v159, 0
    v_mov_b32 v160, 0
    v_mov_b32 v161, 0
    v_mov_b32 v162, 0
    v_mov_b32 v163, 0
    v_mov_b32 v164, 0
    v_mov_b32 v165, 0
    v_mov_b32 v166, 0
    v_mov_b32 v167, 0
    v_mov_b32 v168, 0
    v_mov_b32 v169, 0
    v_mov_b32 v170, 0
    v_mov_b32 v171, 0
    v_mov_b32 v172, 0
    v_mov_b32 v173, 0
    v_mov_b32 v174, 0
    v_mov_b32 v175, 0
    v_mov_b32 v176, 0
    v_mov_b32 v177, 0
    v_mov_b32 v178, 0
    v_mov_b32 v179, 0
    v_mov_b32 v180, 0
    v_mov_b32 v181, 0
    v_mov_b32 v182, 0
    v_mov_b32 v183, 0
    v_mov_b32 v184, 0
    v_mov_b32 v185, 0
    v_mov_b32 v186, 0
    v_mov_b32 v187, 0
    v_mov_b32 v188, 0
    v_mov_b32 v189, 0
    v_mov_b32 v190, 0
    v_mov_b32 v191, 0
    v_and_b32 v255, 31, v1
    v_lshrrev_b32 v248, 5, v1
    v_lshlrev_b32 v248, 2, v248
    v_sub_u32 v255, v255, v248
    v_mov_b32 v254, 0xf149f2ca
    v_cmp_le_i32 vcc, 0, v255
    v_mov_b32 v192, 0
    v_mov_b32 v193, 0
    v_cndmask_b32_e64 v224, v254, 0, vcc
    v_cmp_le_i32 vcc, 1, v255
    v_mov_b32 v194, 0
    v_mov_b32 v195, 0
    v_cndmask_b32_e64 v225, v254, 0, vcc
    v_cmp_le_i32 vcc, 2, v255
    v_mov_b32 v196, 0
    v_mov_b32 v197, 0
    v_cndmask_b32_e64 v226, v254, 0, vcc
    v_cmp_le_i32 vcc, 3, v255
    v_mov_b32 v198, 0
    v_mov_b32 v199, 0
    v_cndmask_b32_e64 v227, v254, 0, vcc
    v_cmp_le_i32 vcc, 16, v255
    v_mov_b32 v200, 0
    v_mov_b32 v201, 0
    v_cndmask_b32_e64 v228, v254, 0, vcc
    v_cmp_le_i32 vcc, 17, v255
    v_mov_b32 v202, 0
    v_mov_b32 v203, 0
    v_cndmask_b32_e64 v229, v254, 0, vcc
    v_cmp_le_i32 vcc, 18, v255
    v_mov_b32 v204, 0
    v_mov_b32 v205, 0
    v_cndmask_b32_e64 v230, v254, 0, vcc
    v_cmp_le_i32 vcc, 19, v255
    v_mov_b32 v206, 0
    v_mov_b32 v207, 0
    v_cndmask_b32_e64 v231, v254, 0, vcc
    v_cmp_le_i32 vcc, 8, v255
    v_mov_b32 v208, 0
    v_mov_b32 v209, 0
    v_cndmask_b32_e64 v232, v254, 0, vcc
    v_cmp_le_i32 vcc, 9, v255
    v_mov_b32 v210, 0
    v_mov_b32 v211, 0
    v_cndmask_b32_e64 v233, v254, 0, vcc
    v_cmp_le_i32 vcc, 10, v255
    v_mov_b32 v212, 0
    v_mov_b32 v213, 0
    v_cndmask_b32_e64 v234, v254, 0, vcc
    v_cmp_le_i32 vcc, 11, v255
    v_mov_b32 v214, 0
    v_mov_b32 v215, 0
    v_cndmask_b32_e64 v235, v254, 0, vcc
    v_cmp_le_i32 vcc, 24, v255
    v_mov_b32 v216, 0
    v_mov_b32 v217, 0
    v_cndmask_b32_e64 v236, v254, 0, vcc
    v_cmp_le_i32 vcc, 25, v255
    v_mov_b32 v218, 0
    v_mov_b32 v219, 0
    v_cndmask_b32_e64 v237, v254, 0, vcc
    v_cmp_le_i32 vcc, 26, v255
    v_mov_b32 v220, 0
    v_mov_b32 v221, 0
    v_cndmask_b32_e64 v238, v254, 0, vcc
    v_cmp_le_i32 vcc, 27, v255
    v_mov_b32 v222, 0
    v_mov_b32 v223, 0
    v_cndmask_b32_e64 v239, v254, 0, vcc
    v_mov_b32 v240, 0
    v_mov_b32 v242, 0
    v_mov_b32 v241, 0
    v_mov_b32 v243, 0
    v_mov_b32 v244, 0x3f803f80
    v_mov_b32 v245, 0x3f803f80
    v_mov_b32 v246, 0x3f803f80
    v_mov_b32 v247, 0x3f803f80
    s_mov_b32 s22, 0
    v_mov_b32 v13, v9
    v_mov_b32 v14, v10
    s_waitcnt vmcnt(12)
    s_barrier
    ds_read_b128 v[16:19], v7 offset:0
    ds_read_b64_tr_b16 v[32:33], v13 offset:0
    ds_read_b64_tr_b16 v[34:35], v13 offset:512
    ds_read_b64_tr_b16 v[36:37], v14 offset:0
    ds_read_b64_tr_b16 v[38:39], v14 offset:512
    ds_read_b64_tr_b16 v[40:41], v13 offset:4096
    ds_read_b64_tr_b16 v[42:43], v13 offset:4608
    ds_read_b64_tr_b16 v[44:45], v14 offset:4096
    ds_read_b64_tr_b16 v[46:47], v14 offset:4608
    ds_read_b64_tr_b16 v[48:49], v13 offset:8192
    ds_read_b64_tr_b16 v[50:51], v13 offset:8704
    ds_read_b64_tr_b16 v[52:53], v14 offset:8192
    ds_read_b64_tr_b16 v[54:55], v14 offset:8704
    ds_read_b128 v[20:23], v7 offset:2048
    ds_read_b128 v[24:27], v8 offset:0
    ds_read_b128 v[28:31], v8 offset:2048
    s_mov_b32 s21, s22
    s_add_u32 s22, s22, 12288
    s_cmp_eq_u32 s22, 61440
    s_cselect_b32 s22, 0, s22
    v_add_u32 v13, s22, v9
    v_add_u32 v14, s22, v10
    v_add_u32 v11, s55, v11
    v_add_u32 v12, s55, v12
    s_mov_b32 s23, 16
L_parallel_sum__sliding_block__mixer_token_mlp__prompt_kernel_q0:
    s_waitcnt vmcnt(63) lgkmcnt(0)
    s_barrier
    v_mfma_f32_16x16x32_bf16 v[96:99], v[32:35], v[16:19], v[96:99]
    ds_read_b128 v[56:59], v11 offset:0
    v_mfma_f32_16x16x32_bf16 v[100:103], v[36:39], v[16:19], v[100:103]
    s_add_u32 m0, s19, s18
    s_nop 0
    buffer_load_dwordx4 v3, s[4:7], s17 offen offset:0 lds
    ds_read_b64_tr_b16 v[72:73], v13 offset:0
    v_mfma_f32_16x16x32_bf16 v[104:107], v[40:43], v[16:19], v[104:107]
    ds_read_b64_tr_b16 v[74:75], v13 offset:512
    v_mfma_f32_16x16x32_bf16 v[108:111], v[44:47], v[16:19], v[108:111]
    ds_read_b64_tr_b16 v[76:77], v14 offset:0
    v_mfma_f32_16x16x32_bf16 v[160:163], v[16:19], v[48:51], v[160:163]
    ds_read_b64_tr_b16 v[78:79], v14 offset:512
    v_mfma_f32_16x16x32_bf16 v[168:171], v[16:19], v[52:55], v[168:171]
    buffer_load_dwordx4 v4, s[4:7], s17 offen offset:1024 lds
    ds_read_b64_tr_b16 v[80:81], v13 offset:4096
    v_mfma_f32_16x16x32_bf16 v[172:175], v[20:23], v[52:55], v[172:175]
    ds_read_b64_tr_b16 v[82:83], v13 offset:4608
    v_mfma_f32_16x16x32_bf16 v[164:167], v[20:23], v[48:51], v[164:167]
    ds_read_b64_tr_b16 v[84:85], v14 offset:4096
    v_mfma_f32_16x16x32_bf16 v[124:127], v[44:47], v[20:23], v[124:127]
    ds_read_b64_tr_b16 v[86:87], v14 offset:4608
    v_mfma_f32_16x16x32_bf16 v[120:123], v[40:43], v[20:23], v[120:123]
    ds_read_b64_tr_b16 v[88:89], v13 offset:8192
    v_mfma_f32_16x16x32_bf16 v[116:119], v[36:39], v[20:23], v[116:119]
    buffer_load_dwordx4 v5, s[4:7], s17 offen offset:2048 lds
    ds_read_b64_tr_b16 v[90:91], v13 offset:8704
    v_mfma_f32_16x16x32_bf16 v[112:115], v[32:35], v[20:23], v[112:115]
    ds_read_b64_tr_b16 v[92:93], v14 offset:8192
    v_mfma_f32_16x16x32_bf16 v[128:131], v[32:35], v[24:27], v[128:131]
    ds_read_b64_tr_b16 v[94:95], v14 offset:8704
    v_mfma_f32_16x16x32_bf16 v[132:135], v[36:39], v[24:27], v[132:135]
    ds_read_b128 v[60:63], v11 offset:2048
    v_mfma_f32_16x16x32_bf16 v[136:139], v[40:43], v[24:27], v[136:139]
    buffer_load_dwordx4 v6, s[4:7], s17 offen offset:3072 lds
    s_sub_u32 s17, s17, 65408
    s_add_u32 s18, s18, 28672
    s_cmp_eq_u32 s18, 98304
    s_cselect_b32 s18, 0, s18
    ds_read_b128 v[64:67], v12 offset:0
    v_mfma_f32_16x16x32_bf16 v[140:143], v[44:47], v[24:27], v[140:143]
    ds_read_b128 v[68:71], v12 offset:2048
    s_mov_b32 s21, s22
    s_add_u32 s22, s22, 12288
    s_cmp_eq_u32 s22, 61440
    s_cselect_b32 s22, 0, s22
    s_add_u32 s26, s26, 1
    s_cmp_eq_u32 s26, 3
    s_cselect_b32 s26, 0, s26
    s_cselect_b32 s55, s54, 32768
    v_mfma_f32_16x16x32_bf16 v[176:179], v[24:27], v[48:51], v[176:179]
    v_add_u32 v13, s22, v9
    v_add_u32 v14, s22, v10
    v_mfma_f32_16x16x32_bf16 v[184:187], v[24:27], v[52:55], v[184:187]
    v_add_u32 v7, s55, v7
    v_add_u32 v8, s55, v8
    v_mfma_f32_16x16x32_bf16 v[188:191], v[28:31], v[52:55], v[188:191]
    v_mfma_f32_16x16x32_bf16 v[180:183], v[28:31], v[48:51], v[180:183]
    v_mfma_f32_16x16x32_bf16 v[156:159], v[44:47], v[28:31], v[156:159]
    v_mfma_f32_16x16x32_bf16 v[152:155], v[40:43], v[28:31], v[152:155]
    v_mfma_f32_16x16x32_bf16 v[148:151], v[36:39], v[28:31], v[148:151]
    v_mfma_f32_16x16x32_bf16 v[144:147], v[32:35], v[28:31], v[144:147]
    s_waitcnt vmcnt(8) lgkmcnt(0)
    s_barrier
    v_mfma_f32_16x16x32_bf16 v[96:99], v[72:75], v[56:59], v[96:99]
    ds_read_b128 v[16:19], v7 offset:0
    v_mfma_f32_16x16x32_bf16 v[100:103], v[76:79], v[56:59], v[100:103]
    s_add_u32 m0, s19, s18
    s_nop 0
    buffer_load_dwordx4 v3, s[4:7], s17 offen offset:0 lds
    ds_read_b64_tr_b16 v[32:33], v13 offset:0
    v_mfma_f32_16x16x32_bf16 v[104:107], v[80:83], v[56:59], v[104:107]
    ds_read_b64_tr_b16 v[34:35], v13 offset:512
    v_mfma_f32_16x16x32_bf16 v[108:111], v[84:87], v[56:59], v[108:111]
    ds_read_b64_tr_b16 v[36:37], v14 offset:0
    v_mfma_f32_16x16x32_bf16 v[160:163], v[56:59], v[88:91], v[160:163]
    ds_read_b64_tr_b16 v[38:39], v14 offset:512
    v_mfma_f32_16x16x32_bf16 v[168:171], v[56:59], v[92:95], v[168:171]
    buffer_load_dwordx4 v4, s[4:7], s17 offen offset:1024 lds
    ds_read_b64_tr_b16 v[40:41], v13 offset:4096
    v_mfma_f32_16x16x32_bf16 v[172:175], v[60:63], v[92:95], v[172:175]
    ds_read_b64_tr_b16 v[42:43], v13 offset:4608
    v_mfma_f32_16x16x32_bf16 v[164:167], v[60:63], v[88:91], v[164:167]
    ds_read_b64_tr_b16 v[44:45], v14 offset:4096
    v_mfma_f32_16x16x32_bf16 v[124:127], v[84:87], v[60:63], v[124:127]
    ds_read_b64_tr_b16 v[46:47], v14 offset:4608
    v_mfma_f32_16x16x32_bf16 v[120:123], v[80:83], v[60:63], v[120:123]
    ds_read_b64_tr_b16 v[48:49], v13 offset:8192
    v_mfma_f32_16x16x32_bf16 v[116:119], v[76:79], v[60:63], v[116:119]
    buffer_load_dwordx4 v5, s[4:7], s17 offen offset:2048 lds
    ds_read_b64_tr_b16 v[50:51], v13 offset:8704
    v_mfma_f32_16x16x32_bf16 v[112:115], v[72:75], v[60:63], v[112:115]
    ds_read_b64_tr_b16 v[52:53], v14 offset:8192
    v_mfma_f32_16x16x32_bf16 v[128:131], v[72:75], v[64:67], v[128:131]
    ds_read_b64_tr_b16 v[54:55], v14 offset:8704
    v_mfma_f32_16x16x32_bf16 v[132:135], v[76:79], v[64:67], v[132:135]
    ds_read_b128 v[20:23], v7 offset:2048
    v_mfma_f32_16x16x32_bf16 v[136:139], v[80:83], v[64:67], v[136:139]
    buffer_load_dwordx4 v6, s[4:7], s17 offen offset:3072 lds
    s_add_u32 s17, s17, 65536
    s_add_u32 s18, s18, 4096
    ds_read_b128 v[24:27], v8 offset:0
    v_mfma_f32_16x16x32_bf16 v[140:143], v[84:87], v[64:67], v[140:143]
    ds_read_b128 v[28:31], v8 offset:2048
    s_mov_b32 s21, s22
    s_add_u32 s22, s22, 12288
    s_cmp_eq_u32 s22, 61440
    s_cselect_b32 s22, 0, s22
    v_mfma_f32_16x16x32_bf16 v[176:179], v[64:67], v[88:91], v[176:179]
    v_add_u32 v13, s22, v9
    v_add_u32 v14, s22, v10
    v_mfma_f32_16x16x32_bf16 v[184:187], v[64:67], v[92:95], v[184:187]
    v_add_u32 v11, s55, v11
    v_add_u32 v12, s55, v12
    v_mfma_f32_16x16x32_bf16 v[188:191], v[68:71], v[92:95], v[188:191]
    v_mfma_f32_16x16x32_bf16 v[180:183], v[68:71], v[88:91], v[180:183]
    v_mfma_f32_16x16x32_bf16 v[156:159], v[84:87], v[68:71], v[156:159]
    v_mfma_f32_16x16x32_bf16 v[152:155], v[80:83], v[68:71], v[152:155]
    v_mfma_f32_16x16x32_bf16 v[148:151], v[76:79], v[68:71], v[148:151]
    v_mfma_f32_16x16x32_bf16 v[144:147], v[72:75], v[68:71], v[144:147]
    s_sub_u32 s23, s23, 1
    s_cmp_lg_u32 s23, 0
    s_cbranch_scc1 L_parallel_sum__sliding_block__mixer_token_mlp__prompt_kernel_q0
    s_waitcnt vmcnt(0) lgkmcnt(0)
    s_branch L_parallel_sum__sliding_block__mixer_token_mlp__prompt_kernel_qepi
L_parallel_sum__sliding_block__mixer_token_mlp__prompt_kernel_c1:
    v_lshrrev_b32 v16, 3, v1
    v_and_b32 v17, 7, v1
    v_bfe_u32 v18, v1, 4, 1
    v_lshlrev_b32 v18, 1, v18
    v_xor_b32 v17, v17, v18
    v_xor_b32 v19, 4, v17
    v_mul_u32_u24 v16, 6144, v16
    v_lshl_add_u32 v17, v17, 4, v16
    v_lshl_add_u32 v19, v19, 4, v16
    v_add_u32 v3, 0, v17
    v_add_u32 v4, 48128, v19
    v_add_u32 v5, 96256, v17
    v_add_u32 v6, 144384, v19
    s_sub_u32 s17, s16, 4
    s_lshl_b32 s19, s17, 12
    s_add_u32 s19, s19, 98304
    s_lshl_b32 s17, s17, 11
    s_lshl_b32 s40, s39, 7
    s_add_u32 s17, s17, s40
    s_waitcnt lgkmcnt(0)
    s_mov_b32 s4, s30
    s_and_b32 s5, s31, 0xffff
    s_mov_b32 s6, 6291456
    s_mov_b32 s7, 0x20000
    s_add_u32 m0, s19, 0
    s_nop 0
    buffer_load_dwordx4 v3, s[4:7], s17 offen offset:0 lds
    buffer_load_dwordx4 v4, s[4:7], s17 offen offset:1024 lds
    buffer_load_dwordx4 v5, s[4:7], s17 offen offset:2048 lds
    buffer_load_dwordx4 v6, s[4:7], s17 offen offset:3072 lds
    s_add_u32 s17, s17, 196608
    s_add_u32 m0, s19, 12288
    s_nop 0
    buffer_load_dwordx4 v3, s[4:7], s17 offen offset:0 lds
    buffer_load_dwordx4 v4, s[4:7], s17 offen offset:1024 lds
    buffer_load_dwordx4 v5, s[4:7], s17 offen offset:2048 lds
    buffer_load_dwordx4 v6, s[4:7], s17 offen offset:3072 lds
    s_add_u32 s17, s17, 196608
    s_add_u32 m0, s19, 24576
    s_nop 0
    buffer_load_dwordx4 v3, s[4:7], s17 offen offset:0 lds
    buffer_load_dwordx4 v4, s[4:7], s17 offen offset:1024 lds
    buffer_load_dwordx4 v5, s[4:7], s17 offen offset:2048 lds
    buffer_load_dwordx4 v6, s[4:7], s17 offen offset:3072 lds
    s_add_u32 s17, s17, 196608
    s_add_u32 m0, s19, 36864
    s_nop 0
    buffer_load_dwordx4 v3, s[4:7], s17 offen offset:0 lds
    buffer_load_dwordx4 v4, s[4:7], s17 offen offset:1024 lds
    buffer_load_dwordx4 v5, s[4:7], s17 offen offset:2048 lds
    buffer_load_dwordx4 v6, s[4:7], s17 offen offset:3072 lds
    s_add_u32 s17, s17, 196608
    s_mov_b32 s21, 49152
    s_add_u32 m0, s19, s21
    s_nop 0
    buffer_load_dwordx4 v3, s[4:7], s17 offen offset:0 lds
    buffer_load_dwordx4 v4, s[4:7], s17 offen offset:1024 lds
    buffer_load_dwordx4 v5, s[4:7], s17 offen offset:2048 lds
    buffer_load_dwordx4 v6, s[4:7], s17 offen offset:3072 lds
    s_add_u32 s17, s17, 196608
    v_lshrrev_b32 v16, 4, v1
    v_and_b32 v17, 15, v1
    v_lshlrev_b32 v17, 4, v17
    v_lshl_add_u32 v17, v16, 9, v17
    s_lshl_b32 s27, s24, 11
    v_add_u32 v7, s27, v17
    s_sub_u32 s27, 14336, s27
    v_add_u32 v8, s27, v17
    v_bfe_u32 v18, v1, 2, 2
    v_lshlrev_b32 v17, 10, v16
    v_lshl_add_u32 v17, v18, 7, v17
    v_and_b32 v19, 3, v1
    v_lshl_add_u32 v17, v19, 3, v17
    v_add_u32 v17, 16384, v17
    v_lshrrev_b32 v18, 1, v18
    v_and_b32 v16, 1, v16
    v_lshl_add_u32 v16, v16, 1, v18
    s_lshl_b32 s27, s25, 1
    s_add_u32 s3, s27, 0
    v_xor_b32 v18, s3, v16
    v_lshl_add_u32 v9, v18, 5, v17
    s_add_u32 s3, s27, 1
    v_xor_b32 v18, s3, v16
    v_lshl_add_u32 v10, v18, 5, v17
    v_add_u32 v9, 81920, v9
    v_add_u32 v10, 81920, v10
    v_bfe_u32 v16, v1, 1, 3
    v_lshrrev_b32 v17, 4, v1
    v_xor_b32 v17, v17, v16
    v_and_b32 v16, 15, v1
    v_lshlrev_b32 v16, 7, v16
    v_lshl_add_u32 v16, v17, 4, v16
    v_xor_b32 v17, 64, v16
    s_lshl_b32 s27, s24, 12
    v_add_u32 v7, s27, v16
    v_add_u32 v11, s27, v17
    s_sub_u32 s27, 28672, s27
    v_add_u32 v8, s27, v16
    v_add_u32 v12, s27, v17
    s_mov_b32 s26, 0
    s_mov_b32 s54, 4294901760
    s_mov_b32 s55, 0
    v_mov_b32 v96, 0
    v_mov_b32 v97, 0
    v_mov_b32 v98, 0
    v_mov_b32 v99, 0
    v_mov_b32 v100, 0
    v_mov_b32 v101, 0
    v_mov_b32 v102, 0
    v_mov_b32 v103, 0
    v_mov_b32 v104, 0
    v_mov_b32 v105, 0
    v_mov_b32 v106, 0
    v_mov_b32 v107, 0
    v_mov_b32 v108, 0
    v_mov_b32 v109, 0
    v_mov_b32 v110, 0
    v_mov_b32 v111, 0
    v_mov_b32 v112, 0
    v_mov_b32 v113, 0
    v_mov_b32 v114, 0
    v_mov_b32 v115, 0
    v_mov_b32 v116, 0
    v_mov_b32 v117, 0
    v_mov_b32 v118, 0
    v_mov_b32 v119, 0
    v_mov_b32 v120, 0
    v_mov_b32 v121, 0
    v_mov_b32 v122, 0
    v_mov_b32 v123, 0
    v_mov_b32 v124, 0
    v_mov_b32 v125, 0
    v_mov_b32 v126, 0
    v_mov_b32 v127, 0
    v_mov_b32 v128, 0
    v_mov_b32 v129, 0
    v_mov_b32 v130, 0
    v_mov_b32 v131, 0
    v_mov_b32 v132, 0
    v_mov_b32 v133, 0
    v_mov_b32 v134, 0
    v_mov_b32 v135, 0
    v_mov_b32 v136, 0
    v_mov_b32 v137, 0
    v_mov_b32 v138, 0
    v_mov_b32 v139, 0
    v_mov_b32 v140, 0
    v_mov_b32 v141, 0
    v_mov_b32 v142, 0
    v_mov_b32 v143, 0
    v_mov_b32 v144, 0
    v_mov_b32 v145, 0
    v_mov_b32 v146, 0
    v_mov_b32 v147, 0
    v_mov_b32 v148, 0
    v_mov_b32 v149, 0
    v_mov_b32 v150, 0
    v_mov_b32 v151, 0
    v_mov_b32 v152, 0
    v_mov_b32 v153, 0
    v_mov_b32 v154, 0
    v_mov_b32 v155, 0
    v_mov_b32 v156, 0
    v_mov_b32 v157, 0
    v_mov_b32 v158, 0
    v_mov_b32 v159, 0
    v_mov_b32 v160, 0
    v_mov_b32 v161, 0
    v_mov_b32 v162, 0
    v_mov_b32 v163, 0
    v_mov_b32 v164, 0
    v_mov_b32 v165, 0
    v_mov_b32 v166, 0
    v_mov_b32 v167, 0
    v_mov_b32 v168, 0
    v_mov_b32 v169, 0
    v_mov_b32 v170, 0
    v_mov_b32 v171, 0
    v_mov_b32 v172, 0
    v_mov_b32 v173, 0
    v_mov_b32 v174, 0
    v_mov_b32 v175, 0
    v_mov_b32 v176, 0
    v_mov_b32 v177, 0
    v_mov_b32 v178, 0
    v_mov_b32 v179, 0
    v_mov_b32 v180, 0
    v_mov_b32 v181, 0
    v_mov_b32 v182, 0
    v_mov_b32 v183, 0
    v_mov_b32 v184, 0
    v_mov_b32 v185, 0
    v_mov_b32 v186, 0
    v_mov_b32 v187, 0
    v_mov_b32 v188, 0
    v_mov_b32 v189, 0
    v_mov_b32 v190, 0
    v_mov_b32 v191, 0
    v_and_b32 v255, 31, v1
    v_lshrrev_b32 v248, 5, v1
    v_lshlrev_b32 v248, 2, v248
    v_sub_u32 v255, v255, v248
    v_mov_b32 v254, 0xf149f2ca
    v_cmp_le_i32 vcc, 0, v255
    v_mov_b32 v192, 0
    v_mov_b32 v193, 0
    v_cndmask_b32_e64 v224, v254, 0, vcc
    v_cmp_le_i32 vcc, 1, v255
    v_mov_b32 v194, 0
    v_mov_b32 v195, 0
    v_cndmask_b32_e64 v225, v254, 0, vcc
    v_cmp_le_i32 vcc, 2, v255
    v_mov_b32 v196, 0
    v_mov_b32 v197, 0
    v_cndmask_b32_e64 v226, v254, 0, vcc
    v_cmp_le_i32 vcc, 3, v255
    v_mov_b32 v198, 0
    v_mov_b32 v199, 0
    v_cndmask_b32_e64 v227, v254, 0, vcc
    v_cmp_le_i32 vcc, 16, v255
    v_mov_b32 v200, 0
    v_mov_b32 v201, 0
    v_cndmask_b32_e64 v228, v254, 0, vcc
    v_cmp_le_i32 vcc, 17, v255
    v_mov_b32 v202, 0
    v_mov_b32 v203, 0
    v_cndmask_b32_e64 v229, v254, 0, vcc
    v_cmp_le_i32 vcc, 18, v255
    v_mov_b32 v204, 0
    v_mov_b32 v205, 0
    v_cndmask_b32_e64 v230, v254, 0, vcc
    v_cmp_le_i32 vcc, 19, v255
    v_mov_b32 v206, 0
    v_mov_b32 v207, 0
    v_cndmask_b32_e64 v231, v254, 0, vcc
    v_cmp_le_i32 vcc, 8, v255
    v_mov_b32 v208, 0
    v_mov_b32 v209, 0
    v_cndmask_b32_e64 v232, v254, 0, vcc
    v_cmp_le_i32 vcc, 9, v255
    v_mov_b32 v210, 0
    v_mov_b32 v211, 0
    v_cndmask_b32_e64 v233, v254, 0, vcc
    v_cmp_le_i32 vcc, 10, v255
    v_mov_b32 v212, 0
    v_mov_b32 v213, 0
    v_cndmask_b32_e64 v234, v254, 0, vcc
    v_cmp_le_i32 vcc, 11, v255
    v_mov_b32 v214, 0
    v_mov_b32 v215, 0
    v_cndmask_b32_e64 v235, v254, 0, vcc
    v_cmp_le_i32 vcc, 24, v255
    v_mov_b32 v216, 0
    v_mov_b32 v217, 0
    v_cndmask_b32_e64 v236, v254, 0, vcc
    v_cmp_le_i32 vcc, 25, v255
    v_mov_b32 v218, 0
    v_mov_b32 v219, 0
    v_cndmask_b32_e64 v237, v254, 0, vcc
    v_cmp_le_i32 vcc, 26, v255
    v_mov_b32 v220, 0
    v_mov_b32 v221, 0
    v_cndmask_b32_e64 v238, v254, 0, vcc
    v_cmp_le_i32 vcc, 27, v255
    v_mov_b32 v222, 0
    v_mov_b32 v223, 0
    v_cndmask_b32_e64 v239, v254, 0, vcc
    v_mov_b32 v240, 0
    v_mov_b32 v242, 0
    v_mov_b32 v241, 0
    v_mov_b32 v243, 0
    v_mov_b32 v244, 0x3f803f80
    v_mov_b32 v245, 0x3f803f80
    v_mov_b32 v246, 0x3f803f80
    v_mov_b32 v247, 0x3f803f80
    s_mov_b32 s22, 0
    v_mov_b32 v13, v9
    v_mov_b32 v14, v10
    s_waitcnt vmcnt(16)
    s_barrier
    ds_read_b128 v[16:19], v7 offset:0
    ds_read_b64_tr_b16 v[32:33], v13 offset:0
    ds_read_b64_tr_b16 v[34:35], v13 offset:512
    ds_read_b64_tr_b16 v[36:37], v14 offset:0
    ds_read_b64_tr_b16 v[38:39], v14 offset:512
    ds_read_b64_tr_b16 v[40:41], v13 offset:4096
    ds_read_b64_tr_b16 v[42:43], v13 offset:4608
    ds_read_b64_tr_b16 v[44:45], v14 offset:4096
    ds_read_b64_tr_b16 v[46:47], v14 offset:4608
    ds_read_b64_tr_b16 v[48:49], v13 offset:8192
    ds_read_b64_tr_b16 v[50:51], v13 offset:8704
    ds_read_b64_tr_b16 v[52:53], v14 offset:8192
    ds_read_b64_tr_b16 v[54:55], v14 offset:8704
    ds_read_b128 v[20:23], v7 offset:2048
    ds_read_b128 v[24:27], v8 offset:0
    ds_read_b128 v[28:31], v8 offset:2048
    s_mov_b32 s21, s22
    s_add_u32 s22, s22, 12288
    s_cmp_eq_u32 s22, 61440
    s_cselect_b32 s22, 0, s22
    v_add_u32 v13, s22, v9
    v_add_u32 v14, s22, v10
    v_add_u32 v11, s55, v11
    v_add_u32 v12, s55, v12
    s_mov_b32 s23, 16
L_parallel_sum__sliding_block__mixer_token_mlp__prompt_kernel_q1:
    s_waitcnt vmcnt(12) lgkmcnt(0)
    s_barrier
    v_mfma_f32_16x16x32_bf16 v[96:99], v[32:35], v[16:19], v[96:99]
    ds_read_b128 v[56:59], v11 offset:0
    v_mfma_f32_16x16x32_bf16 v[100:103], v[36:39], v[16:19], v[100:103]
    s_add_u32 m0, s19, s21
    s_nop 0
    buffer_load_dwordx4 v3, s[4:7], s17 offen offset:0 lds
    ds_read_b64_tr_b16 v[72:73], v13 offset:0
    v_mfma_f32_16x16x32_bf16 v[104:107], v[40:43], v[16:19], v[104:107]
    ds_read_b64_tr_b16 v[74:75], v13 offset:512
    v_mfma_f32_16x16x32_bf16 v[108:111], v[44:47], v[16:19], v[108:111]
    ds_read_b64_tr_b16 v[76:77], v14 offset:0
    v_mfma_f32_16x16x32_bf16 v[160:163], v[16:19], v[48:51], v[160:163]
    ds_read_b64_tr_b16 v[78:79], v14 offset:512
    v_mfma_f32_16x16x32_bf16 v[168:171], v[16:19], v[52:55], v[168:171]
    buffer_load_dwordx4 v4, s[4:7], s17 offen offset:1024 lds
    ds_read_b64_tr_b16 v[80:81], v13 offset:4096
    v_mfma_f32_16x16x32_bf16 v[172:175], v[20:23], v[52:55], v[172:175]
    ds_read_b64_tr_b16 v[82:83], v13 offset:4608
    v_mfma_f32_16x16x32_bf16 v[164:167], v[20:23], v[48:51], v[164:167]
    ds_read_b64_tr_b16 v[84:85], v14 offset:4096
    v_mfma_f32_16x16x32_bf16 v[124:127], v[44:47], v[20:23], v[124:127]
    ds_read_b64_tr_b16 v[86:87], v14 offset:4608
    v_mfma_f32_16x16x32_bf16 v[120:123], v[40:43], v[20:23], v[120:123]
    ds_read_b64_tr_b16 v[88:89], v13 offset:8192
    v_mfma_f32_16x16x32_bf16 v[116:119], v[36:39], v[20:23], v[116:119]
    buffer_load_dwordx4 v5, s[4:7], s17 offen offset:2048 lds
    ds_read_b64_tr_b16 v[90:91], v13 offset:8704
    v_mfma_f32_16x16x32_bf16 v[112:115], v[32:35], v[20:23], v[112:115]
    ds_read_b64_tr_b16 v[92:93], v14 offset:8192
    v_mfma_f32_16x16x32_bf16 v[128:131], v[32:35], v[24:27], v[128:131]
    ds_read_b64_tr_b16 v[94:95], v14 offset:8704
    v_mfma_f32_16x16x32_bf16 v[132:135], v[36:39], v[24:27], v[132:135]
    ds_read_b128 v[60:63], v11 offset:2048
    v_mfma_f32_16x16x32_bf16 v[136:139], v[40:43], v[24:27], v[136:139]
    buffer_load_dwordx4 v6, s[4:7], s17 offen offset:3072 lds
    s_add_u32 s17, s17, 196608
    ds_read_b128 v[64:67], v12 offset:0
    v_mfma_f32_16x16x32_bf16 v[140:143], v[44:47], v[24:27], v[140:143]
    ds_read_b128 v[68:71], v12 offset:2048
    s_mov_b32 s21, s22
    s_add_u32 s22, s22, 12288
    s_cmp_eq_u32 s22, 61440
    s_cselect_b32 s22, 0, s22
    s_add_u32 s26, s26, 1
    s_cmp_eq_u32 s26, 3
    s_cselect_b32 s26, 0, s26
    s_cselect_b32 s55, s54, 32768
    v_mfma_f32_16x16x32_bf16 v[176:179], v[24:27], v[48:51], v[176:179]
    v_add_u32 v13, s22, v9
    v_add_u32 v14, s22, v10
    v_mfma_f32_16x16x32_bf16 v[184:187], v[24:27], v[52:55], v[184:187]
    v_add_u32 v7, s55, v7
    v_add_u32 v8, s55, v8
    v_mfma_f32_16x16x32_bf16 v[188:191], v[28:31], v[52:55], v[188:191]
    v_mfma_f32_16x16x32_bf16 v[180:183], v[28:31], v[48:51], v[180:183]
    v_mfma_f32_16x16x32_bf16 v[156:159], v[44:47], v[28:31], v[156:159]
    v_mfma_f32_16x16x32_bf16 v[152:155], v[40:43], v[28:31], v[152:155]
    v_mfma_f32_16x16x32_bf16 v[148:151], v[36:39], v[28:31], v[148:151]
    v_mfma_f32_16x16x32_bf16 v[144:147], v[32:35], v[28:31], v[144:147]
    s_waitcnt vmcnt(12) lgkmcnt(0)
    s_barrier
    v_mfma_f32_16x16x32_bf16 v[96:99], v[72:75], v[56:59], v[96:99]
    ds_read_b128 v[16:19], v7 offset:0
    v_mfma_f32_16x16x32_bf16 v[100:103], v[76:79], v[56:59], v[100:103]
    s_add_u32 m0, s19, s21
    s_nop 0
    buffer_load_dwordx4 v3, s[4:7], s17 offen offset:0 lds
    ds_read_b64_tr_b16 v[32:33], v13 offset:0
    v_mfma_f32_16x16x32_bf16 v[104:107], v[80:83], v[56:59], v[104:107]
    ds_read_b64_tr_b16 v[34:35], v13 offset:512
    v_mfma_f32_16x16x32_bf16 v[108:111], v[84:87], v[56:59], v[108:111]
    ds_read_b64_tr_b16 v[36:37], v14 offset:0
    v_mfma_f32_16x16x32_bf16 v[160:163], v[56:59], v[88:91], v[160:163]
    ds_read_b64_tr_b16 v[38:39], v14 offset:512
    v_mfma_f32_16x16x32_bf16 v[168:171], v[56:59], v[92:95], v[168:171]
    buffer_load_dwordx4 v4, s[4:7], s17 offen offset:1024 lds
    ds_read_b64_tr_b16 v[40:41], v13 offset:4096
    v_mfma_f32_16x16x32_bf16 v[172:175], v[60:63], v[92:95], v[172:175]
    ds_read_b64_tr_b16 v[42:43], v13 offset:4608
    v_mfma_f32_16x16x32_bf16 v[164:167], v[60:63], v[88:91], v[164:167]
    ds_read_b64_tr_b16 v[44:45], v14 offset:4096
    v_mfma_f32_16x16x32_bf16 v[124:127], v[84:87], v[60:63], v[124:127]
    ds_read_b64_tr_b16 v[46:47], v14 offset:4608
    v_mfma_f32_16x16x32_bf16 v[120:123], v[80:83], v[60:63], v[120:123]
    ds_read_b64_tr_b16 v[48:49], v13 offset:8192
    v_mfma_f32_16x16x32_bf16 v[116:119], v[76:79], v[60:63], v[116:119]
    buffer_load_dwordx4 v5, s[4:7], s17 offen offset:2048 lds
    ds_read_b64_tr_b16 v[50:51], v13 offset:8704
    v_mfma_f32_16x16x32_bf16 v[112:115], v[72:75], v[60:63], v[112:115]
    ds_read_b64_tr_b16 v[52:53], v14 offset:8192
    v_mfma_f32_16x16x32_bf16 v[128:131], v[72:75], v[64:67], v[128:131]
    ds_read_b64_tr_b16 v[54:55], v14 offset:8704
    v_mfma_f32_16x16x32_bf16 v[132:135], v[76:79], v[64:67], v[132:135]
    ds_read_b128 v[20:23], v7 offset:2048
    v_mfma_f32_16x16x32_bf16 v[136:139], v[80:83], v[64:67], v[136:139]
    buffer_load_dwordx4 v6, s[4:7], s17 offen offset:3072 lds
    s_add_u32 s17, s17, 196608
    ds_read_b128 v[24:27], v8 offset:0
    v_mfma_f32_16x16x32_bf16 v[140:143], v[84:87], v[64:67], v[140:143]
    ds_read_b128 v[28:31], v8 offset:2048
    s_mov_b32 s21, s22
    s_add_u32 s22, s22, 12288
    s_cmp_eq_u32 s22, 61440
    s_cselect_b32 s22, 0, s22
    v_mfma_f32_16x16x32_bf16 v[176:179], v[64:67], v[88:91], v[176:179]
    v_add_u32 v13, s22, v9
    v_add_u32 v14, s22, v10
    v_mfma_f32_16x16x32_bf16 v[184:187], v[64:67], v[92:95], v[184:187]
    v_add_u32 v11, s55, v11
    v_add_u32 v12, s55, v12
    v_mfma_f32_16x16x32_bf16 v[188:191], v[68:71], v[92:95], v[188:191]
    v_mfma_f32_16x16x32_bf16 v[180:183], v[68:71], v[88:91], v[180:183]
    v_mfma_f32_16x16x32_bf16 v[156:159], v[84:87], v[68:71], v[156:159]
    v_mfma_f32_16x16x32_bf16 v[152:155], v[80:83], v[68:71], v[152:155]
    v_mfma_f32_16x16x32_bf16 v[148:151], v[76:79], v[68:71], v[148:151]
    v_mfma_f32_16x16x32_bf16 v[144:147], v[72:75], v[68:71], v[144:147]
    s_sub_u32 s23, s23, 1
    s_cmp_lg_u32 s23, 0
    s_cbranch_scc1 L_parallel_sum__sliding_block__mixer_token_mlp__prompt_kernel_q1
    s_waitcnt vmcnt(0) lgkmcnt(0)
    s_branch L_parallel_sum__sliding_block__mixer_token_mlp__prompt_kernel_qepi
L_parallel_sum__sliding_block__mixer_token_mlp__prompt_kernel_c2:
    s_waitcnt lgkmcnt(0)
    v_lshrrev_b32 v16, 4, v1
    v_and_b32 v17, 15, v1
    v_lshlrev_b32 v17, 4, v17
    v_lshl_add_u32 v17, v16, 9, v17
    s_lshl_b32 s27, s24, 11
    v_add_u32 v7, s27, v17
    s_sub_u32 s27, 14336, s27
    v_add_u32 v8, s27, v17
    v_bfe_u32 v18, v1, 2, 2
    v_lshlrev_b32 v17, 10, v16
    v_lshl_add_u32 v17, v18, 7, v17
    v_and_b32 v19, 3, v1
    v_lshl_add_u32 v17, v19, 3, v17
    v_add_u32 v17, 16384, v17
    v_lshrrev_b32 v18, 1, v18
    v_and_b32 v16, 1, v16
    v_lshl_add_u32 v16, v16, 1, v18
    s_lshl_b32 s27, s25, 1
    s_add_u32 s3, s27, 0
    v_xor_b32 v18, s3, v16
    v_lshl_add_u32 v9, v18, 5, v17
    s_add_u32 s3, s27, 1
    v_xor_b32 v18, s3, v16
    v_lshl_add_u32 v10, v18, 5, v17
    v_add_u32 v9, 81920, v9
    v_add_u32 v10, 81920, v10
    v_bfe_u32 v16, v1, 1, 3
    v_lshrrev_b32 v17, 4, v1
    v_xor_b32 v17, v17, v16
    v_and_b32 v16, 15, v1
    v_lshlrev_b32 v16, 7, v16
    v_lshl_add_u32 v16, v17, 4, v16
    v_xor_b32 v17, 64, v16
    s_lshl_b32 s27, s24, 12
    v_add_u32 v7, s27, v16
    v_add_u32 v11, s27, v17
    s_sub_u32 s27, 28672, s27
    v_add_u32 v8, s27, v16
    v_add_u32 v12, s27, v17
    s_mov_b32 s26, 0
    s_mov_b32 s54, 4294901760
    s_mov_b32 s55, 0
    v_mov_b32 v96, 0
    v_mov_b32 v97, 0
    v_mov_b32 v98, 0
    v_mov_b32 v99, 0
    v_mov_b32 v100, 0
    v_mov_b32 v101, 0
    v_mov_b32 v102, 0
    v_mov_b32 v103, 0
    v_mov_b32 v104, 0
    v_mov_b32 v105, 0
    v_mov_b32 v106, 0
    v_mov_b32 v107, 0
    v_mov_b32 v108, 0
    v_mov_b32 v109, 0
    v_mov_b32 v110, 0
    v_mov_b32 v111, 0
    v_mov_b32 v112, 0
    v_mov_b32 v113, 0
    v_mov_b32 v114, 0
    v_mov_b32 v115, 0
    v_mov_b32 v116, 0
    v_mov_b32 v117, 0
    v_mov_b32 v118, 0
    v_mov_b32 v119, 0
    v_mov_b32 v120, 0
    v_mov_b32 v121, 0
    v_mov_b32 v122, 0
    v_mov_b32 v123, 0
    v_mov_b32 v124, 0
    v_mov_b32 v125, 0
    v_mov_b32 v126, 0
    v_mov_b32 v127, 0
    v_mov_b32 v128, 0
    v_mov_b32 v129, 0
    v_mov_b32 v130, 0
    v_mov_b32 v131, 0
    v_mov_b32 v132, 0
    v_mov_b32 v133, 0
    v_mov_b32 v134, 0
    v_mov_b32 v135, 0
    v_mov_b32 v136, 0
    v_mov_b32 v137, 0
    v_mov_b32 v138, 0
    v_mov_b32 v139, 0
    v_mov_b32 v140, 0
    v_mov_b32 v141, 0
    v_mov_b32 v142, 0
    v_mov_b32 v143, 0
    v_mov_b32 v144, 0
    v_mov_b32 v145, 0
    v_mov_b32 v146, 0
    v_mov_b32 v147, 0
    v_mov_b32 v148, 0
    v_mov_b32 v149, 0
    v_mov_b32 v150, 0
    v_mov_b32 v151, 0
    v_mov_b32 v152, 0
    v_mov_b32 v153, 0
    v_mov_b32 v154, 0
    v_mov_b32 v155, 0
    v_mov_b32 v156, 0
    v_mov_b32 v157, 0
    v_mov_b32 v158, 0
    v_mov_b32 v159, 0
    v_mov_b32 v160, 0
    v_mov_b32 v161, 0
    v_mov_b32 v162, 0
    v_mov_b32 v163, 0
    v_mov_b32 v164, 0
    v_mov_b32 v165, 0
    v_mov_b32 v166, 0
    v_mov_b32 v167, 0
    v_mov_b32 v168, 0
    v_mov_b32 v169, 0
    v_mov_b32 v170, 0
    v_mov_b32 v171, 0
    v_mov_b32 v172, 0
    v_mov_b32 v173, 0
    v_mov_b32 v174, 0
    v_mov_b32 v175, 0
    v_mov_b32 v176, 0
    v_mov_b32 v177, 0
    v_mov_b32 v178, 0
    v_mov_b32 v179, 0
    v_mov_b32 v180, 0
    v_mov_b32 v181, 0
    v_mov_b32 v182, 0
    v_mov_b32 v183, 0
    v_mov_b32 v184, 0
    v_mov_b32 v185, 0
    v_mov_b32 v186, 0
    v_mov_b32 v187, 0
    v_mov_b32 v188, 0
    v_mov_b32 v189, 0
    v_mov_b32 v190, 0
    v_mov_b32 v191, 0
    v_and_b32 v255, 31, v1
    v_lshrrev_b32 v248, 5, v1
    v_lshlrev_b32 v248, 2, v248
    v_sub_u32 v255, v255, v248
    v_mov_b32 v254, 0xf149f2ca
    v_cmp_le_i32 vcc, 0, v255
    v_mov_b32 v192, 0
    v_mov_b32 v193, 0
    v_cndmask_b32_e64 v224, v254, 0, vcc
    v_cmp_le_i32 vcc, 1, v255
    v_mov_b32 v194, 0
    v_mov_b32 v195, 0
    v_cndmask_b32_e64 v225, v254, 0, vcc
    v_cmp_le_i32 vcc, 2, v255
    v_mov_b32 v196, 0
    v_mov_b32 v197, 0
    v_cndmask_b32_e64 v226, v254, 0, vcc
    v_cmp_le_i32 vcc, 3, v255
    v_mov_b32 v198, 0
    v_mov_b32 v199, 0
    v_cndmask_b32_e64 v227, v254, 0, vcc
    v_cmp_le_i32 vcc, 16, v255
    v_mov_b32 v200, 0
    v_mov_b32 v201, 0
    v_cndmask_b32_e64 v228, v254, 0, vcc
    v_cmp_le_i32 vcc, 17, v255
    v_mov_b32 v202, 0
    v_mov_b32 v203, 0
    v_cndmask_b32_e64 v229, v254, 0, vcc
    v_cmp_le_i32 vcc, 18, v255
    v_mov_b32 v204, 0
    v_mov_b32 v205, 0
    v_cndmask_b32_e64 v230, v254, 0, vcc
    v_cmp_le_i32 vcc, 19, v255
    v_mov_b32 v206, 0
    v_mov_b32 v207, 0
    v_cndmask_b32_e64 v231, v254, 0, vcc
    v_cmp_le_i32 vcc, 8, v255
    v_mov_b32 v208, 0
    v_mov_b32 v209, 0
    v_cndmask_b32_e64 v232, v254, 0, vcc
    v_cmp_le_i32 vcc, 9, v255
    v_mov_b32 v210, 0
    v_mov_b32 v211, 0
    v_cndmask_b32_e64 v233, v254, 0, vcc
    v_cmp_le_i32 vcc, 10, v255
    v_mov_b32 v212, 0
    v_mov_b32 v213, 0
    v_cndmask_b32_e64 v234, v254, 0, vcc
    v_cmp_le_i32 vcc, 11, v255
    v_mov_b32 v214, 0
    v_mov_b32 v215, 0
    v_cndmask_b32_e64 v235, v254, 0, vcc
    v_cmp_le_i32 vcc, 24, v255
    v_mov_b32 v216, 0
    v_mov_b32 v217, 0
    v_cndmask_b32_e64 v236, v254, 0, vcc
    v_cmp_le_i32 vcc, 25, v255
    v_mov_b32 v218, 0
    v_mov_b32 v219, 0
    v_cndmask_b32_e64 v237, v254, 0, vcc
    v_cmp_le_i32 vcc, 26, v255
    v_mov_b32 v220, 0
    v_mov_b32 v221, 0
    v_cndmask_b32_e64 v238, v254, 0, vcc
    v_cmp_le_i32 vcc, 27, v255
    v_mov_b32 v222, 0
    v_mov_b32 v223, 0
    v_cndmask_b32_e64 v239, v254, 0, vcc
    v_mov_b32 v240, 0
    v_mov_b32 v242, 0
    v_mov_b32 v241, 0
    v_mov_b32 v243, 0
    v_mov_b32 v244, 0x3f803f80
    v_mov_b32 v245, 0x3f803f80
    v_mov_b32 v246, 0x3f803f80
    v_mov_b32 v247, 0x3f803f80
    s_mov_b32 s22, 0
    v_mov_b32 v13, v9
    v_mov_b32 v14, v10
    s_waitcnt vmcnt(63)
    s_barrier
    ds_read_b128 v[16:19], v7 offset:0
    ds_read_b64_tr_b16 v[32:33], v13 offset:0
    ds_read_b64_tr_b16 v[34:35], v13 offset:512
    ds_read_b64_tr_b16 v[36:37], v14 offset:0
    ds_read_b64_tr_b16 v[38:39], v14 offset:512
    ds_read_b64_tr_b16 v[40:41], v13 offset:4096
    ds_read_b64_tr_b16 v[42:43], v13 offset:4608
    ds_read_b64_tr_b16 v[44:45], v14 offset:4096
    ds_read_b64_tr_b16 v[46:47], v14 offset:4608
    ds_read_b64_tr_b16 v[48:49], v13 offset:8192
    ds_read_b64_tr_b16 v[50:51], v13 offset:8704
    ds_read_b64_tr_b16 v[52:53], v14 offset:8192
    ds_read_b64_tr_b16 v[54:55], v14 offset:8704
    ds_read_b128 v[20:23], v7 offset:2048
    ds_read_b128 v[24:27], v8 offset:0
    ds_read_b128 v[28:31], v8 offset:2048
    s_mov_b32 s21, s22
    s_add_u32 s22, s22, 12288
    s_cmp_eq_u32 s22, 61440
    s_cselect_b32 s22, 0, s22
    v_add_u32 v13, s22, v9
    v_add_u32 v14, s22, v10
    v_add_u32 v11, s55, v11
    v_add_u32 v12, s55, v12
    s_mov_b32 s4, s30
    s_and_b32 s5, s31, 0xffff
    s_mov_b32 s6, 6291456
    s_mov_b32 s7, 0x20000
    s_mov_b32 s8, s32
    s_and_b32 s9, s33, 0xffff
    s_mov_b32 s10, 14680064
    s_mov_b32 s11, 0x20000
    v_lshlrev_b32 v3, 7, v1
    s_lshl_b32 s17, s69, 13
    s_add_u32 s20, s17, 8802304
    s_add_u32 s17, s17, 1253376
    s_mov_b32 s18, 6
L_parallel_sum__sliding_block__mixer_token_mlp__prompt_kernel_q2o:
    s_waitcnt vmcnt(63) lgkmcnt(0)
    s_barrier
    v_mfma_f32_16x16x32_bf16 v[96:99], v[32:35], v[16:19], v[96:99]
    ds_read_b128 v[56:59], v11 offset:0
    v_mfma_f32_16x16x32_bf16 v[100:103], v[36:39], v[16:19], v[100:103]
    ds_read_b64_tr_b16 v[72:73], v13 offset:0
    v_mfma_f32_16x16x32_bf16 v[104:107], v[40:43], v[16:19], v[104:107]
    ds_read_b64_tr_b16 v[74:75], v13 offset:512
    v_mfma_f32_16x16x32_bf16 v[108:111], v[44:47], v[16:19], v[108:111]
    ds_read_b64_tr_b16 v[76:77], v14 offset:0
    v_mfma_f32_16x16x32_bf16 v[160:163], v[16:19], v[48:51], v[160:163]
    ds_read_b64_tr_b16 v[78:79], v14 offset:512
    v_mfma_f32_16x16x32_bf16 v[168:171], v[16:19], v[52:55], v[168:171]
    ds_read_b64_tr_b16 v[80:81], v13 offset:4096
    v_mfma_f32_16x16x32_bf16 v[172:175], v[20:23], v[52:55], v[172:175]
    ds_read_b64_tr_b16 v[82:83], v13 offset:4608
    v_mfma_f32_16x16x32_bf16 v[164:167], v[20:23], v[48:51], v[164:167]
    ds_read_b64_tr_b16 v[84:85], v14 offset:4096
    v_mfma_f32_16x16x32_bf16 v[124:127], v[44:47], v[20:23], v[124:127]
    ds_read_b64_tr_b16 v[86:87], v14 offset:4608
    v_mfma_f32_16x16x32_bf16 v[120:123], v[40:43], v[20:23], v[120:123]
    ds_read_b64_tr_b16 v[88:89], v13 offset:8192
    v_mfma_f32_16x16x32_bf16 v[116:119], v[36:39], v[20:23], v[116:119]
    ds_read_b64_tr_b16 v[90:91], v13 offset:8704
    v_mfma_f32_16x16x32_bf16 v[112:115], v[32:35], v[20:23], v[112:115]
    ds_read_b64_tr_b16 v[92:93], v14 offset:8192
    v_mfma_f32_16x16x32_bf16 v[128:131], v[32:35], v[24:27], v[128:131]
    ds_read_b64_tr_b16 v[94:95], v14 offset:8704
    v_mfma_f32_16x16x32_bf16 v[132:135], v[36:39], v[24:27], v[132:135]
    ds_read_b128 v[60:63], v11 offset:2048
    v_mfma_f32_16x16x32_bf16 v[136:139], v[40:43], v[24:27], v[136:139]
    ds_read_b128 v[64:67], v12 offset:0
    v_mfma_f32_16x16x32_bf16 v[140:143], v[44:47], v[24:27], v[140:143]
    ds_read_b128 v[68:71], v12 offset:2048
    s_mov_b32 s21, s22
    s_add_u32 s22, s22, 12288
    s_cmp_eq_u32 s22, 61440
    s_cselect_b32 s22, 0, s22
    s_add_u32 s26, s26, 1
    s_cmp_eq_u32 s26, 3
    s_cselect_b32 s26, 0, s26
    s_cselect_b32 s55, s54, 32768
    v_mfma_f32_16x16x32_bf16 v[176:179], v[24:27], v[48:51], v[176:179]
    v_add_u32 v13, s22, v9
    v_add_u32 v14, s22, v10
    v_mfma_f32_16x16x32_bf16 v[184:187], v[24:27], v[52:55], v[184:187]
    v_add_u32 v7, s55, v7
    v_add_u32 v8, s55, v8
    v_mfma_f32_16x16x32_bf16 v[188:191], v[28:31], v[52:55], v[188:191]
    v_mfma_f32_16x16x32_bf16 v[180:183], v[28:31], v[48:51], v[180:183]
    v_mfma_f32_16x16x32_bf16 v[156:159], v[44:47], v[28:31], v[156:159]
    v_mfma_f32_16x16x32_bf16 v[152:155], v[40:43], v[28:31], v[152:155]
    v_mfma_f32_16x16x32_bf16 v[148:151], v[36:39], v[28:31], v[148:151]
    v_mfma_f32_16x16x32_bf16 v[144:147], v[32:35], v[28:31], v[144:147]
    s_waitcnt vmcnt(63) lgkmcnt(0)
    s_barrier
    v_mfma_f32_16x16x32_bf16 v[96:99], v[72:75], v[56:59], v[96:99]
    ds_read_b128 v[16:19], v7 offset:0
    v_mfma_f32_16x16x32_bf16 v[100:103], v[76:79], v[56:59], v[100:103]
    ds_read_b64_tr_b16 v[32:33], v13 offset:0
    v_mfma_f32_16x16x32_bf16 v[104:107], v[80:83], v[56:59], v[104:107]
    ds_read_b64_tr_b16 v[34:35], v13 offset:512
    v_mfma_f32_16x16x32_bf16 v[108:111], v[84:87], v[56:59], v[108:111]
    ds_read_b64_tr_b16 v[36:37], v14 offset:0
    v_mfma_f32_16x16x32_bf16 v[160:163], v[56:59], v[88:91], v[160:163]
    ds_read_b64_tr_b16 v[38:39], v14 offset:512
    v_mfma_f32_16x16x32_bf16 v[168:171], v[56:59], v[92:95], v[168:171]
    ds_read_b64_tr_b16 v[40:41], v13 offset:4096
    v_mfma_f32_16x16x32_bf16 v[172:175], v[60:63], v[92:95], v[172:175]
    ds_read_b64_tr_b16 v[42:43], v13 offset:4608
    v_mfma_f32_16x16x32_bf16 v[164:167], v[60:63], v[88:91], v[164:167]
    ds_read_b64_tr_b16 v[44:45], v14 offset:4096
    v_mfma_f32_16x16x32_bf16 v[124:127], v[84:87], v[60:63], v[124:127]
    ds_read_b64_tr_b16 v[46:47], v14 offset:4608
    v_mfma_f32_16x16x32_bf16 v[120:123], v[80:83], v[60:63], v[120:123]
    ds_read_b64_tr_b16 v[48:49], v13 offset:8192
    v_mfma_f32_16x16x32_bf16 v[116:119], v[76:79], v[60:63], v[116:119]
    ds_read_b64_tr_b16 v[50:51], v13 offset:8704
    v_mfma_f32_16x16x32_bf16 v[112:115], v[72:75], v[60:63], v[112:115]
    ds_read_b64_tr_b16 v[52:53], v14 offset:8192
    v_mfma_f32_16x16x32_bf16 v[128:131], v[72:75], v[64:67], v[128:131]
    ds_read_b64_tr_b16 v[54:55], v14 offset:8704
    v_mfma_f32_16x16x32_bf16 v[132:135], v[76:79], v[64:67], v[132:135]
    ds_read_b128 v[20:23], v7 offset:2048
    v_mfma_f32_16x16x32_bf16 v[136:139], v[80:83], v[64:67], v[136:139]
    ds_read_b128 v[24:27], v8 offset:0
    v_mfma_f32_16x16x32_bf16 v[140:143], v[84:87], v[64:67], v[140:143]
    ds_read_b128 v[28:31], v8 offset:2048
    s_mov_b32 s21, s22
    s_add_u32 s22, s22, 12288
    s_cmp_eq_u32 s22, 61440
    s_cselect_b32 s22, 0, s22
    v_mfma_f32_16x16x32_bf16 v[176:179], v[64:67], v[88:91], v[176:179]
    v_add_u32 v13, s22, v9
    v_add_u32 v14, s22, v10
    v_mfma_f32_16x16x32_bf16 v[184:187], v[64:67], v[92:95], v[184:187]
    v_add_u32 v11, s55, v11
    v_add_u32 v12, s55, v12
    v_mfma_f32_16x16x32_bf16 v[188:191], v[68:71], v[92:95], v[188:191]
    v_mfma_f32_16x16x32_bf16 v[180:183], v[68:71], v[88:91], v[180:183]
    v_mfma_f32_16x16x32_bf16 v[156:159], v[84:87], v[68:71], v[156:159]
    v_mfma_f32_16x16x32_bf16 v[152:155], v[80:83], v[68:71], v[152:155]
    v_mfma_f32_16x16x32_bf16 v[148:151], v[76:79], v[68:71], v[148:151]
    v_mfma_f32_16x16x32_bf16 v[144:147], v[72:75], v[68:71], v[144:147]
    buffer_load_dword v4, v3, s[8:11], s20 offen
    s_add_u32 s20, s20, 1048576
    s_waitcnt vmcnt(63) lgkmcnt(0)
    s_barrier
    v_mfma_f32_16x16x32_bf16 v[96:99], v[32:35], v[16:19], v[96:99]
    ds_read_b128 v[56:59], v11 offset:0
    v_mfma_f32_16x16x32_bf16 v[100:103], v[36:39], v[16:19], v[100:103]
    ds_read_b64_tr_b16 v[72:73], v13 offset:0
    v_mfma_f32_16x16x32_bf16 v[104:107], v[40:43], v[16:19], v[104:107]
    ds_read_b64_tr_b16 v[74:75], v13 offset:512
    v_mfma_f32_16x16x32_bf16 v[108:111], v[44:47], v[16:19], v[108:111]
    ds_read_b64_tr_b16 v[76:77], v14 offset:0
    v_mfma_f32_16x16x32_bf16 v[160:163], v[16:19], v[48:51], v[160:163]
    ds_read_b64_tr_b16 v[78:79], v14 offset:512
    v_mfma_f32_16x16x32_bf16 v[168:171], v[16:19], v[52:55], v[168:171]
    ds_read_b64_tr_b16 v[80:81], v13 offset:4096
    v_mfma_f32_16x16x32_bf16 v[172:175], v[20:23], v[52:55], v[172:175]
    ds_read_b64_tr_b16 v[82:83], v13 offset:4608
    v_mfma_f32_16x16x32_bf16 v[164:167], v[20:23], v[48:51], v[164:167]
    ds_read_b64_tr_b16 v[84:85], v14 offset:4096
    v_mfma_f32_16x16x32_bf16 v[124:127], v[44:47], v[20:23], v[124:127]
    ds_read_b64_tr_b16 v[86:87], v14 offset:4608
    v_mfma_f32_16x16x32_bf16 v[120:123], v[40:43], v[20:23], v[120:123]
    ds_read_b64_tr_b16 v[88:89], v13 offset:8192
    v_mfma_f32_16x16x32_bf16 v[116:119], v[36:39], v[20:23], v[116:119]
    ds_read_b64_tr_b16 v[90:91], v13 offset:8704
    v_mfma_f32_16x16x32_bf16 v[112:115], v[32:35], v[20:23], v[112:115]
    ds_read_b64_tr_b16 v[92:93], v14 offset:8192
    v_mfma_f32_16x16x32_bf16 v[128:131], v[32:35], v[24:27], v[128:131]
    ds_read_b64_tr_b16 v[94:95], v14 offset:8704
    v_mfma_f32_16x16x32_bf16 v[132:135], v[36:39], v[24:27], v[132:135]
    ds_read_b128 v[60:63], v11 offset:2048
    v_mfma_f32_16x16x32_bf16 v[136:139], v[40:43], v[24:27], v[136:139]
    ds_read_b128 v[64:67], v12 offset:0
    v_mfma_f32_16x16x32_bf16 v[140:143], v[44:47], v[24:27], v[140:143]
    ds_read_b128 v[68:71], v12 offset:2048
    s_mov_b32 s21, s22
    s_add_u32 s22, s22, 12288
    s_cmp_eq_u32 s22, 61440
    s_cselect_b32 s22, 0, s22
    s_add_u32 s26, s26, 1
    s_cmp_eq_u32 s26, 3
    s_cselect_b32 s26, 0, s26
    s_cselect_b32 s55, s54, 32768
    v_mfma_f32_16x16x32_bf16 v[176:179], v[24:27], v[48:51], v[176:179]
    v_add_u32 v13, s22, v9
    v_add_u32 v14, s22, v10
    v_mfma_f32_16x16x32_bf16 v[184:187], v[24:27], v[52:55], v[184:187]
    v_add_u32 v7, s55, v7
    v_add_u32 v8, s55, v8
    v_mfma_f32_16x16x32_bf16 v[188:191], v[28:31], v[52:55], v[188:191]
    v_mfma_f32_16x16x32_bf16 v[180:183], v[28:31], v[48:51], v[180:183]
    v_mfma_f32_16x16x32_bf16 v[156:159], v[44:47], v[28:31], v[156:159]
    v_mfma_f32_16x16x32_bf16 v[152:155], v[40:43], v[28:31], v[152:155]
    v_mfma_f32_16x16x32_bf16 v[148:151], v[36:39], v[28:31], v[148:151]
    v_mfma_f32_16x16x32_bf16 v[144:147], v[32:35], v[28:31], v[144:147]
    s_waitcnt vmcnt(63) lgkmcnt(0)
    s_barrier
    v_mfma_f32_16x16x32_bf16 v[96:99], v[72:75], v[56:59], v[96:99]
    ds_read_b128 v[16:19], v7 offset:0
    v_mfma_f32_16x16x32_bf16 v[100:103], v[76:79], v[56:59], v[100:103]
    ds_read_b64_tr_b16 v[32:33], v13 offset:0
    v_mfma_f32_16x16x32_bf16 v[104:107], v[80:83], v[56:59], v[104:107]
    ds_read_b64_tr_b16 v[34:35], v13 offset:512
    v_mfma_f32_16x16x32_bf16 v[108:111], v[84:87], v[56:59], v[108:111]
    ds_read_b64_tr_b16 v[36:37], v14 offset:0
    v_mfma_f32_16x16x32_bf16 v[160:163], v[56:59], v[88:91], v[160:163]
    ds_read_b64_tr_b16 v[38:39], v14 offset:512
    v_mfma_f32_16x16x32_bf16 v[168:171], v[56:59], v[92:95], v[168:171]
    ds_read_b64_tr_b16 v[40:41], v13 offset:4096
    v_mfma_f32_16x16x32_bf16 v[172:175], v[60:63], v[92:95], v[172:175]
    ds_read_b64_tr_b16 v[42:43], v13 offset:4608
    v_mfma_f32_16x16x32_bf16 v[164:167], v[60:63], v[88:91], v[164:167]
    ds_read_b64_tr_b16 v[44:45], v14 offset:4096
    v_mfma_f32_16x16x32_bf16 v[124:127], v[84:87], v[60:63], v[124:127]
    ds_read_b64_tr_b16 v[46:47], v14 offset:4608
    v_mfma_f32_16x16x32_bf16 v[120:123], v[80:83], v[60:63], v[120:123]
    ds_read_b64_tr_b16 v[48:49], v13 offset:8192
    v_mfma_f32_16x16x32_bf16 v[116:119], v[76:79], v[60:63], v[116:119]
    ds_read_b64_tr_b16 v[50:51], v13 offset:8704
    v_mfma_f32_16x16x32_bf16 v[112:115], v[72:75], v[60:63], v[112:115]
    ds_read_b64_tr_b16 v[52:53], v14 offset:8192
    v_mfma_f32_16x16x32_bf16 v[128:131], v[72:75], v[64:67], v[128:131]
    ds_read_b64_tr_b16 v[54:55], v14 offset:8704
    v_mfma_f32_16x16x32_bf16 v[132:135], v[76:79], v[64:67], v[132:135]
    ds_read_b128 v[20:23], v7 offset:2048
    v_mfma_f32_16x16x32_bf16 v[136:139], v[80:83], v[64:67], v[136:139]
    ds_read_b128 v[24:27], v8 offset:0
    v_mfma_f32_16x16x32_bf16 v[140:143], v[84:87], v[64:67], v[140:143]
    ds_read_b128 v[28:31], v8 offset:2048
    s_mov_b32 s21, s22
    s_add_u32 s22, s22, 12288
    s_cmp_eq_u32 s22, 61440
    s_cselect_b32 s22, 0, s22
    v_mfma_f32_16x16x32_bf16 v[176:179], v[64:67], v[88:91], v[176:179]
    v_add_u32 v13, s22, v9
    v_add_u32 v14, s22, v10
    v_mfma_f32_16x16x32_bf16 v[184:187], v[64:67], v[92:95], v[184:187]
    v_add_u32 v11, s55, v11
    v_add_u32 v12, s55, v12
    v_mfma_f32_16x16x32_bf16 v[188:191], v[68:71], v[92:95], v[188:191]
    v_mfma_f32_16x16x32_bf16 v[180:183], v[68:71], v[88:91], v[180:183]
    v_mfma_f32_16x16x32_bf16 v[156:159], v[84:87], v[68:71], v[156:159]
    v_mfma_f32_16x16x32_bf16 v[152:155], v[80:83], v[68:71], v[152:155]
    v_mfma_f32_16x16x32_bf16 v[148:151], v[76:79], v[68:71], v[148:151]
    v_mfma_f32_16x16x32_bf16 v[144:147], v[72:75], v[68:71], v[144:147]
    s_sub_u32 s18, s18, 1
    s_cmp_lg_u32 s18, 0
    s_cbranch_scc1 L_parallel_sum__sliding_block__mixer_token_mlp__prompt_kernel_q2o
    s_mov_b32 s4, s74
    s_and_b32 s5, s75, 0xffff
    s_mov_b32 s6, 256
    s_mov_b32 s7, 0x20000
    v_mov_b32 v3, 0
    s_mov_b32 s18, 0x40000
L_parallel_sum__sliding_block__mixer_token_mlp__prompt_kernel_pst:
    buffer_load_dword v4, v3, s[4:7], 0 offen offset:132 sc1
    s_waitcnt vmcnt(0)
    v_readfirstlane_b32 s40, v4
    s_nop 0
    s_cmp_ge_u32 s40, 128
    s_cbranch_scc1 L_parallel_sum__sliding_block__mixer_token_mlp__prompt_kernel_pst_ok
    s_sleep 8
    s_sub_u32 s18, s18, 1
    s_cmp_lg_u32 s18, 0
    s_cbranch_scc1 L_parallel_sum__sliding_block__mixer_token_mlp__prompt_kernel_pst
L_parallel_sum__sliding_block__mixer_token_mlp__prompt_kernel_pst_ok:
    s_add_u32 s4, s28, 51380224
    s_addc_u32 s5, s29, 0
    s_and_b32 s5, s5, 0xffff
    s_mov_b32 s6, 147456
    s_mov_b32 s7, 0x20000
    s_lshl_b32 s40, s38, 10
    s_add_u32 s41, s40, 8192
    s_lshl_b32 s42, s39, 10
    s_add_u32 s42, s42, 16384
    s_mov_b32 m0, 159808
    s_nop 0
    buffer_load_dwordx4 v2, s[4:7], s40 offen sc1 lds
    s_mov_b32 m0, 160832
    s_nop 0
    buffer_load_dwordx4 v2, s[4:7], s41 offen sc1 lds
    buffer_load_dwordx4 v[192:195], v2, s[4:7], s42 offen sc1
    s_add_u32 s42, s42, 16384
    buffer_load_dwordx4 v[196:199], v2, s[4:7], s42 offen sc1
    s_add_u32 s42, s42, 16384
    buffer_load_dwordx4 v[200:203], v2, s[4:7], s42 offen sc1
    s_add_u32 s42, s42, 16384
    buffer_load_dwordx4 v[204:207], v2, s[4:7], s42 offen sc1
    s_add_u32 s42, s42, 16384
    buffer_load_dwordx4 v[208:211], v2, s[4:7], s42 offen sc1
    s_add_u32 s42, s42, 16384
    buffer_load_dwordx4 v[212:215], v2, s[4:7], s42 offen sc1
    s_add_u32 s42, s42, 16384
    buffer_load_dwordx4 v[216:219], v2, s[4:7], s42 offen sc1
    s_add_u32 s42, s42, 16384
    buffer_load_dwordx4 v[220:223], v2, s[4:7], s42 offen sc1
    s_add_u32 s42, s42, 16384
    s_waitcnt vmcnt(63) lgkmcnt(0)
    s_barrier
    v_mfma_f32_16x16x32_bf16 v[96:99], v[32:35], v[16:19], v[96:99]
    ds_read_b128 v[56:59], v11 offset:0
    v_mfma_f32_16x16x32_bf16 v[100:103], v[36:39], v[16:19], v[100:103]
    ds_read_b64_tr_b16 v[72:73], v13 offset:0
    v_mfma_f32_16x16x32_bf16 v[104:107], v[40:43], v[16:19], v[104:107]
    ds_read_b64_tr_b16 v[74:75], v13 offset:512
    v_mfma_f32_16x16x32_bf16 v[108:111], v[44:47], v[16:19], v[108:111]
    ds_read_b64_tr_b16 v[76:77], v14 offset:0
    v_mfma_f32_16x16x32_bf16 v[160:163], v[16:19], v[48:51], v[160:163]
    ds_read_b64_tr_b16 v[78:79], v14 offset:512
    v_mfma_f32_16x16x32_bf16 v[168:171], v[16:19], v[52:55], v[168:171]
    ds_read_b64_tr_b16 v[80:81], v13 offset:4096
    v_mfma_f32_16x16x32_bf16 v[172:175], v[20:23], v[52:55], v[172:175]
    ds_read_b64_tr_b16 v[82:83], v13 offset:4608
    v_mfma_f32_16x16x32_bf16 v[164:167], v[20:23], v[48:51], v[164:167]
    ds_read_b64_tr_b16 v[84:85], v14 offset:4096
    v_mfma_f32_16x16x32_bf16 v[124:127], v[44:47], v[20:23], v[124:127]
    ds_read_b64_tr_b16 v[86:87], v14 offset:4608
    v_mfma_f32_16x16x32_bf16 v[120:123], v[40:43], v[20:23], v[120:123]
    ds_read_b64_tr_b16 v[88:89], v13 offset:8192
    v_mfma_f32_16x16x32_bf16 v[116:119], v[36:39], v[20:23], v[116:119]
    ds_read_b64_tr_b16 v[90:91], v13 offset:8704
    v_mfma_f32_16x16x32_bf16 v[112:115], v[32:35], v[20:23], v[112:115]
    ds_read_b64_tr_b16 v[92:93], v14 offset:8192
    v_mfma_f32_16x16x32_bf16 v[128:131], v[32:35], v[24:27], v[128:131]
    ds_read_b64_tr_b16 v[94:95], v14 offset:8704
    v_mfma_f32_16x16x32_bf16 v[132:135], v[36:39], v[24:27], v[132:135]
    ds_read_b128 v[60:63], v11 offset:2048
    v_mfma_f32_16x16x32_bf16 v[136:139], v[40:43], v[24:27], v[136:139]
    ds_read_b128 v[64:67], v12 offset:0
    v_mfma_f32_16x16x32_bf16 v[140:143], v[44:47], v[24:27], v[140:143]
    ds_read_b128 v[68:71], v12 offset:2048
    s_mov_b32 s21, s22
    s_add_u32 s22, s22, 12288
    s_cmp_eq_u32 s22, 61440
    s_cselect_b32 s22, 0, s22
    s_add_u32 s26, s26, 1
    s_cmp_eq_u32 s26, 3
    s_cselect_b32 s26, 0, s26
    s_cselect_b32 s55, s54, 32768
    v_mfma_f32_16x16x32_bf16 v[176:179], v[24:27], v[48:51], v[176:179]
    v_add_u32 v13, s22, v9
    v_add_u32 v14, s22, v10
    v_mfma_f32_16x16x32_bf16 v[184:187], v[24:27], v[52:55], v[184:187]
    v_add_u32 v7, s55, v7
    v_add_u32 v8, s55, v8
    v_mfma_f32_16x16x32_bf16 v[188:191], v[28:31], v[52:55], v[188:191]
    v_mfma_f32_16x16x32_bf16 v[180:183], v[28:31], v[48:51], v[180:183]
    v_mfma_f32_16x16x32_bf16 v[156:159], v[44:47], v[28:31], v[156:159]
    v_mfma_f32_16x16x32_bf16 v[152:155], v[40:43], v[28:31], v[152:155]
    v_mfma_f32_16x16x32_bf16 v[148:151], v[36:39], v[28:31], v[148:151]
    v_mfma_f32_16x16x32_bf16 v[144:147], v[32:35], v[28:31], v[144:147]
    s_waitcnt vmcnt(63) lgkmcnt(0)
    s_barrier
    v_mfma_f32_16x16x32_bf16 v[96:99], v[72:75], v[56:59], v[96:99]
    ds_read_b128 v[16:19], v7 offset:0
    v_mfma_f32_16x16x32_bf16 v[100:103], v[76:79], v[56:59], v[100:103]
    ds_read_b64_tr_b16 v[32:33], v13 offset:0
    v_mfma_f32_16x16x32_bf16 v[104:107], v[80:83], v[56:59], v[104:107]
    ds_read_b64_tr_b16 v[34:35], v13 offset:512
    v_mfma_f32_16x16x32_bf16 v[108:111], v[84:87], v[56:59], v[108:111]
    ds_read_b64_tr_b16 v[36:37], v14 offset:0
    v_mfma_f32_16x16x32_bf16 v[160:163], v[56:59], v[88:91], v[160:163]
    ds_read_b64_tr_b16 v[38:39], v14 offset:512
    v_mfma_f32_16x16x32_bf16 v[168:171], v[56:59], v[92:95], v[168:171]
    ds_read_b64_tr_b16 v[40:41], v13 offset:4096
    v_mfma_f32_16x16x32_bf16 v[172:175], v[60:63], v[92:95], v[172:175]
    ds_read_b64_tr_b16 v[42:43], v13 offset:4608
    v_mfma_f32_16x16x32_bf16 v[164:167], v[60:63], v[88:91], v[164:167]
    ds_read_b64_tr_b16 v[44:45], v14 offset:4096
    v_mfma_f32_16x16x32_bf16 v[124:127], v[84:87], v[60:63], v[124:127]
    ds_read_b64_tr_b16 v[46:47], v14 offset:4608
    v_mfma_f32_16x16x32_bf16 v[120:123], v[80:83], v[60:63], v[120:123]
    ds_read_b64_tr_b16 v[48:49], v13 offset:8192
    v_mfma_f32_16x16x32_bf16 v[116:119], v[76:79], v[60:63], v[116:119]
    ds_read_b64_tr_b16 v[50:51], v13 offset:8704
    v_mfma_f32_16x16x32_bf16 v[112:115], v[72:75], v[60:63], v[112:115]
    ds_read_b64_tr_b16 v[52:53], v14 offset:8192
    v_mfma_f32_16x16x32_bf16 v[128:131], v[72:75], v[64:67], v[128:131]
    ds_read_b64_tr_b16 v[54:55], v14 offset:8704
    v_mfma_f32_16x16x32_bf16 v[132:135], v[76:79], v[64:67], v[132:135]
    ds_read_b128 v[20:23], v7 offset:2048
    v_mfma_f32_16x16x32_bf16 v[136:139], v[80:83], v[64:67], v[136:139]
    ds_read_b128 v[24:27], v8 offset:0
    v_mfma_f32_16x16x32_bf16 v[140:143], v[84:87], v[64:67], v[140:143]
    ds_read_b128 v[28:31], v8 offset:2048
    s_mov_b32 s21, s22
    s_add_u32 s22, s22, 12288
    s_cmp_eq_u32 s22, 61440
    s_cselect_b32 s22, 0, s22
    v_mfma_f32_16x16x32_bf16 v[176:179], v[64:67], v[88:91], v[176:179]
    v_add_u32 v13, s22, v9
    v_add_u32 v14, s22, v10
    v_mfma_f32_16x16x32_bf16 v[184:187], v[64:67], v[92:95], v[184:187]
    v_add_u32 v11, s55, v11
    v_add_u32 v12, s55, v12
    v_mfma_f32_16x16x32_bf16 v[188:191], v[68:71], v[92:95], v[188:191]
    v_mfma_f32_16x16x32_bf16 v[180:183], v[68:71], v[88:91], v[180:183]
    v_mfma_f32_16x16x32_bf16 v[156:159], v[84:87], v[68:71], v[156:159]
    v_mfma_f32_16x16x32_bf16 v[152:155], v[80:83], v[68:71], v[152:155]
    v_mfma_f32_16x16x32_bf16 v[148:151], v[76:79], v[68:71], v[148:151]
    v_mfma_f32_16x16x32_bf16 v[144:147], v[72:75], v[68:71], v[144:147]
    s_waitcnt vmcnt(0)
    v_add_f32 v192, v192, v196
    v_add_f32 v193, v193, v197
    v_add_f32 v194, v194, v198
    v_add_f32 v195, v195, v199
    v_add_f32 v192, v192, v200
    v_add_f32 v193, v193, v201
    v_add_f32 v194, v194, v202
    v_add_f32 v195, v195, v203
    v_add_f32 v192, v192, v204
    v_add_f32 v193, v193, v205
    v_add_f32 v194, v194, v206
    v_add_f32 v195, v195, v207
    v_add_f32 v192, v192, v208
    v_add_f32 v193, v193, v209
    v_add_f32 v194, v194, v210
    v_add_f32 v195, v195, v211
    v_add_f32 v192, v192, v212
    v_add_f32 v193, v193, v213
    v_add_f32 v194, v194, v214
    v_add_f32 v195, v195, v215
    v_add_f32 v192, v192, v216
    v_add_f32 v193, v193, v217
    v_add_f32 v194, v194, v218
    v_add_f32 v195, v195, v219
    v_add_f32 v192, v192, v220
    v_add_f32 v193, v193, v221
    v_add_f32 v194, v194, v222
    v_add_f32 v195, v195, v223
    v_add_u32 v3, 161856, v2
    ds_write_b128 v3, v[192:195]
    s_waitcnt lgkmcnt(0)
    v_mov_b32 v192, 0
    v_mov_b32 v193, 0
    v_mov_b32 v194, 0
    v_mov_b32 v195, 0
    v_mov_b32 v196, 0
    v_mov_b32 v197, 0
    v_mov_b32 v198, 0
    v_mov_b32 v199, 0
    v_mov_b32 v200, 0
    v_mov_b32 v201, 0
    v_mov_b32 v202, 0
    v_mov_b32 v203, 0
    v_mov_b32 v204, 0
    v_mov_b32 v205, 0
    v_mov_b32 v206, 0
    v_mov_b32 v207, 0
    v_mov_b32 v208, 0
    v_mov_b32 v209, 0
    v_mov_b32 v210, 0
    v_mov_b32 v211, 0
    v_mov_b32 v212, 0
    v_mov_b32 v213, 0
    v_mov_b32 v214, 0
    v_mov_b32 v215, 0
    v_mov_b32 v216, 0
    v_mov_b32 v217, 0
    v_mov_b32 v218, 0
    v_mov_b32 v219, 0
    v_mov_b32 v220, 0
    v_mov_b32 v221, 0
    v_mov_b32 v222, 0
    v_mov_b32 v223, 0
    s_mov_b32 s23, 3
L_parallel_sum__sliding_block__mixer_token_mlp__prompt_kernel_q2d:
    s_waitcnt vmcnt(63) lgkmcnt(0)
    s_barrier
    v_mfma_f32_16x16x32_bf16 v[96:99], v[32:35], v[16:19], v[96:99]
    ds_read_b128 v[56:59], v11 offset:0
    v_mfma_f32_16x16x32_bf16 v[100:103], v[36:39], v[16:19], v[100:103]
    ds_read_b64_tr_b16 v[72:73], v13 offset:0
    v_mfma_f32_16x16x32_bf16 v[104:107], v[40:43], v[16:19], v[104:107]
    ds_read_b64_tr_b16 v[74:75], v13 offset:512
    v_mfma_f32_16x16x32_bf16 v[108:111], v[44:47], v[16:19], v[108:111]
    ds_read_b64_tr_b16 v[76:77], v14 offset:0
    v_mfma_f32_16x16x32_bf16 v[160:163], v[16:19], v[48:51], v[160:163]
    ds_read_b64_tr_b16 v[78:79], v14 offset:512
    v_mfma_f32_16x16x32_bf16 v[168:171], v[16:19], v[52:55], v[168:171]
    ds_read_b64_tr_b16 v[80:81], v13 offset:4096
    v_mfma_f32_16x16x32_bf16 v[172:175], v[20:23], v[52:55], v[172:175]
    ds_read_b64_tr_b16 v[82:83], v13 offset:4608
    v_mfma_f32_16x16x32_bf16 v[164:167], v[20:23], v[48:51], v[164:167]
    ds_read_b64_tr_b16 v[84:85], v14 offset:4096
    v_mfma_f32_16x16x32_bf16 v[124:127], v[44:47], v[20:23], v[124:127]
    ds_read_b64_tr_b16 v[86:87], v14 offset:4608
    v_mfma_f32_16x16x32_bf16 v[120:123], v[40:43], v[20:23], v[120:123]
    ds_read_b64_tr_b16 v[88:89], v13 offset:8192
    v_mfma_f32_16x16x32_bf16 v[116:119], v[36:39], v[20:23], v[116:119]
    ds_read_b64_tr_b16 v[90:91], v13 offset:8704
    v_mfma_f32_16x16x32_bf16 v[112:115], v[32:35], v[20:23], v[112:115]
    ds_read_b64_tr_b16 v[92:93], v14 offset:8192
    v_mfma_f32_16x16x32_bf16 v[128:131], v[32:35], v[24:27], v[128:131]
    ds_read_b64_tr_b16 v[94:95], v14 offset:8704
    v_mfma_f32_16x16x32_bf16 v[132:135], v[36:39], v[24:27], v[132:135]
    ds_read_b128 v[60:63], v11 offset:2048
    v_mfma_f32_16x16x32_bf16 v[136:139], v[40:43], v[24:27], v[136:139]
    ds_read_b128 v[64:67], v12 offset:0
    v_mfma_f32_16x16x32_bf16 v[140:143], v[44:47], v[24:27], v[140:143]
    ds_read_b128 v[68:71], v12 offset:2048
    s_mov_b32 s21, s22
    s_add_u32 s22, s22, 12288
    s_cmp_eq_u32 s22, 61440
    s_cselect_b32 s22, 0, s22
    s_add_u32 s26, s26, 1
    s_cmp_eq_u32 s26, 3
    s_cselect_b32 s26, 0, s26
    s_cselect_b32 s55, s54, 32768
    v_mfma_f32_16x16x32_bf16 v[176:179], v[24:27], v[48:51], v[176:179]
    v_add_u32 v13, s22, v9
    v_add_u32 v14, s22, v10
    v_mfma_f32_16x16x32_bf16 v[184:187], v[24:27], v[52:55], v[184:187]
    v_add_u32 v7, s55, v7
    v_add_u32 v8, s55, v8
    v_mfma_f32_16x16x32_bf16 v[188:191], v[28:31], v[52:55], v[188:191]
    v_mfma_f32_16x16x32_bf16 v[180:183], v[28:31], v[48:51], v[180:183]
    v_mfma_f32_16x16x32_bf16 v[156:159], v[44:47], v[28:31], v[156:159]
    v_mfma_f32_16x16x32_bf16 v[152:155], v[40:43], v[28:31], v[152:155]
    v_mfma_f32_16x16x32_bf16 v[148:151], v[36:39], v[28:31], v[148:151]
    v_mfma_f32_16x16x32_bf16 v[144:147], v[32:35], v[28:31], v[144:147]
    s_waitcnt vmcnt(63) lgkmcnt(0)
    s_barrier
    v_mfma_f32_16x16x32_bf16 v[96:99], v[72:75], v[56:59], v[96:99]
    ds_read_b128 v[16:19], v7 offset:0
    v_mfma_f32_16x16x32_bf16 v[100:103], v[76:79], v[56:59], v[100:103]
    ds_read_b64_tr_b16 v[32:33], v13 offset:0
    v_mfma_f32_16x16x32_bf16 v[104:107], v[80:83], v[56:59], v[104:107]
    ds_read_b64_tr_b16 v[34:35], v13 offset:512
    v_mfma_f32_16x16x32_bf16 v[108:111], v[84:87], v[56:59], v[108:111]
    ds_read_b64_tr_b16 v[36:37], v14 offset:0
    v_mfma_f32_16x16x32_bf16 v[160:163], v[56:59], v[88:91], v[160:163]
    ds_read_b64_tr_b16 v[38:39], v14 offset:512
    v_mfma_f32_16x16x32_bf16 v[168:171], v[56:59], v[92:95], v[168:171]
    ds_read_b64_tr_b16 v[40:41], v13 offset:4096
    v_mfma_f32_16x16x32_bf16 v[172:175], v[60:63], v[92:95], v[172:175]
    ds_read_b64_tr_b16 v[42:43], v13 offset:4608
    v_mfma_f32_16x16x32_bf16 v[164:167], v[60:63], v[88:91], v[164:167]
    ds_read_b64_tr_b16 v[44:45], v14 offset:4096
    v_mfma_f32_16x16x32_bf16 v[124:127], v[84:87], v[60:63], v[124:127]
    ds_read_b64_tr_b16 v[46:47], v14 offset:4608
    v_mfma_f32_16x16x32_bf16 v[120:123], v[80:83], v[60:63], v[120:123]
    ds_read_b64_tr_b16 v[48:49], v13 offset:8192
    v_mfma_f32_16x16x32_bf16 v[116:119], v[76:79], v[60:63], v[116:119]
    ds_read_b64_tr_b16 v[50:51], v13 offset:8704
    v_mfma_f32_16x16x32_bf16 v[112:115], v[72:75], v[60:63], v[112:115]
    ds_read_b64_tr_b16 v[52:53], v14 offset:8192
    v_mfma_f32_16x16x32_bf16 v[128:131], v[72:75], v[64:67], v[128:131]
    ds_read_b64_tr_b16 v[54:55], v14 offset:8704
    v_mfma_f32_16x16x32_bf16 v[132:135], v[76:79], v[64:67], v[132:135]
    ds_read_b128 v[20:23], v7 offset:2048
    v_mfma_f32_16x16x32_bf16 v[136:139], v[80:83], v[64:67], v[136:139]
    ds_read_b128 v[24:27], v8 offset:0
    v_mfma_f32_16x16x32_bf16 v[140:143], v[84:87], v[64:67], v[140:143]
    ds_read_b128 v[28:31], v8 offset:2048
    s_mov_b32 s21, s22
    s_add_u32 s22, s22, 12288
    s_cmp_eq_u32 s22, 61440
    s_cselect_b32 s22, 0, s22
    v_mfma_f32_16x16x32_bf16 v[176:179], v[64:67], v[88:91], v[176:179]
    v_add_u32 v13, s22, v9
    v_add_u32 v14, s22, v10
    v_mfma_f32_16x16x32_bf16 v[184:187], v[64:67], v[92:95], v[184:187]
    v_add_u32 v11, s55, v11
    v_add_u32 v12, s55, v12
    v_mfma_f32_16x16x32_bf16 v[188:191], v[68:71], v[92:95], v[188:191]
    v_mfma_f32_16x16x32_bf16 v[180:183], v[68:71], v[88:91], v[180:183]
    v_mfma_f32_16x16x32_bf16 v[156:159], v[84:87], v[68:71], v[156:159]
    v_mfma_f32_16x16x32_bf16 v[152:155], v[80:83], v[68:71], v[152:155]
    v_mfma_f32_16x16x32_bf16 v[148:151], v[76:79], v[68:71], v[148:151]
    v_mfma_f32_16x16x32_bf16 v[144:147], v[72:75], v[68:71], v[144:147]
    s_sub_u32 s23, s23, 1
    s_cmp_lg_u32 s23, 0
    s_cbranch_scc1 L_parallel_sum__sliding_block__mixer_token_mlp__prompt_kernel_q2d
    s_waitcnt vmcnt(0) lgkmcnt(0)
L_parallel_sum__sliding_block__mixer_token_mlp__prompt_kernel_qepi:
    s_barrier
    s_add_u32 s12, s28, 8388608
    s_addc_u32 s13, s29, 0
    s_and_b32 s13, s13, 0xffff
    s_mov_b32 s14, 8388608
    s_mov_b32 s15, 0x20000
    s_add_u32 s44, s28, 29360128
    s_addc_u32 s45, s29, 0
    s_and_b32 s45, s45, 0xffff
    s_mov_b32 s46, 4194304
    s_mov_b32 s47, 0x20000
    s_add_u32 s48, s28, 50331648
    s_addc_u32 s49, s29, 0
    s_and_b32 s49, s49, 0xffff
    s_mov_b32 s50, 131072
    s_mov_b32 s51, 0x20000
    s_sub_u32 s57, 7, s24
    v_and_b32 v13, 15, v1
    v_lshlrev_b32 v13, 2, v13
    v_lshrrev_b32 v14, 4, v1
    v_lshlrev_b32 v14, 4, v14
    s_lshl_b32 s40, s24, 7
    s_add_u32 s40, s40, 159808
    v_add_u32 v15, s40, v13
    v_add_u32 v9, s40, v14
    ds_read_b32 v16, v15 offset:0
    ds_read_b32 v20, v15 offset:1024
    ds_read_b128 v[24:27], v9 offset:0
    ds_read_b128 v[40:43], v9 offset:1024
    ds_read_b32 v17, v15 offset:64
    ds_read_b32 v21, v15 offset:1088
    ds_read_b128 v[28:31], v9 offset:64
    ds_read_b128 v[44:47], v9 offset:1088
    s_lshl_b32 s40, s57, 7
    s_add_u32 s40, s40, 159808
    v_add_u32 v15, s40, v13
    v_add_u32 v9, s40, v14
    ds_read_b32 v18, v15 offset:0
    ds_read_b32 v22, v15 offset:1024
    ds_read_b128 v[32:35], v9 offset:0
    ds_read_b128 v[48:51], v9 offset:1024
    ds_read_b32 v19, v15 offset:64
    ds_read_b32 v23, v15 offset:1088
    ds_read_b128 v[36:39], v9 offset:64
    ds_read_b128 v[52:55], v9 offset:1088
    s_lshl_b32 s40, s25, 7
    s_add_u32 s40, s40, 161856
    v_add_u32 v15, s40, v13
    v_add_u32 v9, s40, v14
    s_waitcnt lgkmcnt(8)
    ds_read_b128 v[56:59], v9 offset:0
    ds_read_b128 v[60:63], v9 offset:64
    ds_read_b128 v[64:67], v9 offset:256
    ds_read_b128 v[68:71], v9 offset:320
    ds_read_b32 v72, v15 offset:512
    ds_read_b32 v73, v15 offset:576
    s_lshl_b32 s40, s38, 4
    s_add_u32 s40, s40, s39
    s_lshl_b32 s60, s40, 16
    s_lshl_b32 s41, s25, 15
    s_add_u32 s41, s41, s60
    s_lshl_b32 s42, s25, 16
    v_add_u32 v8, s42, v2
    s_mov_b32 s54, 0x3e8293ee
    v_lshrrev_b32 v13, 4, v1
    v_and_b32 v11, 15, v1
    v_lshlrev_b32 v11, 4, v11
    v_lshl_add_u32 v11, v13, 9, v11
    v_and_b32 v12, 7, v1
    v_lshlrev_b32 v12, 4, v12
    v_lshl_add_u32 v12, v13, 9, v12
    v_bfe_u32 v13, v1, 3, 1
    v_lshl_add_u32 v12, v13, 8, v12
    s_waitcnt lgkmcnt(0)
    v_mul_f32 v74, s54, v20
    v_mul_f32 v75, s54, v21
    v_mul_f32 v76, s54, v22
    v_mul_f32 v77, s54, v23
    s_lshl_b32 s42, s24, 12
    s_add_u32 s43, s41, s42
    s_lshl_b32 s40, s25, 16
    s_add_u32 s42, s42, s40
    v_add_u32 v13, s42, v11
    v_add_u32 v14, s42, v12
    v_add_u32 v78, s42, v2
    v_fmac_f32 v104, v64, v16
    v_fmac_f32 v105, v65, v16
    v_fmac_f32 v106, v66, v16
    v_fmac_f32 v107, v67, v16
    v_fmac_f32 v108, v68, v16
    v_fmac_f32 v109, v69, v16
    v_fmac_f32 v110, v70, v16
    v_fmac_f32 v111, v71, v16
    v_mul_f32 v104, v104, v20
    v_mul_f32 v105, v105, v20
    v_mul_f32 v106, v106, v20
    v_mul_f32 v107, v107, v20
    v_mul_f32 v108, v108, v20
    v_mul_f32 v109, v109, v20
    v_mul_f32 v110, v110, v20
    v_mul_f32 v111, v111, v20
    v_cvt_pk_bf16_f32 v104, v104, v105
    v_cvt_pk_bf16_f32 v105, v106, v107
    v_cvt_pk_bf16_f32 v106, v108, v109
    v_cvt_pk_bf16_f32 v107, v110, v111
    buffer_store_dwordx4 v[104:107], v12, s[12:15], s43 offen offset:0 sc1
    ds_write_b128 v14, v[104:107] offset:32768
    v_fmac_f32 v120, v64, v17
    v_fmac_f32 v121, v65, v17
    v_fmac_f32 v122, v66, v17
    v_fmac_f32 v123, v67, v17
    v_fmac_f32 v124, v68, v17
    v_fmac_f32 v125, v69, v17
    v_fmac_f32 v126, v70, v17
    v_fmac_f32 v127, v71, v17
    v_mul_f32 v120, v120, v21
    v_mul_f32 v121, v121, v21
    v_mul_f32 v122, v122, v21
    v_mul_f32 v123, v123, v21
    v_mul_f32 v124, v124, v21
    v_mul_f32 v125, v125, v21
    v_mul_f32 v126, v126, v21
    v_mul_f32 v127, v127, v21
    v_cvt_pk_bf16_f32 v120, v120, v121
    v_cvt_pk_bf16_f32 v121, v122, v123
    v_cvt_pk_bf16_f32 v122, v124, v125
    v_cvt_pk_bf16_f32 v123, v126, v127
    buffer_store_dwordx4 v[120:123], v12, s[12:15], s43 offen offset:128 sc1
    ds_write_b128 v14, v[120:123] offset:32896
    v_fmac_f32 v160, v24, v72
    v_fmac_f32 v161, v25, v72
    v_fmac_f32 v162, v26, v72
    v_fmac_f32 v163, v27, v72
    v_fmac_f32 v164, v28, v72
    v_fmac_f32 v165, v29, v72
    v_fmac_f32 v166, v30, v72
    v_fmac_f32 v167, v31, v72
    v_mul_f32 v160, v160, v40
    v_mul_f32 v161, v161, v41
    v_mul_f32 v162, v162, v42
    v_mul_f32 v163, v163, v43
    v_mul_f32 v164, v164, v44
    v_mul_f32 v165, v165, v45
    v_mul_f32 v166, v166, v46
    v_mul_f32 v167, v167, v47
    v_cvt_pk_bf16_f32 v160, v160, v161
    v_cvt_pk_bf16_f32 v161, v162, v163
    v_cvt_pk_bf16_f32 v162, v164, v165
    v_cvt_pk_bf16_f32 v163, v166, v167
    buffer_store_dwordx4 v[160:163], v11, s[12:15], s43 offen offset:2048 sc1
    ds_write_b128 v13, v[160:163] offset:34816
    v_fmac_f32 v168, v24, v73
    v_fmac_f32 v169, v25, v73
    v_fmac_f32 v170, v26, v73
    v_fmac_f32 v171, v27, v73
    v_fmac_f32 v172, v28, v73
    v_fmac_f32 v173, v29, v73
    v_fmac_f32 v174, v30, v73
    v_fmac_f32 v175, v31, v73
    v_mul_f32 v168, v168, v40
    v_mul_f32 v169, v169, v41
    v_mul_f32 v170, v170, v42
    v_mul_f32 v171, v171, v43
    v_mul_f32 v172, v172, v44
    v_mul_f32 v173, v173, v45
    v_mul_f32 v174, v174, v46
    v_mul_f32 v175, v175, v47
    v_cvt_pk_bf16_f32 v168, v168, v169
    v_cvt_pk_bf16_f32 v169, v170, v171
    v_cvt_pk_bf16_f32 v170, v172, v173
    v_cvt_pk_bf16_f32 v171, v174, v175
    buffer_store_dwordx4 v[168:171], v11, s[12:15], s43 offen offset:2304 sc1
    ds_write_b128 v13, v[168:171] offset:35072
    v_fmac_f32 v96, v56, v16
    v_fmac_f32 v97, v57, v16
    v_fmac_f32 v98, v58, v16
    v_fmac_f32 v99, v59, v16
    v_fmac_f32 v100, v60, v16
    v_fmac_f32 v101, v61, v16
    v_fmac_f32 v102, v62, v16
    v_fmac_f32 v103, v63, v16
    v_mul_f32 v96, v96, v74
    v_mul_f32 v97, v97, v74
    v_mul_f32 v98, v98, v74
    v_mul_f32 v99, v99, v74
    v_mul_f32 v100, v100, v74
    v_mul_f32 v101, v101, v74
    v_mul_f32 v102, v102, v74
    v_mul_f32 v103, v103, v74
    v_cvt_pk_bf16_f32 v96, v96, v97
    v_cvt_pk_bf16_f32 v97, v98, v99
    v_cvt_pk_bf16_f32 v98, v100, v101
    v_cvt_pk_bf16_f32 v99, v102, v103
    ds_write_b128 v13, v[96:99] offset:0
    v_fmac_f32 v112, v56, v17
    v_fmac_f32 v113, v57, v17
    v_fmac_f32 v114, v58, v17
    v_fmac_f32 v115, v59, v17
    v_fmac_f32 v116, v60, v17
    v_fmac_f32 v117, v61, v17
    v_fmac_f32 v118, v62, v17
    v_fmac_f32 v119, v63, v17
    v_mul_f32 v112, v112, v75
    v_mul_f32 v113, v113, v75
    v_mul_f32 v114, v114, v75
    v_mul_f32 v115, v115, v75
    v_mul_f32 v116, v116, v75
    v_mul_f32 v117, v117, v75
    v_mul_f32 v118, v118, v75
    v_mul_f32 v119, v119, v75
    v_cvt_pk_bf16_f32 v112, v112, v113
    v_cvt_pk_bf16_f32 v113, v114, v115
    v_cvt_pk_bf16_f32 v114, v116, v117
    v_cvt_pk_bf16_f32 v115, v118, v119
    ds_write_b128 v13, v[112:115] offset:256
    s_lshl_b32 s42, s57, 12
    s_add_u32 s43, s41, s42
    s_lshl_b32 s40, s25, 16
    s_add_u32 s42, s42, s40
    v_add_u32 v13, s42, v11
    v_add_u32 v14, s42, v12
    v_add_u32 v79, s42, v2
    v_fmac_f32 v136, v64, v18
    v_fmac_f32 v137, v65, v18
    v_fmac_f32 v138, v66, v18
    v_fmac_f32 v139, v67, v18
    v_fmac_f32 v140, v68, v18
    v_fmac_f32 v141, v69, v18
    v_fmac_f32 v142, v70, v18
    v_fmac_f32 v143, v71, v18
    v_mul_f32 v136, v136, v22
    v_mul_f32 v137, v137, v22
    v_mul_f32 v138, v138, v22
    v_mul_f32 v139, v139, v22
    v_mul_f32 v140, v140, v22
    v_mul_f32 v141, v141, v22
    v_mul_f32 v142, v142, v22
    v_mul_f32 v143, v143, v22
    v_cvt_pk_bf16_f32 v136, v136, v137
    v_cvt_pk_bf16_f32 v137, v138, v139
    v_cvt_pk_bf16_f32 v138, v140, v141
    v_cvt_pk_bf16_f32 v139, v142, v143
    buffer_store_dwordx4 v[136:139], v12, s[12:15], s43 offen offset:0 sc1
    ds_write_b128 v14, v[136:139] offset:32768
    v_fmac_f32 v152, v64, v19
    v_fmac_f32 v153, v65, v19
    v_fmac_f32 v154, v66, v19
    v_fmac_f32 v155, v67, v19
    v_fmac_f32 v156, v68, v19
    v_fmac_f32 v157, v69, v19
    v_fmac_f32 v158, v70, v19
    v_fmac_f32 v159, v71, v19
    v_mul_f32 v152, v152, v23
    v_mul_f32 v153, v153, v23
    v_mul_f32 v154, v154, v23
    v_mul_f32 v155, v155, v23
    v_mul_f32 v156, v156, v23
    v_mul_f32 v157, v157, v23
    v_mul_f32 v158, v158, v23
    v_mul_f32 v159, v159, v23
    v_cvt_pk_bf16_f32 v152, v152, v153
    v_cvt_pk_bf16_f32 v153, v154, v155
    v_cvt_pk_bf16_f32 v154, v156, v157
    v_cvt_pk_bf16_f32 v155, v158, v159
    buffer_store_dwordx4 v[152:155], v12, s[12:15], s43 offen offset:128 sc1
    ds_write_b128 v14, v[152:155] offset:32896
    v_fmac_f32 v176, v32, v72
    v_fmac_f32 v177, v33, v72
    v_fmac_f32 v178, v34, v72
    v_fmac_f32 v179, v35, v72
    v_fmac_f32 v180, v36, v72
    v_fmac_f32 v181, v37, v72
    v_fmac_f32 v182, v38, v72
    v_fmac_f32 v183, v39, v72
    v_mul_f32 v176, v176, v48
    v_mul_f32 v177, v177, v49
    v_mul_f32 v178, v178, v50
    v_mul_f32 v179, v179, v51
    v_mul_f32 v180, v180, v52
    v_mul_f32 v181, v181, v53
    v_mul_f32 v182, v182, v54
    v_mul_f32 v183, v183, v55
    v_cvt_pk_bf16_f32 v176, v176, v177
    v_cvt_pk_bf16_f32 v177, v178, v179
    v_cvt_pk_bf16_f32 v178, v180, v181
    v_cvt_pk_bf16_f32 v179, v182, v183
    buffer_store_dwordx4 v[176:179], v11, s[12:15], s43 offen offset:2048 sc1
    ds_write_b128 v13, v[176:179] offset:34816
    v_fmac_f32 v184, v32, v73
    v_fmac_f32 v185, v33, v73
    v_fmac_f32 v186, v34, v73
    v_fmac_f32 v187, v35, v73
    v_fmac_f32 v188, v36, v73
    v_fmac_f32 v189, v37, v73
    v_fmac_f32 v190, v38, v73
    v_fmac_f32 v191, v39, v73
    v_mul_f32 v184, v184, v48
    v_mul_f32 v185, v185, v49
    v_mul_f32 v186, v186, v50
    v_mul_f32 v187, v187, v51
    v_mul_f32 v188, v188, v52
    v_mul_f32 v189, v189, v53
    v_mul_f32 v190, v190, v54
    v_mul_f32 v191, v191, v55
    v_cvt_pk_bf16_f32 v184, v184, v185
    v_cvt_pk_bf16_f32 v185, v186, v187
    v_cvt_pk_bf16_f32 v186, v188, v189
    v_cvt_pk_bf16_f32 v187, v190, v191
    buffer_store_dwordx4 v[184:187], v11, s[12:15], s43 offen offset:2304 sc1
    ds_write_b128 v13, v[184:187] offset:35072
    v_fmac_f32 v128, v56, v18
    v_fmac_f32 v129, v57, v18
    v_fmac_f32 v130, v58, v18
    v_fmac_f32 v131, v59, v18
    v_fmac_f32 v132, v60, v18
    v_fmac_f32 v133, v61, v18
    v_fmac_f32 v134, v62, v18
    v_fmac_f32 v135, v63, v18
    v_mul_f32 v128, v128, v76
    v_mul_f32 v129, v129, v76
    v_mul_f32 v130, v130, v76
    v_mul_f32 v131, v131, v76
    v_mul_f32 v132, v132, v76
    v_mul_f32 v133, v133, v76
    v_mul_f32 v134, v134, v76
    v_mul_f32 v135, v135, v76
    v_cvt_pk_bf16_f32 v128, v128, v129
    v_cvt_pk_bf16_f32 v129, v130, v131
    v_cvt_pk_bf16_f32 v130, v132, v133
    v_cvt_pk_bf16_f32 v131, v134, v135
    ds_write_b128 v13, v[128:131] offset:0
    v_fmac_f32 v144, v56, v19
    v_fmac_f32 v145, v57, v19
    v_fmac_f32 v146, v58, v19
    v_fmac_f32 v147, v59, v19
    v_fmac_f32 v148, v60, v19
    v_fmac_f32 v149, v61, v19
    v_fmac_f32 v150, v62, v19
    v_fmac_f32 v151, v63, v19
    v_mul_f32 v144, v144, v77
    v_mul_f32 v145, v145, v77
    v_mul_f32 v146, v146, v77
    v_mul_f32 v147, v147, v77
    v_mul_f32 v148, v148, v77
    v_mul_f32 v149, v149, v77
    v_mul_f32 v150, v150, v77
    v_mul_f32 v151, v151, v77
    v_cvt_pk_bf16_f32 v144, v144, v145
    v_cvt_pk_bf16_f32 v145, v146, v147
    v_cvt_pk_bf16_f32 v146, v148, v149
    v_cvt_pk_bf16_f32 v147, v150, v151
    ds_write_b128 v13, v[144:147] offset:256
    s_waitcnt lgkmcnt(0)
    ds_read_b128 v[184:187], v78
    ds_read_b128 v[188:191], v78 offset:1024
    ds_read_b128 v[176:179], v79
    ds_read_b128 v[180:183], v79 offset:1024
    s_lshr_b32 s61, s60, 8
    v_mov_b32 v10, 0
    s_waitcnt lgkmcnt(0)
    s_barrier
    s_mov_b32 s56, 0
    s_add_u32 s52, s57, 1
    s_sub_u32 s62, s52, 4
    s_mov_b32 s53, -4096
    s_lshl_b32 s42, s57, 12
    s_add_u32 s42, s42, 32768
    v_add_u32 v3, s42, v8
L_parallel_sum__sliding_block__mixer_token_mlp__prompt_kernel_chunk:
    v_mov_b32 v4, v3
    ds_read_b128 v[48:51], v4
    ds_read_b128 v[52:55], v4 offset:1024
    v_add_u32 v4, s53, v4
    v_mov_b32 v5, v3
    ds_read_b128 v[56:59], v4
    ds_read_b128 v[60:63], v4 offset:1024
    ds_read_b128 v[64:67], v5 offset:2048
    ds_read_b128 v[68:71], v5 offset:3072
    v_mov_b32 v160, v241
    v_mov_b32 v252, 0x41000000
    v_sub_f32 v16, v224, v240
    v_sub_f32 v17, v225, v240
    v_sub_f32 v18, v226, v240
    v_sub_f32 v19, v227, v240
    v_sub_f32 v20, v228, v240
    v_sub_f32 v21, v229, v240
    v_sub_f32 v22, v230, v240
    v_sub_f32 v23, v231, v240
    v_sub_f32 v24, v232, v240
    v_sub_f32 v25, v233, v240
    v_sub_f32 v26, v234, v240
    v_sub_f32 v27, v235, v240
    v_sub_f32 v28, v236, v240
    v_sub_f32 v29, v237, v240
    v_sub_f32 v30, v238, v240
    v_sub_f32 v31, v239, v240
    s_waitcnt lgkmcnt(4)
    s_nop 0
    v_mfma_f32_32x32x16_bf16 v[16:31], v[48:51], v[176:179], v[16:31]
    v_mfma_f32_32x32x16_bf16 v[16:31], v[52:55], v[180:183], v[16:31]
    v_sub_f32 v144, 0, v240
    v_sub_f32 v145, 0, v240
    v_sub_f32 v146, 0, v240
    v_sub_f32 v147, 0, v240
    v_sub_f32 v148, 0, v240
    v_sub_f32 v149, 0, v240
    v_sub_f32 v150, 0, v240
    v_sub_f32 v151, 0, v240
    v_sub_f32 v152, 0, v240
    v_sub_f32 v153, 0, v240
    v_sub_f32 v154, 0, v240
    v_sub_f32 v155, 0, v240
    v_sub_f32 v156, 0, v240
    v_sub_f32 v157, 0, v240
    v_sub_f32 v158, 0, v240
    v_sub_f32 v159, 0, v240
    v_max_f32 v248, v16, v17
    v_max_f32 v249, v18, v19
    v_max3_f32 v248, v248, v20, v21
    v_max3_f32 v249, v249, v22, v23
    v_max3_f32 v248, v248, v24, v25
    v_max3_f32 v249, v249, v26, v27
    v_max3_f32 v248, v248, v28, v29
    v_max3_f32 v249, v249, v30, v31
    v_max_f32 v248, v248, v249
    v_mov_b32 v249, v248
    s_nop 1
    v_permlane32_swap_b32 v248, v249
    v_max_f32 v248, v248, v249
    v_cmp_lt_f32 vcc, v252, v248
    s_cmp_lt_u32 s56, 2
    s_cbranch_scc1 L_parallel_sum__sliding_block__mixer_token_mlp__prompt_kernel_ck_shift1
    s_cbranch_vccnz L_parallel_sum__sliding_block__mixer_token_mlp__prompt_kernel_ck_rare1
L_parallel_sum__sliding_block__mixer_token_mlp__prompt_kernel_ck_b0:
    s_waitcnt lgkmcnt(2)
    v_mfma_f32_32x32x16_bf16 v[32:47], v[56:59], v[176:179], v[144:159]
    v_add_u32 v4, s53, v4
    v_add_u32 v5, s53, v5
    v_exp_f32 v16, v16
    v_exp_f32 v17, v17
    v_exp_f32 v18, v18
    v_mfma_f32_32x32x16_bf16 v[32:47], v[60:63], v[180:183], v[32:47]
    ds_read_b128 v[48:51], v4
    ds_read_b128 v[52:55], v4 offset:1024
    ds_read_b128 v[72:75], v5 offset:2048
    ds_read_b128 v[76:79], v5 offset:3072
    v_exp_f32 v19, v19
    v_exp_f32 v20, v20
    v_exp_f32 v21, v21
    v_exp_f32 v22, v22
    v_exp_f32 v23, v23
    v_cvt_pk_bf16_f32 v16, v16, v17
    v_cvt_pk_bf16_f32 v17, v18, v19
    v_cvt_pk_bf16_f32 v18, v20, v21
    v_cvt_pk_bf16_f32 v19, v22, v23
    v_exp_f32 v24, v24
    v_exp_f32 v25, v25
    s_waitcnt lgkmcnt(4)
    v_mfma_f32_32x32x16_bf16 v[192:207], v[64:67], v[16:19], v[192:207]
    v_exp_f32 v26, v26
    v_exp_f32 v27, v27
    v_exp_f32 v28, v28
    v_mfma_f32_32x32x16_bf16 v[160:175], v[244:247], v[16:19], v[160:175]
    v_exp_f32 v29, v29
    v_exp_f32 v30, v30
    v_exp_f32 v31, v31
    v_cvt_pk_bf16_f32 v20, v24, v25
    v_cvt_pk_bf16_f32 v21, v26, v27
    v_cvt_pk_bf16_f32 v22, v28, v29
    v_cvt_pk_bf16_f32 v23, v30, v31
    v_max_f32 v248, v32, v33
    v_max_f32 v249, v34, v35
    v_mfma_f32_32x32x16_bf16 v[192:207], v[68:71], v[20:23], v[192:207]
    v_max3_f32 v248, v248, v36, v37
    v_max3_f32 v249, v249, v38, v39
    v_max3_f32 v248, v248, v40, v41
    v_max3_f32 v249, v249, v42, v43
    v_max3_f32 v248, v248, v44, v45
    v_max3_f32 v249, v249, v46, v47
    v_mfma_f32_32x32x16_bf16 v[160:175], v[244:247], v[20:23], v[160:175]
    v_max_f32 v248, v248, v249
    v_mov_b32 v249, v248
    s_nop 1
    v_permlane32_swap_b32 v248, v249
    v_max_f32 v248, v248, v249
    v_cmp_lt_f32 vcc, v252, v248
    s_sub_u32 s52, s52, 1
    s_cmp_eq_u32 s52, 0
    s_cbranch_scc1 L_parallel_sum__sliding_block__mixer_token_mlp__prompt_kernel_ck_x
    s_cbranch_vccnz L_parallel_sum__sliding_block__mixer_token_mlp__prompt_kernel_ck_rare0
L_parallel_sum__sliding_block__mixer_token_mlp__prompt_kernel_ck_b1:
    s_waitcnt lgkmcnt(2)
    v_mfma_f32_32x32x16_bf16 v[16:31], v[48:51], v[176:179], v[144:159]
    v_add_u32 v4, s53, v4
    v_add_u32 v5, s53, v5
    v_exp_f32 v32, v32
    v_exp_f32 v33, v33
    v_exp_f32 v34, v34
    v_mfma_f32_32x32x16_bf16 v[16:31], v[52:55], v[180:183], v[16:31]
    ds_read_b128 v[56:59], v4
    ds_read_b128 v[60:63], v4 offset:1024
    ds_read_b128 v[64:67], v5 offset:2048
    ds_read_b128 v[68:71], v5 offset:3072
    v_exp_f32 v35, v35
    v_exp_f32 v36, v36
    v_exp_f32 v37, v37
    v_exp_f32 v38, v38
    v_exp_f32 v39, v39
    v_cvt_pk_bf16_f32 v32, v32, v33
    v_cvt_pk_bf16_f32 v33, v34, v35
    v_cvt_pk_bf16_f32 v34, v36, v37
    v_cvt_pk_bf16_f32 v35, v38, v39
    v_exp_f32 v40, v40
    v_exp_f32 v41, v41
    s_waitcnt lgkmcnt(4)
    v_mfma_f32_32x32x16_bf16 v[192:207], v[72:75], v[32:35], v[192:207]
    v_exp_f32 v42, v42
    v_exp_f32 v43, v43
    v_exp_f32 v44, v44
    v_mfma_f32_32x32x16_bf16 v[160:175], v[244:247], v[32:35], v[160:175]
    v_exp_f32 v45, v45
    v_exp_f32 v46, v46
    v_exp_f32 v47, v47
    v_cvt_pk_bf16_f32 v36, v40, v41
    v_cvt_pk_bf16_f32 v37, v42, v43
    v_cvt_pk_bf16_f32 v38, v44, v45
    v_cvt_pk_bf16_f32 v39, v46, v47
    v_max_f32 v248, v16, v17
    v_max_f32 v249, v18, v19
    v_mfma_f32_32x32x16_bf16 v[192:207], v[76:79], v[36:39], v[192:207]
    v_max3_f32 v248, v248, v20, v21
    v_max3_f32 v249, v249, v22, v23
    v_max3_f32 v248, v248, v24, v25
    v_max3_f32 v249, v249, v26, v27
    v_max3_f32 v248, v248, v28, v29
    v_max3_f32 v249, v249, v30, v31
    v_mfma_f32_32x32x16_bf16 v[160:175], v[244:247], v[36:39], v[160:175]
    v_max_f32 v248, v248, v249
    v_mov_b32 v249, v248
    s_nop 1
    v_permlane32_swap_b32 v248, v249
    v_max_f32 v248, v248, v249
    v_cmp_lt_f32 vcc, v252, v248
    s_sub_u32 s52, s52, 1
    s_cmp_eq_u32 s52, 0
    s_cbranch_scc1 L_parallel_sum__sliding_block__mixer_token_mlp__prompt_kernel_ck_x
    s_cmp_eq_u32 s52, s62
    s_cbranch_scc1 L_parallel_sum__sliding_block__mixer_token_mlp__prompt_kernel_ck_pub
L_parallel_sum__sliding_block__mixer_token_mlp__prompt_kernel_ck_pubret:
    s_cbranch_vccnz L_parallel_sum__sliding_block__mixer_token_mlp__prompt_kernel_ck_rare1
    s_branch L_parallel_sum__sliding_block__mixer_token_mlp__prompt_kernel_ck_b0
L_parallel_sum__sliding_block__mixer_token_mlp__prompt_kernel_ck_rare0:
    v_max_f32 v248, 0, v248
    v_sub_f32 v249, 0, v248
    v_exp_f32 v249, v249
    s_nop 7
    v_mul_f32 v192, v192, v249
    v_mul_f32 v193, v193, v249
    v_mul_f32 v194, v194, v249
    v_mul_f32 v195, v195, v249
    v_mul_f32 v196, v196, v249
    v_mul_f32 v197, v197, v249
    v_mul_f32 v198, v198, v249
    v_mul_f32 v199, v199, v249
    v_mul_f32 v200, v200, v249
    v_mul_f32 v201, v201, v249
    v_mul_f32 v202, v202, v249
    v_mul_f32 v203, v203, v249
    v_mul_f32 v204, v204, v249
    v_mul_f32 v205, v205, v249
    v_mul_f32 v206, v206, v249
    v_mul_f32 v207, v207, v249
    v_mul_f32 v160, v160, v249
    v_add_f32 v240, v240, v248
    v_sub_f32 v32, v32, v248
    v_sub_f32 v33, v33, v248
    v_sub_f32 v34, v34, v248
    v_sub_f32 v35, v35, v248
    v_sub_f32 v36, v36, v248
    v_sub_f32 v37, v37, v248
    v_sub_f32 v38, v38, v248
    v_sub_f32 v39, v39, v248
    v_sub_f32 v40, v40, v248
    v_sub_f32 v41, v41, v248
    v_sub_f32 v42, v42, v248
    v_sub_f32 v43, v43, v248
    v_sub_f32 v44, v44, v248
    v_sub_f32 v45, v45, v248
    v_sub_f32 v46, v46, v248
    v_sub_f32 v47, v47, v248
    v_sub_f32 v144, 0, v240
    v_sub_f32 v145, 0, v240
    v_sub_f32 v146, 0, v240
    v_sub_f32 v147, 0, v240
    v_sub_f32 v148, 0, v240
    v_sub_f32 v149, 0, v240
    v_sub_f32 v150, 0, v240
    v_sub_f32 v151, 0, v240
    v_sub_f32 v152, 0, v240
    v_sub_f32 v153, 0, v240
    v_sub_f32 v154, 0, v240
    v_sub_f32 v155, 0, v240
    v_sub_f32 v156, 0, v240
    v_sub_f32 v157, 0, v240
    v_sub_f32 v158, 0, v240
    v_sub_f32 v159, 0, v240
    s_nop 1
    s_branch L_parallel_sum__sliding_block__mixer_token_mlp__prompt_kernel_ck_b1
L_parallel_sum__sliding_block__mixer_token_mlp__prompt_kernel_ck_rare1:
    v_max_f32 v248, 0, v248
    v_sub_f32 v249, 0, v248
    v_exp_f32 v249, v249
    s_nop 7
    v_mul_f32 v192, v192, v249
    v_mul_f32 v193, v193, v249
    v_mul_f32 v194, v194, v249
    v_mul_f32 v195, v195, v249
    v_mul_f32 v196, v196, v249
    v_mul_f32 v197, v197, v249
    v_mul_f32 v198, v198, v249
    v_mul_f32 v199, v199, v249
    v_mul_f32 v200, v200, v249
    v_mul_f32 v201, v201, v249
    v_mul_f32 v202, v202, v249
    v_mul_f32 v203, v203, v249
    v_mul_f32 v204, v204, v249
    v_mul_f32 v205, v205, v249
    v_mul_f32 v206, v206, v249
    v_mul_f32 v207, v207, v249
    v_mul_f32 v160, v160, v249
L_parallel_sum__sliding_block__mixer_token_mlp__prompt_kernel_ck_shift1:
    v_add_f32 v240, v240, v248
    v_sub_f32 v16, v16, v248
    v_sub_f32 v17, v17, v248
    v_sub_f32 v18, v18, v248
    v_sub_f32 v19, v19, v248
    v_sub_f32 v20, v20, v248
    v_sub_f32 v21, v21, v248
    v_sub_f32 v22, v22, v248
    v_sub_f32 v23, v23, v248
    v_sub_f32 v24, v24, v248
    v_sub_f32 v25, v25, v248
    v_sub_f32 v26, v26, v248
    v_sub_f32 v27, v27, v248
    v_sub_f32 v28, v28, v248
    v_sub_f32 v29, v29, v248
    v_sub_f32 v30, v30, v248
    v_sub_f32 v31, v31, v248
    v_sub_f32 v144, 0, v240
    v_sub_f32 v145, 0, v240
    v_sub_f32 v146, 0, v240
    v_sub_f32 v147, 0, v240
    v_sub_f32 v148, 0, v240
    v_sub_f32 v149, 0, v240
    v_sub_f32 v150, 0, v240
    v_sub_f32 v151, 0, v240
    v_sub_f32 v152, 0, v240
    v_sub_f32 v153, 0, v240
    v_sub_f32 v154, 0, v240
    v_sub_f32 v155, 0, v240
    v_sub_f32 v156, 0, v240
    v_sub_f32 v157, 0, v240
    v_sub_f32 v158, 0, v240
    v_sub_f32 v159, 0, v240
    s_nop 1
    s_branch L_parallel_sum__sliding_block__mixer_token_mlp__prompt_kernel_ck_b0
L_parallel_sum__sliding_block__mixer_token_mlp__prompt_kernel_ck_pub:
    s_waitcnt vmcnt(0)
    s_mov_b64 exec, 1
    v_mov_b32 v11, 159744
    v_mov_b32 v9, 1
    ds_add_rtn_u32 v9, v11, v9
    s_waitcnt lgkmcnt(0)
    v_readfirstlane_b32 s42, v9
    s_mov_b64 exec, -1
    v_mov_b32 v9, 1
    v_lshlrev_b32 v11, 8, v1
    s_cmp_lg_u32 s42, 7
    s_cbranch_scc1 L_parallel_sum__sliding_block__mixer_token_mlp__prompt_kernel_arr0
    s_mov_b64 exec, 0x1
    buffer_atomic_add v9, v11, s[48:51], s61 offen sc1
    s_mov_b64 exec, -1
L_parallel_sum__sliding_block__mixer_token_mlp__prompt_kernel_arr0:
    s_mov_b32 s62, -1
    s_branch L_parallel_sum__sliding_block__mixer_token_mlp__prompt_kernel_ck_pubret
L_parallel_sum__sliding_block__mixer_token_mlp__prompt_kernel_ck_x:
    s_waitcnt lgkmcnt(0)
    s_nop 3
    v_mov_b32 v241, v160
    s_add_u32 s56, s56, 1
    s_cmp_eq_u32 s56, 2
    s_cbranch_scc1 L_parallel_sum__sliding_block__mixer_token_mlp__prompt_kernel_a2
    s_cmp_eq_u32 s56, 3
    s_cbranch_scc1 L_parallel_sum__sliding_block__mixer_token_mlp__prompt_kernel_a3
    s_cmp_eq_u32 s56, 4
    s_cbranch_scc1 L_parallel_sum__sliding_block__mixer_token_mlp__prompt_kernel_fin
    v_swap_b32 v176, v184
    v_swap_b32 v177, v185
    v_swap_b32 v178, v186
    v_swap_b32 v179, v187
    v_swap_b32 v180, v188
    v_swap_b32 v181, v189
    v_swap_b32 v182, v190
    v_swap_b32 v183, v191
    v_swap_b32 v192, v208
    v_swap_b32 v193, v209
    v_swap_b32 v194, v210
    v_swap_b32 v195, v211
    v_swap_b32 v196, v212
    v_swap_b32 v197, v213
    v_swap_b32 v198, v214
    v_swap_b32 v199, v215
    v_swap_b32 v200, v216
    v_swap_b32 v201, v217
    v_swap_b32 v202, v218
    v_swap_b32 v203, v219
    v_swap_b32 v204, v220
    v_swap_b32 v205, v221
    v_swap_b32 v206, v222
    v_swap_b32 v207, v223
    v_swap_b32 v240, v242
    v_swap_b32 v241, v243
    s_cmp_eq_u32 s38, 0
    s_cbranch_scc1 L_parallel_sum__sliding_block__mixer_token_mlp__prompt_kernel_nonb
    s_cmp_ge_u32 s16, 4
    s_cbranch_scc1 L_parallel_sum__sliding_block__mixer_token_mlp__prompt_kernel_nonb
    s_sub_u32 s42, s61, 4096
    s_mov_b32 s41, 262144
L_parallel_sum__sliding_block__mixer_token_mlp__prompt_kernel_pollkv:
    buffer_load_dword v9, v10, s[48:51], s42 offen sc1
    s_waitcnt vmcnt(0)
    v_readfirstlane_b32 s40, v9
    s_nop 0
    s_cmp_ge_u32 s40, 1
    s_cbranch_scc1 L_parallel_sum__sliding_block__mixer_token_mlp__prompt_kernel_pollkv_ok
    s_sleep 4
    s_sub_u32 s41, s41, 1
    s_cmp_lg_u32 s41, 0
    s_cbranch_scc1 L_parallel_sum__sliding_block__mixer_token_mlp__prompt_kernel_pollkv
L_parallel_sum__sliding_block__mixer_token_mlp__prompt_kernel_pollkv_ok:
    s_sub_u32 s42, s60, 1048576
    s_lshl_b32 s43, s16, 14
    s_add_u32 s42, s42, s43
    buffer_load_dwordx4 v[80:83], v2, s[12:15], s42 offen offset:0 sc1
    buffer_load_dwordx4 v[84:87], v2, s[12:15], s42 offen offset:1024 sc1
    buffer_load_dwordx4 v[88:91], v2, s[12:15], s42 offen offset:2048 sc1
    buffer_load_dwordx4 v[92:95], v2, s[12:15], s42 offen offset:3072 sc1
    s_add_u32 s42, s42, 4096
    buffer_load_dwordx4 v[96:99], v2, s[12:15], s42 offen offset:0 sc1
    buffer_load_dwordx4 v[100:103], v2, s[12:15], s42 offen offset:1024 sc1
    buffer_load_dwordx4 v[104:107], v2, s[12:15], s42 offen offset:2048 sc1
    buffer_load_dwordx4 v[108:111], v2, s[12:15], s42 offen offset:3072 sc1
    s_add_u32 s42, s42, 4096
    buffer_load_dwordx4 v[112:115], v2, s[12:15], s42 offen offset:0 sc1
    buffer_load_dwordx4 v[116:119], v2, s[12:15], s42 offen offset:1024 sc1
    buffer_load_dwordx4 v[120:123], v2, s[12:15], s42 offen offset:2048 sc1
    buffer_load_dwordx4 v[124:127], v2, s[12:15], s42 offen offset:3072 sc1
    s_add_u32 s42, s42, 4096
    buffer_load_dwordx4 v[128:131], v2, s[12:15], s42 offen offset:0 sc1
    buffer_load_dwordx4 v[132:135], v2, s[12:15], s42 offen offset:1024 sc1
    buffer_load_dwordx4 v[136:139], v2, s[12:15], s42 offen offset:2048 sc1
    buffer_load_dwordx4 v[140:143], v2, s[12:15], s42 offen offset:3072 sc1
L_parallel_sum__sliding_block__mixer_token_mlp__prompt_kernel_nonb:
    s_add_u32 s52, s24, 1
    s_lshl_b32 s42, s24, 12
    s_add_u32 s42, s42, 32768
    v_add_u32 v3, s42, v8
    s_branch L_parallel_sum__sliding_block__mixer_token_mlp__prompt_kernel_chunk
L_parallel_sum__sliding_block__mixer_token_mlp__prompt_kernel_a2:
    s_cmp_eq_u32 s38, 0
    s_cbranch_scc1 L_parallel_sum__sliding_block__mixer_token_mlp__prompt_kernel_fin0
    v_sub_f32 v224, v254, v224
    v_sub_f32 v225, v254, v225
    v_sub_f32 v226, v254, v226
    v_sub_f32 v227, v254, v227
    v_sub_f32 v228, v254, v228
    v_sub_f32 v229, v254, v229
    v_sub_f32 v230, v254, v230
    v_sub_f32 v231, v254, v231
    v_sub_f32 v232, v254, v232
    v_sub_f32 v233, v254, v233
    v_sub_f32 v234, v254, v234
    v_sub_f32 v235, v254, v235
    v_sub_f32 v236, v254, v236
    v_sub_f32 v237, v254, v237
    v_sub_f32 v238, v254, v238
    v_sub_f32 v239, v254, v239
    s_cmp_ge_u32 s16, 4
    s_cbranch_scc1 L_parallel_sum__sliding_block__mixer_token_mlp__prompt_kernel_nost
    s_lshr_b32 s42, s16, 1
    s_lshl_b32 s42, s42, 16
    s_and_b32 s43, s16, 1
    s_lshl_b32 s43, s43, 14
    s_add_u32 s42, s42, s43
    v_add_u32 v9, s42, v2
    s_waitcnt vmcnt(15)
    ds_write_b128 v9, v[80:83] offset:0
    s_waitcnt vmcnt(14)
    ds_write_b128 v9, v[84:87] offset:1024
    s_waitcnt vmcnt(13)
    ds_write_b128 v9, v[88:91] offset:2048
    s_waitcnt vmcnt(12)
    ds_write_b128 v9, v[92:95] offset:3072
    s_waitcnt vmcnt(11)
    ds_write_b128 v9, v[96:99] offset:4096
    s_waitcnt vmcnt(10)
    ds_write_b128 v9, v[100:103] offset:5120
    s_waitcnt vmcnt(9)
    ds_write_b128 v9, v[104:107] offset:6144
    s_waitcnt vmcnt(8)
    ds_write_b128 v9, v[108:111] offset:7168
    s_waitcnt vmcnt(7)
    ds_write_b128 v9, v[112:115] offset:8192
    s_waitcnt vmcnt(6)
    ds_write_b128 v9, v[116:119] offset:9216
    s_waitcnt vmcnt(5)
    ds_write_b128 v9, v[120:123] offset:10240
    s_waitcnt vmcnt(4)
    ds_write_b128 v9, v[124:127] offset:11264
    s_waitcnt vmcnt(3)
    ds_write_b128 v9, v[128:131] offset:12288
    s_waitcnt vmcnt(2)
    ds_write_b128 v9, v[132:135] offset:13312
    s_waitcnt vmcnt(1)
    ds_write_b128 v9, v[136:139] offset:14336
    s_waitcnt vmcnt(0)
    ds_write_b128 v9, v[140:143] offset:15360
L_parallel_sum__sliding_block__mixer_token_mlp__prompt_kernel_nost:
    s_sub_u32 s52, 8, s24
    s_mov_b32 s53, 4096
    s_lshl_b32 s42, s24, 12
    v_add_u32 v3, s42, v8
    s_waitcnt lgkmcnt(0)
    s_barrier
    s_load_dwordx2 s[40:41], s[0:1], 48
    s_load_dwordx2 s[42:43], s[0:1], 16
    v_lshlrev_b32 v12, 7, v1
    s_lshl_b32 s17, s69, 3
    s_add_u32 s17, s17, s16
    s_lshl_b32 s18, s17, 13
    s_mov_b32 s20, 0
    s_cmp_ge_u32 s17, 256
    s_cselect_b32 s20, 0, s20
    s_cmp_ge_u32 s17, 576
    s_cselect_b32 s20, 2097152, s20
    s_cmp_ge_u32 s17, 896
    s_cselect_b32 s20, 4194304, s20
    s_cmp_ge_u32 s17, 960
    s_cselect_b32 s20, 6291456, s20
    s_cmp_ge_u32 s17, 1024
    s_cselect_b32 s20, 67108864, s20
    s_waitcnt lgkmcnt(0)
    s_cmp_lt_u32 s17, 256
    s_cselect_b32 s4, s42, s40
    s_cselect_b32 s5, s43, s41
    s_mov_b32 s6, 14680064
    s_cselect_b32 s6, 2097152, s6
    s_and_b32 s5, s5, 0xffff
    s_mov_b32 s7, 0x20000
    s_add_u32 s18, s18, s20
    buffer_load_dword v13, v12, s[4:7], s18 offen
    s_branch L_parallel_sum__sliding_block__mixer_token_mlp__prompt_kernel_chunk
L_parallel_sum__sliding_block__mixer_token_mlp__prompt_kernel_a3:
    v_swap_b32 v176, v184
    v_swap_b32 v177, v185
    v_swap_b32 v178, v186
    v_swap_b32 v179, v187
    v_swap_b32 v180, v188
    v_swap_b32 v181, v189
    v_swap_b32 v182, v190
    v_swap_b32 v183, v191
    v_swap_b32 v192, v208
    v_swap_b32 v193, v209
    v_swap_b32 v194, v210
    v_swap_b32 v195, v211
    v_swap_b32 v196, v212
    v_swap_b32 v197, v213
    v_swap_b32 v198, v214
    v_swap_b32 v199, v215
    v_swap_b32 v200, v216
    v_swap_b32 v201, v217
    v_swap_b32 v202, v218
    v_swap_b32 v203, v219
    v_swap_b32 v204, v220
    v_swap_b32 v205, v221
    v_swap_b32 v206, v222
    v_swap_b32 v207, v223
    v_swap_b32 v240, v242
    v_swap_b32 v241, v243
    s_sub_u32 s52, 8, s57
    s_lshl_b32 s42, s57, 12
    v_add_u32 v3, s42, v8
    s_branch L_parallel_sum__sliding_block__mixer_token_mlp__prompt_kernel_chunk
L_parallel_sum__sliding_block__mixer_token_mlp__prompt_kernel_fin0:
    s_load_dwordx2 s[40:41], s[0:1], 48
    s_load_dwordx2 s[42:43], s[0:1], 16
    v_lshlrev_b32 v12, 7, v1
    s_lshl_b32 s17, s69, 3
    s_add_u32 s17, s17, s16
    s_lshl_b32 s18, s17, 13
    s_mov_b32 s20, 0
    s_cmp_ge_u32 s17, 256
    s_cselect_b32 s20, 0, s20
    s_cmp_ge_u32 s17, 576
    s_cselect_b32 s20, 2097152, s20
    s_cmp_ge_u32 s17, 896
    s_cselect_b32 s20, 4194304, s20
    s_cmp_ge_u32 s17, 960
    s_cselect_b32 s20, 6291456, s20
    s_cmp_ge_u32 s17, 1024
    s_cselect_b32 s20, 67108864, s20
    s_waitcnt lgkmcnt(0)
    s_cmp_lt_u32 s17, 256
    s_cselect_b32 s4, s42, s40
    s_cselect_b32 s5, s43, s41
    s_mov_b32 s6, 14680064
    s_cselect_b32 s6, 2097152, s6
    s_and_b32 s5, s5, 0xffff
    s_mov_b32 s7, 0x20000
    s_add_u32 s18, s18, s20
    buffer_load_dword v13, v12, s[4:7], s18 offen
    v_swap_b32 v176, v184
    v_swap_b32 v177, v185
    v_swap_b32 v178, v186
    v_swap_b32 v179, v187
    v_swap_b32 v180, v188
    v_swap_b32 v181, v189
    v_swap_b32 v182, v190
    v_swap_b32 v183, v191
    v_swap_b32 v192, v208
    v_swap_b32 v193, v209
    v_swap_b32 v194, v210
    v_swap_b32 v195, v211
    v_swap_b32 v196, v212
    v_swap_b32 v197, v213
    v_swap_b32 v198, v214
    v_swap_b32 v199, v215
    v_swap_b32 v200, v216
    v_swap_b32 v201, v217
    v_swap_b32 v202, v218
    v_swap_b32 v203, v219
    v_swap_b32 v204, v220
    v_swap_b32 v205, v221
    v_swap_b32 v206, v222
    v_swap_b32 v207, v223
    v_swap_b32 v240, v242
    v_swap_b32 v241, v243
L_parallel_sum__sliding_block__mixer_token_mlp__prompt_kernel_fin:
    s_lshl_b32 s40, s39, 1
    s_add_u32 s40, s40, s25
    s_lshl_b32 s40, s40, 11
    s_lshl_b32 s41, s38, 19
    s_add_u32 s40, s40, s41
    v_rcp_f32 v9, v241
    s_lshl_b32 s41, s57, 16
    s_add_u32 s41, s41, s40
    v_mul_f32 v192, v192, v9
    v_mul_f32 v193, v193, v9
    v_mul_f32 v194, v194, v9
    v_mul_f32 v195, v195, v9
    v_mul_f32 v196, v196, v9
    v_mul_f32 v197, v197, v9
    v_mul_f32 v198, v198, v9
    v_mul_f32 v199, v199, v9
    v_mul_f32 v200, v200, v9
    v_mul_f32 v201, v201, v9
    v_mul_f32 v202, v202, v9
    v_mul_f32 v203, v203, v9
    v_mul_f32 v204, v204, v9
    v_mul_f32 v205, v205, v9
    v_mul_f32 v206, v206, v9
    v_mul_f32 v207, v207, v9
    v_cvt_pk_bf16_f32 v192, v192, v193
    v_cvt_pk_bf16_f32 v193, v194, v195
    v_cvt_pk_bf16_f32 v194, v196, v197
    v_cvt_pk_bf16_f32 v195, v198, v199
    v_cvt_pk_bf16_f32 v196, v200, v201
    v_cvt_pk_bf16_f32 v197, v202, v203
    v_cvt_pk_bf16_f32 v198, v204, v205
    v_cvt_pk_bf16_f32 v199, v206, v207
    buffer_store_dwordx4 v[192:195], v2, s[44:47], s41 offen offset:0 sc1
    buffer_store_dwordx4 v[196:199], v2, s[44:47], s41 offen offset:1024 sc1
    v_rcp_f32 v9, v243
    s_lshl_b32 s41, s24, 16
    s_add_u32 s41, s41, s40
    v_mul_f32 v208, v208, v9
    v_mul_f32 v209, v209, v9
    v_mul_f32 v210, v210, v9
    v_mul_f32 v211, v211, v9
    v_mul_f32 v212, v212, v9
    v_mul_f32 v213, v213, v9
    v_mul_f32 v214, v214, v9
    v_mul_f32 v215, v215, v9
    v_mul_f32 v216, v216, v9
    v_mul_f32 v217, v217, v9
    v_mul_f32 v218, v218, v9
    v_mul_f32 v219, v219, v9
    v_mul_f32 v220, v220, v9
    v_mul_f32 v221, v221, v9
    v_mul_f32 v222, v222, v9
    v_mul_f32 v223, v223, v9
    v_cvt_pk_bf16_f32 v208, v208, v209
    v_cvt_pk_bf16_f32 v209, v210, v211
    v_cvt_pk_bf16_f32 v210, v212, v213
    v_cvt_pk_bf16_f32 v211, v214, v215
    v_cvt_pk_bf16_f32 v212, v216, v217
    v_cvt_pk_bf16_f32 v213, v218, v219
    v_cvt_pk_bf16_f32 v214, v220, v221
    v_cvt_pk_bf16_f32 v215, v222, v223
    buffer_store_dwordx4 v[208:211], v2, s[44:47], s41 offen offset:0 sc1
    buffer_store_dwordx4 v[212:215], v2, s[44:47], s41 offen offset:1024 sc1
    s_lshr_b32 s69, s60, 16
    s_lshl_b32 s63, s69, 7
    s_add_u32 s63, s63, 49152
    s_mov_b64 s[58:59], 1
    s_mov_b32 s62, 1
    s_mov_b32 s61, 0
    s_branch L_parallel_sum__sliding_block__mixer_token_mlp__prompt_kernel_p2
L_parallel_sum__sliding_block__mixer_token_mlp__prompt_kernel_lnw:
    s_sub_u32 s70, s2, 128
    s_cmp_lt_u32 s2, 112
    s_cselect_b32 s70, s2, s70
    s_cmp_ge_u32 s37, 7
    s_cselect_b32 s38, 1, 0
    s_mul_i32 s39, s38, 7
    s_sub_u32 s39, s37, s39
    s_and_b32 s40, s36, 1
    s_lshl_b32 s40, s40, 1
    s_add_u32 s38, s38, s40
    s_lshr_b32 s40, s36, 1
    s_mul_i32 s40, s40, 7
    s_add_u32 s39, s39, s40
    s_lshl_b32 s76, s39, 8
    s_waitcnt lgkmcnt(0)
    v_lshlrev_b32 v3, 4, v1
    s_lshl_b32 s17, s70, 4
    s_lshl_b32 s18, s16, 1
    s_add_u32 s17, s17, s18
    s_lshl_b32 s18, s17, 11
    s_mov_b32 s8, s72
    s_and_b32 s9, s73, 0xffff
    s_mov_b32 s10, 4194304
    s_mov_b32 s11, 0x20000
    buffer_load_dwordx4 v[4:7], v3, s[8:11], s18 offen offset:0
    buffer_load_dwordx4 v[8:11], v3, s[8:11], s18 offen offset:1024
    buffer_load_dwordx4 v[48:51], v3, s[8:11], s18 offen offset:2048
    buffer_load_dwordx4 v[52:55], v3, s[8:11], s18 offen offset:3072
    s_add_u32 s44, s28, 52428800
    s_addc_u32 s45, s29, 0
    s_and_b32 s45, s45, 0xffff
    s_mov_b32 s46, 32768
    s_mov_b32 s47, 0x20000
    s_lshl_b32 s41, s70, 8
    v_mov_b32 v56, 0
    buffer_load_dword v58, v56, s[44:47], s41 offen sc1
    s_add_u32 s44, s28, 50331648
    s_addc_u32 s45, s29, 0
    s_and_b32 s45, s45, 0xffff
    s_mov_b32 s46, 131072
    s_mov_b32 s47, 0x20000
    s_lshl_b32 s40, s70, 3
    s_add_u32 s40, s40, s16
    s_lshl_b32 s41, s40, 7
    v_and_b32 v59, 31, v1
    v_lshlrev_b32 v59, 2, v59
    buffer_store_dword v56, v59, s[44:47], s41 offen sc1
    s_mov_b32 s44, s30
    s_and_b32 s45, s31, 0xffff
    s_mov_b32 s46, 6291456
    s_mov_b32 s47, 0x20000
    v_lshrrev_b32 v64, 5, v1
    v_lshl_add_u32 v65, v64, 11, v59
    v_mul_u32_u24 v64, 49152, v64
    v_add_u32 v64, v64, v59
    v_add_u32 v64, 4096, v64
    s_lshr_b32 s41, s70, 4
    s_lshl_b32 s41, s41, 3
    s_add_u32 s41, s41, s16
    s_mul_i32 s41, s41, 98304
    s_and_b32 s42, s70, 15
    s_lshl_b32 s42, s42, 7
    s_add_u32 s41, s41, s42
    buffer_load_dword v72, v65, s[44:47], s41 offen
    buffer_load_dword v88, v64, s[44:47], s41 offen
    s_add_u32 s41, s41, 6144
    buffer_load_dword v73, v65, s[44:47], s41 offen
    buffer_load_dword v89, v64, s[44:47], s41 offen
    s_add_u32 s41, s41, 6144
    buffer_load_dword v74, v65, s[44:47], s41 offen
    buffer_load_dword v90, v64, s[44:47], s41 offen
    s_add_u32 s41, s41, 6144
    buffer_load_dword v75, v65, s[44:47], s41 offen
    buffer_load_dword v91, v64, s[44:47], s41 offen
    s_add_u32 s41, s41, 6144
    buffer_load_dword v76, v65, s[44:47], s41 offen
    buffer_load_dword v92, v64, s[44:47], s41 offen
    s_add_u32 s41, s41, 6144
    buffer_load_dword v77, v65, s[44:47], s41 offen
    buffer_load_dword v93, v64, s[44:47], s41 offen
    s_add_u32 s41, s41, 6144
    buffer_load_dword v78, v65, s[44:47], s41 offen
    buffer_load_dword v94, v64, s[44:47], s41 offen
    s_add_u32 s41, s41, 6144
    buffer_load_dword v79, v65, s[44:47], s41 offen
    buffer_load_dword v95, v64, s[44:47], s41 offen
    s_add_u32 s41, s41, 6144
    buffer_load_dword v80, v65, s[44:47], s41 offen
    s_add_u32 s41, s41, 6144
    buffer_load_dword v81, v65, s[44:47], s41 offen
    s_add_u32 s41, s41, 6144
    buffer_load_dword v82, v65, s[44:47], s41 offen
    s_add_u32 s41, s41, 6144
    buffer_load_dword v83, v65, s[44:47], s41 offen
    s_add_u32 s41, s41, 6144
    buffer_load_dword v84, v65, s[44:47], s41 offen
    s_add_u32 s41, s41, 6144
    buffer_load_dword v85, v65, s[44:47], s41 offen
    s_add_u32 s41, s41, 6144
    buffer_load_dword v86, v65, s[44:47], s41 offen
    s_add_u32 s41, s41, 6144
    buffer_load_dword v87, v65, s[44:47], s41 offen
    s_add_u32 s41, s41, 6144
    s_add_u32 s12, s28, 4194304
    s_addc_u32 s13, s29, 0
    s_and_b32 s13, s13, 0xffff
    s_mov_b32 s14, 4194304
    s_mov_b32 s15, 0x20000
    s_add_u32 s44, s28, 51380224
    s_addc_u32 s45, s29, 0
    s_and_b32 s45, s45, 0xffff
    s_mov_b32 s46, 32768
    s_mov_b32 s47, 0x20000
    s_mov_b32 s20, 0xffff0000
    s_mov_b32 s21, 0x3a800000
    s_mov_b32 s22, 0x3727c5ac
    s_lshl_b32 s19, s16, 12
    v_add_u32 v12, s19, v3
    s_lshl_b32 s19, s17, 2
    v_mov_b32 v56, 0
    s_waitcnt vmcnt(26)
    s_and_b32 s50, s16, 3
    v_lshlrev_b32 v104, 4, v1
    v_lshrrev_b32 v105, 4, v1
    v_and_b32 v106, 15, v1
    s_mul_i32 s27, s50, 16
    s_mov_b32 s3, 7168
    v_add_u32 v107, 0, v105
    v_add_u32 v108, s27, v107
    v_bfe_u32 v100, v108, 3, 1
    v_and_b32 v108, 3, v108
    v_lshlrev_b32 v108, 2, v108
    v_lshl_add_u32 v108, v100, 1, v108
    v_xor_b32 v108, v108, v106
    v_lshlrev_b32 v108, 4, v108
    v_mul_lo_u32 v107, v107, s3
    v_add_u32 v100, v107, v108
    v_add_u32 v107, 4, v105
    v_add_u32 v108, s27, v107
    v_bfe_u32 v101, v108, 3, 1
    v_and_b32 v108, 3, v108
    v_lshlrev_b32 v108, 2, v108
    v_lshl_add_u32 v108, v101, 1, v108
    v_xor_b32 v108, v108, v106
    v_lshlrev_b32 v108, 4, v108
    v_mul_lo_u32 v107, v107, s3
    v_add_u32 v101, v107, v108
    v_subrev_u32 v101, 1024, v101
    v_add_u32 v107, 8, v105
    v_add_u32 v108, s27, v107
    v_bfe_u32 v102, v108, 3, 1
    v_and_b32 v108, 3, v108
    v_lshlrev_b32 v108, 2, v108
    v_lshl_add_u32 v108, v102, 1, v108
    v_xor_b32 v108, v108, v106
    v_lshlrev_b32 v108, 4, v108
    v_mul_lo_u32 v107, v107, s3
    v_add_u32 v102, v107, v108
    v_subrev_u32 v102, 2048, v102
    v_add_u32 v107, 12, v105
    v_add_u32 v108, s27, v107
    v_bfe_u32 v103, v108, 3, 1
    v_and_b32 v108, 3, v108
    v_lshlrev_b32 v108, 2, v108
    v_lshl_add_u32 v108, v103, 1, v108
    v_xor_b32 v108, v108, v106
    v_lshlrev_b32 v108, 4, v108
    v_mul_lo_u32 v107, v107, s3
    v_add_u32 v103, v107, v108
    v_subrev_u32 v103, 3072, v103
    s_mul_i32 s52, s50, 8192
    s_mul_i32 s53, s50, 4096
    s_add_u32 s53, s53, 32768
    s_mov_b32 s56, s32
    s_and_b32 s57, s33, 0xffff
    s_mov_b32 s58, 14680064
    s_mov_b32 s59, 0x20000
    s_mul_i32 s54, s50, 114688
    s_add_u32 s54, s54, s76
    s_cmp_ge_u32 s2, 112
    s_cbranch_scc1 L_parallel_sum__sliding_block__mixer_token_mlp__prompt_kernel_nowe
    s_cmp_lt_u32 s16, 4
    s_cbranch_scc1 L_parallel_sum__sliding_block__mixer_token_mlp__prompt_kernel_nowe
    s_add_u32 m0, s53, 0
    s_nop 0
    buffer_load_dwordx4 v100, s[56:59], s54 offen offset:0 lds
    buffer_load_dwordx4 v101, s[56:59], s54 offen offset:1024 lds
    buffer_load_dwordx4 v102, s[56:59], s54 offen offset:2048 lds
    buffer_load_dwordx4 v103, s[56:59], s54 offen offset:3072 lds
    s_add_u32 s54, s54, 458752
    s_add_u32 m0, s53, 49152
    s_nop 0
    buffer_load_dwordx4 v100, s[56:59], s54 offen offset:0 lds
    buffer_load_dwordx4 v101, s[56:59], s54 offen offset:1024 lds
    buffer_load_dwordx4 v102, s[56:59], s54 offen offset:2048 lds
    buffer_load_dwordx4 v103, s[56:59], s54 offen offset:3072 lds
    s_add_u32 s54, s54, 458752
    s_add_u32 m0, s53, 98304
    s_nop 0
    buffer_load_dwordx4 v100, s[56:59], s54 offen offset:0 lds
    buffer_load_dwordx4 v101, s[56:59], s54 offen offset:1024 lds
    buffer_load_dwordx4 v102, s[56:59], s54 offen offset:2048 lds
    buffer_load_dwordx4 v103, s[56:59], s54 offen offset:3072 lds
    s_add_u32 s54, s54, 458752
L_parallel_sum__sliding_block__mixer_token_mlp__prompt_kernel_nowe:
    v_lshlrev_b32 v16, 16, v4
    v_lshlrev_b32 v112, 16, v48
    v_and_b32 v17, s20, v4
    v_and_b32 v113, s20, v48
    v_lshlrev_b32 v18, 16, v5
    v_lshlrev_b32 v114, 16, v49
    v_and_b32 v19, s20, v5
    v_and_b32 v115, s20, v49
    v_lshlrev_b32 v20, 16, v6
    v_lshlrev_b32 v116, 16, v50
    v_and_b32 v21, s20, v6
    v_and_b32 v117, s20, v50
    v_lshlrev_b32 v22, 16, v7
    v_lshlrev_b32 v118, 16, v51
    v_and_b32 v23, s20, v7
    v_and_b32 v119, s20, v51
    v_lshlrev_b32 v24, 16, v8
    v_lshlrev_b32 v120, 16, v52
    v_and_b32 v25, s20, v8
    v_and_b32 v121, s20, v52
    v_lshlrev_b32 v26, 16, v9
    v_lshlrev_b32 v122, 16, v53
    v_and_b32 v27, s20, v9
    v_and_b32 v123, s20, v53
    v_lshlrev_b32 v28, 16, v10
    v_lshlrev_b32 v124, 16, v54
    v_and_b32 v29, s20, v10
    v_and_b32 v125, s20, v54
    v_lshlrev_b32 v30, 16, v11
    v_lshlrev_b32 v126, 16, v55
    v_and_b32 v31, s20, v11
    v_and_b32 v127, s20, v55
    v_add_f32 v32, v16, v24
    v_add_f32 v128, v112, v120
    v_add_f32 v33, v17, v25
    v_add_f32 v129, v113, v121
    v_add_f32 v34, v18, v26
    v_add_f32 v130, v114, v122
    v_add_f32 v35, v19, v27
    v_add_f32 v131, v115, v123
    v_add_f32 v36, v20, v28
    v_add_f32 v132, v116, v124
    v_add_f32 v37, v21, v29
    v_add_f32 v133, v117, v125
    v_add_f32 v38, v22, v30
    v_add_f32 v134, v118, v126
    v_add_f32 v39, v23, v31
    v_add_f32 v135, v119, v127
    v_add_f32 v32, v32, v36
    v_add_f32 v128, v128, v132
    v_add_f32 v33, v33, v37
    v_add_f32 v129, v129, v133
    v_add_f32 v34, v34, v38
    v_add_f32 v130, v130, v134
    v_add_f32 v35, v35, v39
    v_add_f32 v131, v131, v135
    v_add_f32 v32, v32, v34
    v_add_f32 v128, v128, v130
    v_add_f32 v33, v33, v35
    v_add_f32 v129, v129, v131
    v_add_f32 v32, v32, v33
    v_add_f32 v128, v128, v129
    s_nop 0
    v_add_f32_dpp v32, v32, v32 quad_perm:[1,0,3,2] row_mask:0xf bank_mask:0xf
    v_add_f32_dpp v128, v128, v128 quad_perm:[1,0,3,2] row_mask:0xf bank_mask:0xf
    s_nop 0
    v_add_f32_dpp v32, v32, v32 quad_perm:[2,3,0,1] row_mask:0xf bank_mask:0xf
    v_add_f32_dpp v128, v128, v128 quad_perm:[2,3,0,1] row_mask:0xf bank_mask:0xf
    s_nop 0
    v_add_f32_dpp v32, v32, v32 row_half_mirror row_mask:0xf bank_mask:0xf
    v_add_f32_dpp v128, v128, v128 row_half_mirror row_mask:0xf bank_mask:0xf
    s_nop 0
    v_add_f32_dpp v32, v32, v32 row_mirror row_mask:0xf bank_mask:0xf
    v_add_f32_dpp v128, v128, v128 row_mirror row_mask:0xf bank_mask:0xf
    s_nop 0
    v_add_f32_dpp v32, v32, v32 row_bcast:15 row_mask:0xa bank_mask:0xf
    v_add_f32_dpp v128, v128, v128 row_bcast:15 row_mask:0xa bank_mask:0xf
    s_nop 0
    v_add_f32_dpp v32, v32, v32 row_bcast:31 row_mask:0xc bank_mask:0xf
    v_add_f32_dpp v128, v128, v128 row_bcast:31 row_mask:0xc bank_mask:0xf
    v_readlane_b32 s24, v32, 63
    v_readlane_b32 s26, v128, 63
    s_nop 0
    v_mov_b32 v13, s24
    v_mov_b32 v144, s26
    v_mul_f32 v13, s21, v13
    v_mul_f32 v144, s21, v144
    v_sub_f32 v32, v16, v13
    v_sub_f32 v128, v112, v144
    v_sub_f32 v33, v17, v13
    v_sub_f32 v129, v113, v144
    v_sub_f32 v34, v18, v13
    v_sub_f32 v130, v114, v144
    v_sub_f32 v35, v19, v13
    v_sub_f32 v131, v115, v144
    v_sub_f32 v36, v20, v13
    v_sub_f32 v132, v116, v144
    v_sub_f32 v37, v21, v13
    v_sub_f32 v133, v117, v144
    v_sub_f32 v38, v22, v13
    v_sub_f32 v134, v118, v144
    v_sub_f32 v39, v23, v13
    v_sub_f32 v135, v119, v144
    v_sub_f32 v40, v24, v13
    v_sub_f32 v136, v120, v144
    v_sub_f32 v41, v25, v13
    v_sub_f32 v137, v121, v144
    v_sub_f32 v42, v26, v13
    v_sub_f32 v138, v122, v144
    v_sub_f32 v43, v27, v13
    v_sub_f32 v139, v123, v144
    v_sub_f32 v44, v28, v13
    v_sub_f32 v140, v124, v144
    v_sub_f32 v45, v29, v13
    v_sub_f32 v141, v125, v144
    v_sub_f32 v46, v30, v13
    v_sub_f32 v142, v126, v144
    v_sub_f32 v47, v31, v13
    v_sub_f32 v143, v127, v144
    v_mul_f32 v14, v32, v32
    v_mul_f32 v145, v128, v128
    v_mul_f32 v15, v33, v33
    v_mul_f32 v146, v129, v129
    v_fmac_f32 v14, v34, v34
    v_fmac_f32 v145, v130, v130
    v_fmac_f32 v15, v35, v35
    v_fmac_f32 v146, v131, v131
    v_fmac_f32 v14, v36, v36
    v_fmac_f32 v145, v132, v132
    v_fmac_f32 v15, v37, v37
    v_fmac_f32 v146, v133, v133
    v_fmac_f32 v14, v38, v38
    v_fmac_f32 v145, v134, v134
    v_fmac_f32 v15, v39, v39
    v_fmac_f32 v146, v135, v135
    v_fmac_f32 v14, v40, v40
    v_fmac_f32 v145, v136, v136
    v_fmac_f32 v15, v41, v41
    v_fmac_f32 v146, v137, v137
    v_fmac_f32 v14, v42, v42
    v_fmac_f32 v145, v138, v138
    v_fmac_f32 v15, v43, v43
    v_fmac_f32 v146, v139, v139
    v_fmac_f32 v14, v44, v44
    v_fmac_f32 v145, v140, v140
    v_fmac_f32 v15, v45, v45
    v_fmac_f32 v146, v141, v141
    v_fmac_f32 v14, v46, v46
    v_fmac_f32 v145, v142, v142
    v_fmac_f32 v15, v47, v47
    v_fmac_f32 v146, v143, v143
    v_add_f32 v14, v14, v15
    v_add_f32 v145, v145, v146
    s_nop 0
    v_add_f32_dpp v14, v14, v14 quad_perm:[1,0,3,2] row_mask:0xf bank_mask:0xf
    v_add_f32_dpp v145, v145, v145 quad_perm:[1,0,3,2] row_mask:0xf bank_mask:0xf
    s_nop 0
    v_add_f32_dpp v14, v14, v14 quad_perm:[2,3,0,1] row_mask:0xf bank_mask:0xf
    v_add_f32_dpp v145, v145, v145 quad_perm:[2,3,0,1] row_mask:0xf bank_mask:0xf
    s_nop 0
    v_add_f32_dpp v14, v14, v14 row_half_mirror row_mask:0xf bank_mask:0xf
    v_add_f32_dpp v145, v145, v145 row_half_mirror row_mask:0xf bank_mask:0xf
    s_nop 0
    v_add_f32_dpp v14, v14, v14 row_mirror row_mask:0xf bank_mask:0xf
    v_add_f32_dpp v145, v145, v145 row_mirror row_mask:0xf bank_mask:0xf
    s_nop 0
    v_add_f32_dpp v14, v14, v14 row_bcast:15 row_mask:0xa bank_mask:0xf
    v_add_f32_dpp v145, v145, v145 row_bcast:15 row_mask:0xa bank_mask:0xf
    s_nop 0
    v_add_f32_dpp v14, v14, v14 row_bcast:31 row_mask:0xc bank_mask:0xf
    v_add_f32_dpp v145, v145, v145 row_bcast:31 row_mask:0xc bank_mask:0xf
    v_readlane_b32 s25, v14, 63
    v_readlane_b32 s27, v145, 63
    s_nop 0
    v_mov_b32 v14, s25
    v_mov_b32 v145, s27
    v_mul_f32 v14, s21, v14
    v_mul_f32 v145, s21, v145
    v_cvt_pk_bf16_f32 v15, v13, v14
    v_cvt_pk_bf16_f32 v146, v144, v145
    v_lshlrev_b32 v13, 16, v15
    v_lshlrev_b32 v144, 16, v146
    v_and_b32 v14, s20, v15
    v_and_b32 v145, s20, v146
    v_add_f32 v14, s22, v14
    v_add_f32 v145, s22, v145
    v_cvt_pk_bf16_f32 v14, v14, v14
    v_cvt_pk_bf16_f32 v145, v145, v145
    v_and_b32 v14, s20, v14
    v_and_b32 v145, s20, v145
    v_sqrt_f32 v14, v14
    v_sqrt_f32 v145, v145
    v_cvt_pk_bf16_f32 v14, v14, v14
    v_cvt_pk_bf16_f32 v145, v145, v145
    v_and_b32 v14, s20, v14
    v_and_b32 v145, s20, v145
    v_rcp_f32 v15, v14
    v_rcp_f32 v146, v145
    v_fma_f32 v2, -v14, v15, 1.0
    v_fma_f32 v147, -v145, v146, 1.0
    v_fma_f32 v15, v2, v15, v15
    v_fma_f32 v146, v147, v146, v146
    v_sub_f32 v148, 0, v13
    v_sub_f32 v149, 0, v144
    v_mov_b32 v150, v15
    v_mov_b32 v151, v146
    v_sub_f32 v32, v16, v13
    v_sub_f32 v128, v112, v144
    v_sub_f32 v33, v17, v13
    v_sub_f32 v129, v113, v144
    v_sub_f32 v34, v18, v13
    v_sub_f32 v130, v114, v144
    v_sub_f32 v35, v19, v13
    v_sub_f32 v131, v115, v144
    v_sub_f32 v36, v20, v13
    v_sub_f32 v132, v116, v144
    v_sub_f32 v37, v21, v13
    v_sub_f32 v133, v117, v144
    v_sub_f32 v38, v22, v13
    v_sub_f32 v134, v118, v144
    v_sub_f32 v39, v23, v13
    v_sub_f32 v135, v119, v144
    v_sub_f32 v40, v24, v13
    v_sub_f32 v136, v120, v144
    v_sub_f32 v41, v25, v13
    v_sub_f32 v137, v121, v144
    v_sub_f32 v42, v26, v13
    v_sub_f32 v138, v122, v144
    v_sub_f32 v43, v27, v13
    v_sub_f32 v139, v123, v144
    v_sub_f32 v44, v28, v13
    v_sub_f32 v140, v124, v144
    v_sub_f32 v45, v29, v13
    v_sub_f32 v141, v125, v144
    v_sub_f32 v46, v30, v13
    v_sub_f32 v142, v126, v144
    v_sub_f32 v47, v31, v13
    v_sub_f32 v143, v127, v144
    v_cvt_pk_bf16_f32 v4, v32, v33
    v_cvt_pk_bf16_f32 v48, v128, v129
    v_cvt_pk_bf16_f32 v5, v34, v35
    v_cvt_pk_bf16_f32 v49, v130, v131
    v_cvt_pk_bf16_f32 v6, v36, v37
    v_cvt_pk_bf16_f32 v50, v132, v133
    v_cvt_pk_bf16_f32 v7, v38, v39
    v_cvt_pk_bf16_f32 v51, v134, v135
    v_cvt_pk_bf16_f32 v8, v40, v41
    v_cvt_pk_bf16_f32 v52, v136, v137
    v_cvt_pk_bf16_f32 v9, v42, v43
    v_cvt_pk_bf16_f32 v53, v138, v139
    v_cvt_pk_bf16_f32 v10, v44, v45
    v_cvt_pk_bf16_f32 v54, v140, v141
    v_cvt_pk_bf16_f32 v11, v46, v47
    v_cvt_pk_bf16_f32 v55, v142, v143
    v_lshlrev_b32 v32, 16, v4
    v_lshlrev_b32 v128, 16, v48
    v_and_b32 v33, s20, v4
    v_and_b32 v129, s20, v48
    v_lshlrev_b32 v34, 16, v5
    v_lshlrev_b32 v130, 16, v49
    v_and_b32 v35, s20, v5
    v_and_b32 v131, s20, v49
    v_lshlrev_b32 v36, 16, v6
    v_lshlrev_b32 v132, 16, v50
    v_and_b32 v37, s20, v6
    v_and_b32 v133, s20, v50
    v_lshlrev_b32 v38, 16, v7
    v_lshlrev_b32 v134, 16, v51
    v_and_b32 v39, s20, v7
    v_and_b32 v135, s20, v51
    v_lshlrev_b32 v40, 16, v8
    v_lshlrev_b32 v136, 16, v52
    v_and_b32 v41, s20, v8
    v_and_b32 v137, s20, v52
    v_lshlrev_b32 v42, 16, v9
    v_lshlrev_b32 v138, 16, v53
    v_and_b32 v43, s20, v9
    v_and_b32 v139, s20, v53
    v_lshlrev_b32 v44, 16, v10
    v_lshlrev_b32 v140, 16, v54
    v_and_b32 v45, s20, v10
    v_and_b32 v141, s20, v54
    v_lshlrev_b32 v46, 16, v11
    v_lshlrev_b32 v142, 16, v55
    v_and_b32 v47, s20, v11
    v_and_b32 v143, s20, v55
    v_mul_f32 v32, v32, v15
    v_mul_f32 v128, v128, v146
    v_mul_f32 v33, v33, v15
    v_mul_f32 v129, v129, v146
    v_mul_f32 v34, v34, v15
    v_mul_f32 v130, v130, v146
    v_mul_f32 v35, v35, v15
    v_mul_f32 v131, v131, v146
    v_mul_f32 v36, v36, v15
    v_mul_f32 v132, v132, v146
    v_mul_f32 v37, v37, v15
    v_mul_f32 v133, v133, v146
    v_mul_f32 v38, v38, v15
    v_mul_f32 v134, v134, v146
    v_mul_f32 v39, v39, v15
    v_mul_f32 v135, v135, v146
    v_mul_f32 v40, v40, v15
    v_mul_f32 v136, v136, v146
    v_mul_f32 v41, v41, v15
    v_mul_f32 v137, v137, v146
    v_mul_f32 v42, v42, v15
    v_mul_f32 v138, v138, v146
    v_mul_f32 v43, v43, v15
    v_mul_f32 v139, v139, v146
    v_mul_f32 v44, v44, v15
    v_mul_f32 v140, v140, v146
    v_mul_f32 v45, v45, v15
    v_mul_f32 v141, v141, v146
    v_mul_f32 v46, v46, v15
    v_mul_f32 v142, v142, v146
    v_mul_f32 v47, v47, v15
    v_mul_f32 v143, v143, v146
    v_cvt_pk_bf16_f32 v4, v32, v33
    v_cvt_pk_bf16_f32 v48, v128, v129
    v_cvt_pk_bf16_f32 v5, v34, v35
    v_cvt_pk_bf16_f32 v49, v130, v131
    v_cvt_pk_bf16_f32 v6, v36, v37
    v_cvt_pk_bf16_f32 v50, v132, v133
    v_cvt_pk_bf16_f32 v7, v38, v39
    v_cvt_pk_bf16_f32 v51, v134, v135
    v_cvt_pk_bf16_f32 v8, v40, v41
    v_cvt_pk_bf16_f32 v52, v136, v137
    v_cvt_pk_bf16_f32 v9, v42, v43
    v_cvt_pk_bf16_f32 v53, v138, v139
    v_cvt_pk_bf16_f32 v10, v44, v45
    v_cvt_pk_bf16_f32 v54, v140, v141
    v_cvt_pk_bf16_f32 v11, v46, v47
    v_cvt_pk_bf16_f32 v55, v142, v143
    s_add_u32 s23, s19, 8192
    s_mov_b64 exec, 1
    buffer_store_dwordx2 v[148:149], v56, s[44:47], s19 offen sc1
    buffer_store_dwordx2 v[150:151], v56, s[44:47], s23 offen sc1
    s_mov_b64 exec, -1
    v_lshlrev_b32 v16, 16, v4
    v_lshlrev_b32 v112, 16, v48
    v_and_b32 v17, s20, v4
    v_and_b32 v113, s20, v48
    v_lshlrev_b32 v18, 16, v5
    v_lshlrev_b32 v114, 16, v49
    v_and_b32 v19, s20, v5
    v_and_b32 v115, s20, v49
    v_lshlrev_b32 v20, 16, v6
    v_lshlrev_b32 v116, 16, v50
    v_and_b32 v21, s20, v6
    v_and_b32 v117, s20, v50
    v_lshlrev_b32 v22, 16, v7
    v_lshlrev_b32 v118, 16, v51
    v_and_b32 v23, s20, v7
    v_and_b32 v119, s20, v51
    v_lshlrev_b32 v24, 16, v8
    v_lshlrev_b32 v120, 16, v52
    v_and_b32 v25, s20, v8
    v_and_b32 v121, s20, v52
    v_lshlrev_b32 v26, 16, v9
    v_lshlrev_b32 v122, 16, v53
    v_and_b32 v27, s20, v9
    v_and_b32 v123, s20, v53
    v_lshlrev_b32 v28, 16, v10
    v_lshlrev_b32 v124, 16, v54
    v_and_b32 v29, s20, v10
    v_and_b32 v125, s20, v54
    v_lshlrev_b32 v30, 16, v11
    v_lshlrev_b32 v126, 16, v55
    v_and_b32 v31, s20, v11
    v_and_b32 v127, s20, v55
    v_add_f32 v32, v16, v24
    v_add_f32 v128, v112, v120
    v_add_f32 v33, v17, v25
    v_add_f32 v129, v113, v121
    v_add_f32 v34, v18, v26
    v_add_f32 v130, v114, v122
    v_add_f32 v35, v19, v27
    v_add_f32 v131, v115, v123
    v_add_f32 v36, v20, v28
    v_add_f32 v132, v116, v124
    v_add_f32 v37, v21, v29
    v_add_f32 v133, v117, v125
    v_add_f32 v38, v22, v30
    v_add_f32 v134, v118, v126
    v_add_f32 v39, v23, v31
    v_add_f32 v135, v119, v127
    v_add_f32 v32, v32, v36
    v_add_f32 v128, v128, v132
    v_add_f32 v33, v33, v37
    v_add_f32 v129, v129, v133
    v_add_f32 v34, v34, v38
    v_add_f32 v130, v130, v134
    v_add_f32 v35, v35, v39
    v_add_f32 v131, v131, v135
    v_add_f32 v32, v32, v34
    v_add_f32 v128, v128, v130
    v_add_f32 v33, v33, v35
    v_add_f32 v129, v129, v131
    v_add_f32 v32, v32, v33
    v_add_f32 v128, v128, v129
    s_nop 0
    v_add_f32_dpp v32, v32, v32 quad_perm:[1,0,3,2] row_mask:0xf bank_mask:0xf
    v_add_f32_dpp v128, v128, v128 quad_perm:[1,0,3,2] row_mask:0xf bank_mask:0xf
    s_nop 0
    v_add_f32_dpp v32, v32, v32 quad_perm:[2,3,0,1] row_mask:0xf bank_mask:0xf
    v_add_f32_dpp v128, v128, v128 quad_perm:[2,3,0,1] row_mask:0xf bank_mask:0xf
    s_nop 0
    v_add_f32_dpp v32, v32, v32 row_half_mirror row_mask:0xf bank_mask:0xf
    v_add_f32_dpp v128, v128, v128 row_half_mirror row_mask:0xf bank_mask:0xf
    s_nop 0
    v_add_f32_dpp v32, v32, v32 row_mirror row_mask:0xf bank_mask:0xf
    v_add_f32_dpp v128, v128, v128 row_mirror row_mask:0xf bank_mask:0xf
    s_nop 0
    v_add_f32_dpp v32, v32, v32 row_bcast:15 row_mask:0xa bank_mask:0xf
    v_add_f32_dpp v128, v128, v128 row_bcast:15 row_mask:0xa bank_mask:0xf
    s_nop 0
    v_add_f32_dpp v32, v32, v32 row_bcast:31 row_mask:0xc bank_mask:0xf
    v_add_f32_dpp v128, v128, v128 row_bcast:31 row_mask:0xc bank_mask:0xf
    v_readlane_b32 s24, v32, 63
    v_readlane_b32 s26, v128, 63
    s_nop 0
    v_mov_b32 v13, s24
    v_mov_b32 v144, s26
    v_mul_f32 v13, s21, v13
    v_mul_f32 v144, s21, v144
    v_sub_f32 v32, v16, v13
    v_sub_f32 v128, v112, v144
    v_sub_f32 v33, v17, v13
    v_sub_f32 v129, v113, v144
    v_sub_f32 v34, v18, v13
    v_sub_f32 v130, v114, v144
    v_sub_f32 v35, v19, v13
    v_sub_f32 v131, v115, v144
    v_sub_f32 v36, v20, v13
    v_sub_f32 v132, v116, v144
    v_sub_f32 v37, v21, v13
    v_sub_f32 v133, v117, v144
    v_sub_f32 v38, v22, v13
    v_sub_f32 v134, v118, v144
    v_sub_f32 v39, v23, v13
    v_sub_f32 v135, v119, v144
    v_sub_f32 v40, v24, v13
    v_sub_f32 v136, v120, v144
    v_sub_f32 v41, v25, v13
    v_sub_f32 v137, v121, v144
    v_sub_f32 v42, v26, v13
    v_sub_f32 v138, v122, v144
    v_sub_f32 v43, v27, v13
    v_sub_f32 v139, v123, v144
    v_sub_f32 v44, v28, v13
    v_sub_f32 v140, v124, v144
    v_sub_f32 v45, v29, v13
    v_sub_f32 v141, v125, v144
    v_sub_f32 v46, v30, v13
    v_sub_f32 v142, v126, v144
    v_sub_f32 v47, v31, v13
    v_sub_f32 v143, v127, v144
    v_mul_f32 v14, v32, v32
    v_mul_f32 v145, v128, v128
    v_mul_f32 v15, v33, v33
    v_mul_f32 v146, v129, v129
    v_fmac_f32 v14, v34, v34
    v_fmac_f32 v145, v130, v130
    v_fmac_f32 v15, v35, v35
    v_fmac_f32 v146, v131, v131
    v_fmac_f32 v14, v36, v36
    v_fmac_f32 v145, v132, v132
    v_fmac_f32 v15, v37, v37
    v_fmac_f32 v146, v133, v133
    v_fmac_f32 v14, v38, v38
    v_fmac_f32 v145, v134, v134
    v_fmac_f32 v15, v39, v39
    v_fmac_f32 v146, v135, v135
    v_fmac_f32 v14, v40, v40
    v_fmac_f32 v145, v136, v136
    v_fmac_f32 v15, v41, v41
    v_fmac_f32 v146, v137, v137
    v_fmac_f32 v14, v42, v42
    v_fmac_f32 v145, v138, v138
    v_fmac_f32 v15, v43, v43
    v_fmac_f32 v146, v139, v139
    v_fmac_f32 v14, v44, v44
    v_fmac_f32 v145, v140, v140
    v_fmac_f32 v15, v45, v45
    v_fmac_f32 v146, v141, v141
    v_fmac_f32 v14, v46, v46
    v_fmac_f32 v145, v142, v142
    v_fmac_f32 v15, v47, v47
    v_fmac_f32 v146, v143, v143
    v_add_f32 v14, v14, v15
    v_add_f32 v145, v145, v146
    s_nop 0
    v_add_f32_dpp v14, v14, v14 quad_perm:[1,0,3,2] row_mask:0xf bank_mask:0xf
    v_add_f32_dpp v145, v145, v145 quad_perm:[1,0,3,2] row_mask:0xf bank_mask:0xf
    s_nop 0
    v_add_f32_dpp v14, v14, v14 quad_perm:[2,3,0,1] row_mask:0xf bank_mask:0xf
    v_add_f32_dpp v145, v145, v145 quad_perm:[2,3,0,1] row_mask:0xf bank_mask:0xf
    s_nop 0
    v_add_f32_dpp v14, v14, v14 row_half_mirror row_mask:0xf bank_mask:0xf
    v_add_f32_dpp v145, v145, v145 row_half_mirror row_mask:0xf bank_mask:0xf
    s_nop 0
    v_add_f32_dpp v14, v14, v14 row_mirror row_mask:0xf bank_mask:0xf
    v_add_f32_dpp v145, v145, v145 row_mirror row_mask:0xf bank_mask:0xf
    s_nop 0
    v_add_f32_dpp v14, v14, v14 row_bcast:15 row_mask:0xa bank_mask:0xf
    v_add_f32_dpp v145, v145, v145 row_bcast:15 row_mask:0xa bank_mask:0xf
    s_nop 0
    v_add_f32_dpp v14, v14, v14 row_bcast:31 row_mask:0xc bank_mask:0xf
    v_add_f32_dpp v145, v145, v145 row_bcast:31 row_mask:0xc bank_mask:0xf
    v_readlane_b32 s25, v14, 63
    v_readlane_b32 s27, v145, 63
    s_nop 0
    v_mov_b32 v14, s25
    v_mov_b32 v145, s27
    v_mul_f32 v14, s21, v14
    v_mul_f32 v145, s21, v145
    v_cvt_pk_bf16_f32 v15, v13, v14
    v_cvt_pk_bf16_f32 v146, v144, v145
    v_lshlrev_b32 v13, 16, v15
    v_lshlrev_b32 v144, 16, v146
    v_and_b32 v14, s20, v15
    v_and_b32 v145, s20, v146
    v_add_f32 v14, s22, v14
    v_add_f32 v145, s22, v145
    v_cvt_pk_bf16_f32 v14, v14, v14
    v_cvt_pk_bf16_f32 v145, v145, v145
    v_and_b32 v14, s20, v14
    v_and_b32 v145, s20, v145
    v_sqrt_f32 v14, v14
    v_sqrt_f32 v145, v145
    v_cvt_pk_bf16_f32 v14, v14, v14
    v_cvt_pk_bf16_f32 v145, v145, v145
    v_and_b32 v14, s20, v14
    v_and_b32 v145, s20, v145
    v_rcp_f32 v15, v14
    v_rcp_f32 v146, v145
    v_fma_f32 v2, -v14, v15, 1.0
    v_fma_f32 v147, -v145, v146, 1.0
    v_fma_f32 v15, v2, v15, v15
    v_fma_f32 v146, v147, v146, v146
    v_sub_f32 v32, v16, v13
    v_sub_f32 v128, v112, v144
    v_sub_f32 v33, v17, v13
    v_sub_f32 v129, v113, v144
    v_sub_f32 v34, v18, v13
    v_sub_f32 v130, v114, v144
    v_sub_f32 v35, v19, v13
    v_sub_f32 v131, v115, v144
    v_sub_f32 v36, v20, v13
    v_sub_f32 v132, v116, v144
    v_sub_f32 v37, v21, v13
    v_sub_f32 v133, v117, v144
    v_sub_f32 v38, v22, v13
    v_sub_f32 v134, v118, v144
    v_sub_f32 v39, v23, v13
    v_sub_f32 v135, v119, v144
    v_sub_f32 v40, v24, v13
    v_sub_f32 v136, v120, v144
    v_sub_f32 v41, v25, v13
    v_sub_f32 v137, v121, v144
    v_sub_f32 v42, v26, v13
    v_sub_f32 v138, v122, v144
    v_sub_f32 v43, v27, v13
    v_sub_f32 v139, v123, v144
    v_sub_f32 v44, v28, v13
    v_sub_f32 v140, v124, v144
    v_sub_f32 v45, v29, v13
    v_sub_f32 v141, v125, v144
    v_sub_f32 v46, v30, v13
    v_sub_f32 v142, v126, v144
    v_sub_f32 v47, v31, v13
    v_sub_f32 v143, v127, v144
    v_cvt_pk_bf16_f32 v4, v32, v33
    v_cvt_pk_bf16_f32 v48, v128, v129
    v_cvt_pk_bf16_f32 v5, v34, v35
    v_cvt_pk_bf16_f32 v49, v130, v131
    v_cvt_pk_bf16_f32 v6, v36, v37
    v_cvt_pk_bf16_f32 v50, v132, v133
    v_cvt_pk_bf16_f32 v7, v38, v39
    v_cvt_pk_bf16_f32 v51, v134, v135
    v_cvt_pk_bf16_f32 v8, v40, v41
    v_cvt_pk_bf16_f32 v52, v136, v137
    v_cvt_pk_bf16_f32 v9, v42, v43
    v_cvt_pk_bf16_f32 v53, v138, v139
    v_cvt_pk_bf16_f32 v10, v44, v45
    v_cvt_pk_bf16_f32 v54, v140, v141
    v_cvt_pk_bf16_f32 v11, v46, v47
    v_cvt_pk_bf16_f32 v55, v142, v143
    v_lshlrev_b32 v32, 16, v4
    v_lshlrev_b32 v128, 16, v48
    v_and_b32 v33, s20, v4
    v_and_b32 v129, s20, v48
    v_lshlrev_b32 v34, 16, v5
    v_lshlrev_b32 v130, 16, v49
    v_and_b32 v35, s20, v5
    v_and_b32 v131, s20, v49
    v_lshlrev_b32 v36, 16, v6
    v_lshlrev_b32 v132, 16, v50
    v_and_b32 v37, s20, v6
    v_and_b32 v133, s20, v50
    v_lshlrev_b32 v38, 16, v7
    v_lshlrev_b32 v134, 16, v51
    v_and_b32 v39, s20, v7
    v_and_b32 v135, s20, v51
    v_lshlrev_b32 v40, 16, v8
    v_lshlrev_b32 v136, 16, v52
    v_and_b32 v41, s20, v8
    v_and_b32 v137, s20, v52
    v_lshlrev_b32 v42, 16, v9
    v_lshlrev_b32 v138, 16, v53
    v_and_b32 v43, s20, v9
    v_and_b32 v139, s20, v53
    v_lshlrev_b32 v44, 16, v10
    v_lshlrev_b32 v140, 16, v54
    v_and_b32 v45, s20, v10
    v_and_b32 v141, s20, v54
    v_lshlrev_b32 v46, 16, v11
    v_lshlrev_b32 v142, 16, v55
    v_and_b32 v47, s20, v11
    v_and_b32 v143, s20, v55
    v_mul_f32 v32, v32, v15
    v_mul_f32 v128, v128, v146
    v_mul_f32 v33, v33, v15
    v_mul_f32 v129, v129, v146
    v_mul_f32 v34, v34, v15
    v_mul_f32 v130, v130, v146
    v_mul_f32 v35, v35, v15
    v_mul_f32 v131, v131, v146
    v_mul_f32 v36, v36, v15
    v_mul_f32 v132, v132, v146
    v_mul_f32 v37, v37, v15
    v_mul_f32 v133, v133, v146
    v_mul_f32 v38, v38, v15
    v_mul_f32 v134, v134, v146
    v_mul_f32 v39, v39, v15
    v_mul_f32 v135, v135, v146
    v_mul_f32 v40, v40, v15
    v_mul_f32 v136, v136, v146
    v_mul_f32 v41, v41, v15
    v_mul_f32 v137, v137, v146
    v_mul_f32 v42, v42, v15
    v_mul_f32 v138, v138, v146
    v_mul_f32 v43, v43, v15
    v_mul_f32 v139, v139, v146
    v_mul_f32 v44, v44, v15
    v_mul_f32 v140, v140, v146
    v_mul_f32 v45, v45, v15
    v_mul_f32 v141, v141, v146
    v_mul_f32 v46, v46, v15
    v_mul_f32 v142, v142, v146
    v_mul_f32 v47, v47, v15
    v_mul_f32 v143, v143, v146
    v_cvt_pk_bf16_f32 v4, v32, v33
    v_cvt_pk_bf16_f32 v48, v128, v129
    v_cvt_pk_bf16_f32 v5, v34, v35
    v_cvt_pk_bf16_f32 v49, v130, v131
    v_cvt_pk_bf16_f32 v6, v36, v37
    v_cvt_pk_bf16_f32 v50, v132, v133
    v_cvt_pk_bf16_f32 v7, v38, v39
    v_cvt_pk_bf16_f32 v51, v134, v135
    v_cvt_pk_bf16_f32 v8, v40, v41
    v_cvt_pk_bf16_f32 v52, v136, v137
    v_cvt_pk_bf16_f32 v9, v42, v43
    v_cvt_pk_bf16_f32 v53, v138, v139
    v_cvt_pk_bf16_f32 v10, v44, v45
    v_cvt_pk_bf16_f32 v54, v140, v141
    v_cvt_pk_bf16_f32 v11, v46, v47
    v_cvt_pk_bf16_f32 v55, v142, v143
    ds_write_b128 v12, v[4:7] offset:0
    ds_write_b128 v12, v[8:11] offset:1024
    ds_write_b128 v12, v[48:51] offset:2048
    ds_write_b128 v12, v[52:55] offset:3072
    v_bfe_u32 v20, v1, 2, 2
    v_lshlrev_b32 v20, 11, v20
    v_lshrrev_b32 v21, 4, v1
    v_lshl_add_u32 v20, v21, 5, v20
    v_and_b32 v21, 3, v1
    v_lshl_add_u32 v20, v21, 3, v20
    s_lshl_b32 s23, s16, 8
    v_add_u32 v20, s23, v20
    v_lshrrev_b32 v21, 5, v1
    v_lshlrev_b32 v21, 12, v21
    v_and_b32 v22, 31, v1
    v_lshl_add_u32 v21, v22, 4, v21
    s_lshr_b32 s23, s16, 1
    s_lshl_b32 s23, s23, 20
    s_and_b32 s24, s16, 1
    s_lshl_b32 s24, s24, 14
    s_add_u32 s23, s23, s24
    s_lshr_b32 s24, s70, 2
    s_lshl_b32 s24, s24, 15
    s_add_u32 s23, s23, s24
    s_and_b32 s24, s70, 3
    s_lshl_b32 s24, s24, 10
    s_add_u32 s23, s23, s24
    s_add_u32 s24, s23, 8192
    s_waitcnt lgkmcnt(0)
    s_barrier
    ds_read_b64_tr_b16 v[24:25], v20 offset:0
    ds_read_b64_tr_b16 v[26:27], v20 offset:8192
    ds_read_b64_tr_b16 v[28:29], v20 offset:16384
    ds_read_b64_tr_b16 v[30:31], v20 offset:24576
    ds_read_b64_tr_b16 v[32:33], v20 offset:128
    ds_read_b64_tr_b16 v[34:35], v20 offset:8320
    ds_read_b64_tr_b16 v[36:37], v20 offset:16512
    ds_read_b64_tr_b16 v[38:39], v20 offset:24704
    s_waitcnt lgkmcnt(6)
    buffer_store_dwordx4 v[24:27], v21, s[12:15], s23 offen offset:0 sc1
    s_waitcnt lgkmcnt(4)
    buffer_store_dwordx4 v[28:31], v21, s[12:15], s23 offen offset:512 sc1
    s_waitcnt lgkmcnt(2)
    buffer_store_dwordx4 v[32:35], v21, s[12:15], s24 offen offset:0 sc1
    s_waitcnt lgkmcnt(0)
    buffer_store_dwordx4 v[36:39], v21, s[12:15], s24 offen offset:512 sc1
    s_waitcnt vmcnt(0)
    v_readfirstlane_b32 s71, v58
    s_mov_b32 s44, s74
    s_and_b32 s45, s75, 0xffff
    s_mov_b32 s46, 256
    s_mov_b32 s47, 0x20000
    s_mov_b64 exec, 1
    v_mov_b32 v11, 159752
    v_mov_b32 v9, 1
    v_mov_b32 v10, 0
    ds_add_rtn_u32 v9, v11, v9
    s_waitcnt lgkmcnt(0)
    v_readfirstlane_b32 s40, v9
    s_nop 0
    s_cmp_lg_u32 s40, 7
    s_cbranch_scc1 L_parallel_sum__sliding_block__mixer_token_mlp__prompt_kernel_lna
    v_mov_b32 v9, 1
    buffer_atomic_add v9, v10, s[44:47], 0 offen sc0 sc1
    s_waitcnt vmcnt(0)
    v_readfirstlane_b32 s40, v9
    s_nop 0
    s_and_b32 s40, s40, 127
    s_cmp_lg_u32 s40, 127
    s_cbranch_scc1 L_parallel_sum__sliding_block__mixer_token_mlp__prompt_kernel_lna
    s_mov_b64 exec, -1
    s_add_u32 s44, s28, 52428800
    s_addc_u32 s45, s29, 0
    s_and_b32 s45, s45, 0xffff
    s_mov_b32 s46, 32768
    s_mov_b32 s47, 0x20000
    v_lshlrev_b32 v11, 8, v1
    v_mov_b32 v9, 1
    s_mov_b32 s41, 16384
    buffer_atomic_add v9, v11, s[44:47], 0 offen sc1
    buffer_atomic_add v9, v11, s[44:47], s41 offen sc1
L_parallel_sum__sliding_block__mixer_token_mlp__prompt_kernel_lna:
    s_mov_b64 exec, -1
    v_lshlrev_b32 v66, 16, v72
    v_and_b32 v67, s20, v72
    v_lshlrev_b32 v70, 16, v73
    v_and_b32 v71, s20, v73
    v_add_f32 v66, v66, v70
    v_add_f32 v67, v67, v71
    v_lshlrev_b32 v70, 16, v74
    v_and_b32 v71, s20, v74
    v_add_f32 v66, v66, v70
    v_add_f32 v67, v67, v71
    v_lshlrev_b32 v70, 16, v75
    v_and_b32 v71, s20, v75
    v_add_f32 v66, v66, v70
    v_add_f32 v67, v67, v71
    v_lshlrev_b32 v70, 16, v76
    v_and_b32 v71, s20, v76
    v_add_f32 v66, v66, v70
    v_add_f32 v67, v67, v71
    v_lshlrev_b32 v70, 16, v77
    v_and_b32 v71, s20, v77
    v_add_f32 v66, v66, v70
    v_add_f32 v67, v67, v71
    v_lshlrev_b32 v70, 16, v78
    v_and_b32 v71, s20, v78
    v_add_f32 v66, v66, v70
    v_add_f32 v67, v67, v71
    v_lshlrev_b32 v70, 16, v79
    v_and_b32 v71, s20, v79
    v_add_f32 v66, v66, v70
    v_add_f32 v67, v67, v71
    v_lshlrev_b32 v70, 16, v80
    v_and_b32 v71, s20, v80
    v_add_f32 v66, v66, v70
    v_add_f32 v67, v67, v71
    v_lshlrev_b32 v70, 16, v81
    v_and_b32 v71, s20, v81
    v_add_f32 v66, v66, v70
    v_add_f32 v67, v67, v71
    v_lshlrev_b32 v70, 16, v82
    v_and_b32 v71, s20, v82
    v_add_f32 v66, v66, v70
    v_add_f32 v67, v67, v71
    v_lshlrev_b32 v70, 16, v83
    v_and_b32 v71, s20, v83
    v_add_f32 v66, v66, v70
    v_add_f32 v67, v67, v71
    v_lshlrev_b32 v70, 16, v84
    v_and_b32 v71, s20, v84
    v_add_f32 v66, v66, v70
    v_add_f32 v67, v67, v71
    v_lshlrev_b32 v70, 16, v85
    v_and_b32 v71, s20, v85
    v_add_f32 v66, v66, v70
    v_add_f32 v67, v67, v71
    v_lshlrev_b32 v70, 16, v86
    v_and_b32 v71, s20, v86
    v_add_f32 v66, v66, v70
    v_add_f32 v67, v67, v71
    v_lshlrev_b32 v70, 16, v87
    v_and_b32 v71, s20, v87
    v_add_f32 v66, v66, v70
    v_add_f32 v67, v67, v71
    v_lshlrev_b32 v68, 16, v88
    v_and_b32 v69, s20, v88
    v_lshlrev_b32 v70, 16, v89
    v_and_b32 v71, s20, v89
    v_add_f32 v68, v68, v70
    v_add_f32 v69, v69, v71
    v_lshlrev_b32 v70, 16, v90
    v_and_b32 v71, s20, v90
    v_add_f32 v68, v68, v70
    v_add_f32 v69, v69, v71
    v_lshlrev_b32 v70, 16, v91
    v_and_b32 v71, s20, v91
    v_add_f32 v68, v68, v70
    v_add_f32 v69, v69, v71
    v_lshlrev_b32 v70, 16, v92
    v_and_b32 v71, s20, v92
    v_add_f32 v68, v68, v70
    v_add_f32 v69, v69, v71
    v_lshlrev_b32 v70, 16, v93
    v_and_b32 v71, s20, v93
    v_add_f32 v68, v68, v70
    v_add_f32 v69, v69, v71
    v_lshlrev_b32 v70, 16, v94
    v_and_b32 v71, s20, v94
    v_add_f32 v68, v68, v70
    v_add_f32 v69, v69, v71
    v_lshlrev_b32 v70, 16, v95
    v_and_b32 v71, s20, v95
    v_add_f32 v68, v68, v70
    v_add_f32 v69, v69, v71
    s_lshl_b32 s41, s16, 10
    s_add_u32 s41, s41, 147456
    v_lshlrev_b32 v70, 3, v1
    v_add_u32 v70, s41, v70
    ds_write_b64 v70, v[66:67]
    ds_write_b64 v70, v[68:69] offset:512
    s_waitcnt lgkmcnt(0)
    s_barrier
    s_cmp_ge_u32 s16, 4
    s_cbranch_scc1 L_parallel_sum__sliding_block__mixer_token_mlp__prompt_kernel_no2
    s_cmp_ge_u32 s16, 3
    s_cbranch_scc1 L_parallel_sum__sliding_block__mixer_token_mlp__prompt_kernel_csd
    v_lshlrev_b32 v70, 2, v0
    v_add_u32 v71, 147456, v70
    ds_read_b32 v72, v71 offset:0
    ds_read_b32 v73, v71 offset:1024
    ds_read_b32 v74, v71 offset:2048
    ds_read_b32 v75, v71 offset:3072
    ds_read_b32 v76, v71 offset:4096
    ds_read_b32 v77, v71 offset:5120
    ds_read_b32 v78, v71 offset:6144
    ds_read_b32 v79, v71 offset:7168
    ds_read_b32 v80, v71 offset:256
    ds_read_b32 v81, v71 offset:1280
    ds_read_b32 v82, v71 offset:2304
    ds_read_b32 v83, v71 offset:3328
    ds_read_b32 v84, v71 offset:4352
    ds_read_b32 v85, v71 offset:5376
    ds_read_b32 v86, v71 offset:6400
    ds_read_b32 v87, v71 offset:7424
    s_waitcnt lgkmcnt(0)
    v_add_f32 v72, v72, v73
    v_add_f32 v72, v72, v74
    v_add_f32 v72, v72, v75
    v_add_f32 v72, v72, v76
    v_add_f32 v72, v72, v77
    v_add_f32 v72, v72, v78
    v_add_f32 v72, v72, v79
    v_add_f32 v80, v80, v81
    v_add_f32 v80, v80, v82
    v_add_f32 v80, v80, v83
    v_add_f32 v80, v80, v84
    v_add_f32 v80, v80, v85
    v_add_f32 v80, v80, v86
    v_add_f32 v80, v80, v87
    s_cmp_eq_u32 s16, 2
    s_cselect_b32 s41, 1.0, 0
    s_cbranch_scc0 L_parallel_sum__sliding_block__mixer_token_mlp__prompt_kernel_cs2
    v_add_f32 v72, v72, v80
L_parallel_sum__sliding_block__mixer_token_mlp__prompt_kernel_cs2:
    s_add_u32 s44, s28, 51380224
    s_addc_u32 s45, s29, 0
    s_and_b32 s45, s45, 0xffff
    s_mov_b32 s46, 147456
    s_mov_b32 s47, 0x20000
    s_lshl_b32 s41, s70, 10
    s_add_u32 s41, s41, 16384
    buffer_store_dword v72, v70, s[44:47], s41 offen sc1
L_parallel_sum__sliding_block__mixer_token_mlp__prompt_kernel_csd:
    s_lshl_b32 s40, s70, 2
    s_add_u32 s40, s40, s16
    s_add_u32 s44, s28, 33554432
    s_addc_u32 s45, s29, 0
    s_and_b32 s45, s45, 0xffff
    s_mov_b32 s46, 16777216
    s_mov_b32 s47, 0x20000
    v_mov_b32 v60, -1
    v_mov_b32 v61, -1
    v_mov_b32 v62, -1
    v_mov_b32 v63, -1
    s_lshr_b32 s41, s40, 8
    s_lshl_b32 s42, s41, 22
    s_xor_b32 s41, s41, 1
    s_lshl_b32 s41, s41, 13
    s_add_u32 s42, s42, s41
    s_and_b32 s41, s40, 255
    s_lshl_b32 s41, s41, 14
    s_add_u32 s42, s42, s41
    s_add_u32 s41, s42, 4096
    buffer_store_dwordx4 v[60:63], v3, s[44:47], s42 offen offset:0 sc1
    buffer_store_dwordx4 v[60:63], v3, s[44:47], s42 offen offset:1024 sc1
    buffer_store_dwordx4 v[60:63], v3, s[44:47], s42 offen offset:2048 sc1
    buffer_store_dwordx4 v[60:63], v3, s[44:47], s42 offen offset:3072 sc1
    buffer_store_dwordx4 v[60:63], v3, s[44:47], s41 offen offset:0 sc1
    buffer_store_dwordx4 v[60:63], v3, s[44:47], s41 offen offset:1024 sc1
    buffer_store_dwordx4 v[60:63], v3, s[44:47], s41 offen offset:2048 sc1
    buffer_store_dwordx4 v[60:63], v3, s[44:47], s41 offen offset:3072 sc1
    s_waitcnt vmcnt(0)
    s_mov_b32 s44, s74
    s_and_b32 s45, s75, 0xffff
    s_mov_b32 s46, 256
    s_mov_b32 s47, 0x20000
    s_mov_b32 s41, 132
    s_mov_b64 exec, 1
    v_mov_b32 v11, 159756
    v_mov_b32 v9, 1
    ds_add_rtn_u32 v9, v11, v9
    s_waitcnt lgkmcnt(0)
    v_readfirstlane_b32 s40, v9
    s_mov_b64 exec, -1
    v_mov_b32 v9, 1
    v_lshlrev_b32 v11, 8, v1
    s_cmp_lg_u32 s40, 3
    s_cbranch_scc1 L_parallel_sum__sliding_block__mixer_token_mlp__prompt_kernel_arrc
    s_mov_b64 exec, 0x1
    buffer_atomic_add v9, v11, s[44:47], s41 offen sc1
    s_mov_b64 exec, -1
L_parallel_sum__sliding_block__mixer_token_mlp__prompt_kernel_arrc:
L_parallel_sum__sliding_block__mixer_token_mlp__prompt_kernel_no2:
    s_cmp_lt_u32 s2, 112
    s_cbranch_scc1 L_parallel_sum__sliding_block__mixer_token_mlp__prompt_kernel_mlp
    s_sub_u32 s37, s37, 16
    s_sub_u32 s69, s2, 240
    v_lshlrev_b32 v2, 7, v1
    s_mov_b32 s4, s32
    s_and_b32 s5, s33, 0xffff
    s_mov_b32 s6, 8802304
    s_mov_b32 s7, 0x20000
    s_lshl_b32 s17, s69, 3
    s_add_u32 s17, s17, s16
    s_lshl_b32 s17, s17, 13
    s_add_u32 s17, s17, 3670016
    s_mov_b32 s18, 5
L_parallel_sum__sliding_block__mixer_token_mlp__prompt_kernel_ipf1:
    buffer_load_dword v3, v2, s[4:7], s17 offen
    s_add_u32 s17, s17, 1048576
    s_waitcnt vmcnt(1)
    s_barrier
    s_sub_u32 s18, s18, 1
    s_cmp_lg_u32 s18, 0
    s_cbranch_scc1 L_parallel_sum__sliding_block__mixer_token_mlp__prompt_kernel_ipf1
    s_load_dwordx2 s[40:41], s[0:1], 48
    s_waitcnt lgkmcnt(0)
    s_mov_b32 s4, s40
    s_and_b32 s5, s41, 0xffff
    s_mov_b32 s6, 14680064
    s_mov_b32 s7, 0x20000
    s_lshl_b32 s17, s69, 3
    s_add_u32 s17, s17, s16
    s_lshr_b32 s18, s17, 5
    s_and_b32 s17, s17, 31
    s_lshl_b32 s17, s17, 13
    s_cmp_eq_u32 s18, 1
    s_cselect_b32 s19, 4718592, 0
    s_cmp_eq_u32 s18, 2
    s_cselect_b32 s19, 9437184, s19
    s_cmp_eq_u32 s18, 3
    s_cselect_b32 s19, 12058624, s19
    s_add_u32 s17, s17, s19
    s_mov_b32 s18, 8
L_parallel_sum__sliding_block__mixer_token_mlp__prompt_kernel_ipf2:
    buffer_load_dword v3, v2, s[4:7], s17 offen
    s_add_u32 s17, s17, 262144
    s_waitcnt vmcnt(1)
    s_barrier
    s_sub_u32 s18, s18, 1
    s_cmp_lg_u32 s18, 0
    s_cbranch_scc1 L_parallel_sum__sliding_block__mixer_token_mlp__prompt_kernel_ipf2
    s_add_u32 s44, s28, 52428800
    s_addc_u32 s45, s29, 0
    s_and_b32 s45, s45, 0xffff
    s_mov_b32 s46, 32768
    s_mov_b32 s47, 0x20000
    v_mov_b32 v10, 0
    s_lshl_b32 s41, s70, 8
    s_mov_b32 s42, 0x40000
L_parallel_sum__sliding_block__mixer_token_mlp__prompt_kernel_igo:
    buffer_load_dword v9, v10, s[44:47], s41 offen sc1
    s_waitcnt vmcnt(0)
    v_readfirstlane_b32 s40, v9
    s_nop 0
    s_cmp_lg_u32 s40, s71
    s_cbranch_scc1 L_parallel_sum__sliding_block__mixer_token_mlp__prompt_kernel_igo_ok
    s_sleep 2
    s_sub_u32 s42, s42, 1
    s_cmp_lg_u32 s42, 0
    s_cbranch_scc1 L_parallel_sum__sliding_block__mixer_token_mlp__prompt_kernel_igo
L_parallel_sum__sliding_block__mixer_token_mlp__prompt_kernel_igo_ok:
    s_mov_b32 s63, -1
    s_mov_b64 s[58:59], 0
    s_mov_b32 s62, 0
    s_mov_b32 s61, 0
    s_branch L_parallel_sum__sliding_block__mixer_token_mlp__prompt_kernel_p2
L_parallel_sum__sliding_block__mixer_token_mlp__prompt_kernel_mlp:
    s_and_b32 s25, s16, 1
    s_bfe_u32 s24, s16, 0x10001
    s_cmp_ge_u32 s16, 4
    s_cbranch_scc1 L_parallel_sum__sliding_block__mixer_token_mlp__prompt_kernel_mload
    s_mov_b32 s44, s34
    s_and_b32 s45, s35, 0xffff
    s_mov_b32 s46, 7168
    s_mov_b32 s47, 0x20000
    v_lshrrev_b32 v17, 4, v1
    v_lshlrev_b32 v17, 3, v17
    s_lshl_b32 s41, s25, 7
    s_add_u32 s41, s41, s76
    buffer_load_dwordx2 v[248:249], v17, s[44:47], s41 offen offset:0
    buffer_load_dwordx2 v[250:251], v17, s[44:47], s41 offen offset:32
    buffer_load_dwordx2 v[252:253], v17, s[44:47], s41 offen offset:64
    buffer_load_dwordx2 v[254:255], v17, s[44:47], s41 offen offset:96
    v_lshlrev_b32 v18, 7, v1
    s_lshl_b32 s50, s2, 2
    s_add_u32 s50, s50, s16
    s_mov_b32 s52, s32
    s_and_b32 s53, s33, 0xffff
    s_mov_b32 s54, 3670016
    s_mov_b32 s55, 0x20000
    s_mul_i32 s51, s50, 8192
    buffer_load_dword v19, v18, s[52:55], s51 offen
    v_lshrrev_b32 v24, 4, v1
    v_and_b32 v25, 15, v1
    v_lshlrev_b32 v25, 4, v25
    v_lshl_add_u32 v25, v24, 9, v25
    s_mul_i32 s27, s24, 16384
    v_add_u32 v7, s27, v25
    v_lshlrev_b32 v25, 3, v24
    v_bfe_u32 v26, v1, 2, 2
    v_add_u32 v25, v25, v26
    v_lshlrev_b32 v25, 8, v25
    v_and_b32 v27, 3, v1
    v_lshl_add_u32 v25, v27, 3, v25
    v_add_u32 v25, 32768, v25
    v_and_b32 v24, 1, v24
    v_lshl_add_u32 v24, v26, 1, v24
    s_mul_i32 s27, s25, 4
    s_add_u32 s3, s27, 0
    v_xor_b32 v26, s3, v24
    v_lshl_add_u32 v3, v26, 5, v25
    s_add_u32 s3, s27, 1
    v_xor_b32 v26, s3, v24
    v_lshl_add_u32 v4, v26, 5, v25
    s_add_u32 s3, s27, 2
    v_xor_b32 v26, s3, v24
    v_lshl_add_u32 v5, v26, 5, v25
    s_add_u32 s3, s27, 3
    v_xor_b32 v26, s3, v24
    v_lshl_add_u32 v6, v26, 5, v25
    s_add_u32 s12, s28, 20971520
    s_addc_u32 s13, s29, 0
    s_and_b32 s13, s13, 0xffff
    s_mov_b32 s14, 8388608
    s_mov_b32 s15, 0x20000
    s_mov_b32 s48, 0xffff0000
    s_waitcnt vmcnt(0)
    v_lshlrev_b32 v120, 16, v248
    v_and_b32 v121, s48, v248
    v_lshlrev_b32 v136, 16, v248
    v_and_b32 v137, s48, v248
    v_lshlrev_b32 v152, 16, v248
    v_and_b32 v153, s48, v248
    v_lshlrev_b32 v168, 16, v248
    v_and_b32 v169, s48, v248
    v_lshlrev_b32 v184, 16, v248
    v_and_b32 v185, s48, v248
    v_lshlrev_b32 v200, 16, v248
    v_and_b32 v201, s48, v248
    v_lshlrev_b32 v216, 16, v248
    v_and_b32 v217, s48, v248
    v_lshlrev_b32 v232, 16, v248
    v_and_b32 v233, s48, v248
    v_lshlrev_b32 v122, 16, v249
    v_and_b32 v123, s48, v249
    v_lshlrev_b32 v138, 16, v249
    v_and_b32 v139, s48, v249
    v_lshlrev_b32 v154, 16, v249
    v_and_b32 v155, s48, v249
    v_lshlrev_b32 v170, 16, v249
    v_and_b32 v171, s48, v249
    v_lshlrev_b32 v186, 16, v249
    v_and_b32 v187, s48, v249
    v_lshlrev_b32 v202, 16, v249
    v_and_b32 v203, s48, v249
    v_lshlrev_b32 v218, 16, v249
    v_and_b32 v219, s48, v249
    v_lshlrev_b32 v234, 16, v249
    v_and_b32 v235, s48, v249
    v_lshlrev_b32 v124, 16, v250
    v_and_b32 v125, s48, v250
    v_lshlrev_b32 v140, 16, v250
    v_and_b32 v141, s48, v250
    v_lshlrev_b32 v156, 16, v250
    v_and_b32 v157, s48, v250
    v_lshlrev_b32 v172, 16, v250
    v_and_b32 v173, s48, v250
    v_lshlrev_b32 v188, 16, v250
    v_and_b32 v189, s48, v250
    v_lshlrev_b32 v204, 16, v250
    v_and_b32 v205, s48, v250
    v_lshlrev_b32 v220, 16, v250
    v_and_b32 v221, s48, v250
    v_lshlrev_b32 v236, 16, v250
    v_and_b32 v237, s48, v250
    v_lshlrev_b32 v126, 16, v251
    v_and_b32 v127, s48, v251
    v_lshlrev_b32 v142, 16, v251
    v_and_b32 v143, s48, v251
    v_lshlrev_b32 v158, 16, v251
    v_and_b32 v159, s48, v251
    v_lshlrev_b32 v174, 16, v251
    v_and_b32 v175, s48, v251
    v_lshlrev_b32 v190, 16, v251
    v_and_b32 v191, s48, v251
    v_lshlrev_b32 v206, 16, v251
    v_and_b32 v207, s48, v251
    v_lshlrev_b32 v222, 16, v251
    v_and_b32 v223, s48, v251
    v_lshlrev_b32 v238, 16, v251
    v_and_b32 v239, s48, v251
    v_lshlrev_b32 v128, 16, v252
    v_and_b32 v129, s48, v252
    v_lshlrev_b32 v144, 16, v252
    v_and_b32 v145, s48, v252
    v_lshlrev_b32 v160, 16, v252
    v_and_b32 v161, s48, v252
    v_lshlrev_b32 v176, 16, v252
    v_and_b32 v177, s48, v252
    v_lshlrev_b32 v192, 16, v252
    v_and_b32 v193, s48, v252
    v_lshlrev_b32 v208, 16, v252
    v_and_b32 v209, s48, v252
    v_lshlrev_b32 v224, 16, v252
    v_and_b32 v225, s48, v252
    v_lshlrev_b32 v240, 16, v252
    v_and_b32 v241, s48, v252
    v_lshlrev_b32 v130, 16, v253
    v_and_b32 v131, s48, v253
    v_lshlrev_b32 v146, 16, v253
    v_and_b32 v147, s48, v253
    v_lshlrev_b32 v162, 16, v253
    v_and_b32 v163, s48, v253
    v_lshlrev_b32 v178, 16, v253
    v_and_b32 v179, s48, v253
    v_lshlrev_b32 v194, 16, v253
    v_and_b32 v195, s48, v253
    v_lshlrev_b32 v210, 16, v253
    v_and_b32 v211, s48, v253
    v_lshlrev_b32 v226, 16, v253
    v_and_b32 v227, s48, v253
    v_lshlrev_b32 v242, 16, v253
    v_and_b32 v243, s48, v253
    v_lshlrev_b32 v132, 16, v254
    v_and_b32 v133, s48, v254
    v_lshlrev_b32 v148, 16, v254
    v_and_b32 v149, s48, v254
    v_lshlrev_b32 v164, 16, v254
    v_and_b32 v165, s48, v254
    v_lshlrev_b32 v180, 16, v254
    v_and_b32 v181, s48, v254
    v_lshlrev_b32 v196, 16, v254
    v_and_b32 v197, s48, v254
    v_lshlrev_b32 v212, 16, v254
    v_and_b32 v213, s48, v254
    v_lshlrev_b32 v228, 16, v254
    v_and_b32 v229, s48, v254
    v_lshlrev_b32 v244, 16, v254
    v_and_b32 v245, s48, v254
    v_lshlrev_b32 v134, 16, v255
    v_and_b32 v135, s48, v255
    v_lshlrev_b32 v150, 16, v255
    v_and_b32 v151, s48, v255
    v_lshlrev_b32 v166, 16, v255
    v_and_b32 v167, s48, v255
    v_lshlrev_b32 v182, 16, v255
    v_and_b32 v183, s48, v255
    v_lshlrev_b32 v198, 16, v255
    v_and_b32 v199, s48, v255
    v_lshlrev_b32 v214, 16, v255
    v_and_b32 v215, s48, v255
    v_lshlrev_b32 v230, 16, v255
    v_and_b32 v231, s48, v255
    v_lshlrev_b32 v246, 16, v255
    v_and_b32 v247, s48, v255
    s_mov_b32 s22, 0
    v_mov_b32 v8, v7
    v_mov_b32 v13, v3
    v_mov_b32 v14, v4
    v_mov_b32 v15, v5
    v_mov_b32 v16, v6
    s_waitcnt vmcnt(63)
    s_barrier
    ds_read_b128 v[24:27], v8 offset:0
    ds_read_b64_tr_b16 v[56:57], v13 offset:0
    ds_read_b64_tr_b16 v[58:59], v13 offset:1024
    ds_read_b64_tr_b16 v[60:61], v14 offset:0
    ds_read_b64_tr_b16 v[62:63], v14 offset:1024
    ds_read_b64_tr_b16 v[64:65], v15 offset:0
    ds_read_b64_tr_b16 v[66:67], v15 offset:1024
    ds_read_b64_tr_b16 v[68:69], v16 offset:0
    ds_read_b64_tr_b16 v[70:71], v16 offset:1024
    ds_read_b128 v[28:31], v8 offset:256
    ds_read_b128 v[32:35], v8 offset:4096
    ds_read_b128 v[36:39], v8 offset:4352
    ds_read_b128 v[40:43], v8 offset:8192
    ds_read_b128 v[44:47], v8 offset:8448
    ds_read_b128 v[48:51], v8 offset:12288
    ds_read_b128 v[52:55], v8 offset:12544
    s_mov_b32 s49, 8
L_parallel_sum__sliding_block__mixer_token_mlp__prompt_kernel_mcl:
    s_waitcnt lgkmcnt(13)
    v_mfma_f32_16x16x32_bf16 v[120:123], v[56:59], v[24:27], v[120:123]
    ds_read_b128 v[72:75], v8 offset:2048
    s_waitcnt lgkmcnt(12)
    v_mfma_f32_16x16x32_bf16 v[124:127], v[60:63], v[24:27], v[124:127]
    ds_read_b64_tr_b16 v[104:105], v13 offset:8192
    s_waitcnt lgkmcnt(11)
    v_mfma_f32_16x16x32_bf16 v[128:131], v[64:67], v[24:27], v[128:131]
    ds_read_b64_tr_b16 v[106:107], v13 offset:9216
    s_waitcnt lgkmcnt(10)
    v_mfma_f32_16x16x32_bf16 v[132:135], v[68:71], v[24:27], v[132:135]
    ds_read_b64_tr_b16 v[108:109], v14 offset:8192
    s_waitcnt lgkmcnt(10)
    v_mfma_f32_16x16x32_bf16 v[148:151], v[68:71], v[28:31], v[148:151]
    ds_read_b64_tr_b16 v[110:111], v14 offset:9216
    v_mfma_f32_16x16x32_bf16 v[144:147], v[64:67], v[28:31], v[144:147]
    ds_read_b64_tr_b16 v[112:113], v15 offset:8192
    v_mfma_f32_16x16x32_bf16 v[140:143], v[60:63], v[28:31], v[140:143]
    ds_read_b64_tr_b16 v[114:115], v15 offset:9216
    v_mfma_f32_16x16x32_bf16 v[136:139], v[56:59], v[28:31], v[136:139]
    ds_read_b64_tr_b16 v[116:117], v16 offset:8192
    s_waitcnt lgkmcnt(13)
    v_mfma_f32_16x16x32_bf16 v[152:155], v[56:59], v[32:35], v[152:155]
    ds_read_b64_tr_b16 v[118:119], v16 offset:9216
    v_mfma_f32_16x16x32_bf16 v[156:159], v[60:63], v[32:35], v[156:159]
    ds_read_b128 v[76:79], v8 offset:2304
    v_mfma_f32_16x16x32_bf16 v[160:163], v[64:67], v[32:35], v[160:163]
    ds_read_b128 v[80:83], v8 offset:6144
    v_mfma_f32_16x16x32_bf16 v[164:167], v[68:71], v[32:35], v[164:167]
    ds_read_b128 v[84:87], v8 offset:6400
    s_waitcnt lgkmcnt(15)
    v_mfma_f32_16x16x32_bf16 v[180:183], v[68:71], v[36:39], v[180:183]
    ds_read_b128 v[88:91], v8 offset:10240
    v_mfma_f32_16x16x32_bf16 v[176:179], v[64:67], v[36:39], v[176:179]
    ds_read_b128 v[92:95], v8 offset:10496
    v_mfma_f32_16x16x32_bf16 v[172:175], v[60:63], v[36:39], v[172:175]
    ds_read_b128 v[96:99], v8 offset:14336
    v_mfma_f32_16x16x32_bf16 v[168:171], v[56:59], v[36:39], v[168:171]
    ds_read_b128 v[100:103], v8 offset:14592
    s_mov_b32 s21, s22
    s_add_u32 s22, s22, 49152
    s_cmp_eq_u32 s22, 147456
    s_cselect_b32 s22, 0, s22
    s_waitcnt lgkmcnt(15)
    v_mfma_f32_16x16x32_bf16 v[184:187], v[56:59], v[40:43], v[184:187]
    v_add_u32 v8, s22, v7
    v_add_u32 v13, s22, v3
    v_mfma_f32_16x16x32_bf16 v[188:191], v[60:63], v[40:43], v[188:191]
    v_add_u32 v14, s22, v4
    v_add_u32 v15, s22, v5
    v_mfma_f32_16x16x32_bf16 v[192:195], v[64:67], v[40:43], v[192:195]
    v_add_u32 v16, s22, v6
    v_mfma_f32_16x16x32_bf16 v[196:199], v[68:71], v[40:43], v[196:199]
    s_waitcnt lgkmcnt(15)
    v_mfma_f32_16x16x32_bf16 v[212:215], v[68:71], v[44:47], v[212:215]
    v_mfma_f32_16x16x32_bf16 v[208:211], v[64:67], v[44:47], v[208:211]
    v_mfma_f32_16x16x32_bf16 v[204:207], v[60:63], v[44:47], v[204:207]
    v_mfma_f32_16x16x32_bf16 v[200:203], v[56:59], v[44:47], v[200:203]
    s_waitcnt lgkmcnt(15)
    v_mfma_f32_16x16x32_bf16 v[216:219], v[56:59], v[48:51], v[216:219]
    v_mfma_f32_16x16x32_bf16 v[220:223], v[60:63], v[48:51], v[220:223]
    v_mfma_f32_16x16x32_bf16 v[224:227], v[64:67], v[48:51], v[224:227]
    v_mfma_f32_16x16x32_bf16 v[228:231], v[68:71], v[48:51], v[228:231]
    s_waitcnt lgkmcnt(15)
    v_mfma_f32_16x16x32_bf16 v[244:247], v[68:71], v[52:55], v[244:247]
    v_mfma_f32_16x16x32_bf16 v[240:243], v[64:67], v[52:55], v[240:243]
    v_mfma_f32_16x16x32_bf16 v[236:239], v[60:63], v[52:55], v[236:239]
    v_mfma_f32_16x16x32_bf16 v[232:235], v[56:59], v[52:55], v[232:235]
    s_waitcnt vmcnt(63) lgkmcnt(0)
    s_barrier
    v_mfma_f32_16x16x32_bf16 v[120:123], v[104:107], v[72:75], v[120:123]
    ds_read_b128 v[24:27], v8 offset:0
    v_mfma_f32_16x16x32_bf16 v[124:127], v[108:111], v[72:75], v[124:127]
    ds_read_b64_tr_b16 v[56:57], v13 offset:0
    v_mfma_f32_16x16x32_bf16 v[128:131], v[112:115], v[72:75], v[128:131]
    ds_read_b64_tr_b16 v[58:59], v13 offset:1024
    v_mfma_f32_16x16x32_bf16 v[132:135], v[116:119], v[72:75], v[132:135]
    ds_read_b64_tr_b16 v[60:61], v14 offset:0
    v_mfma_f32_16x16x32_bf16 v[148:151], v[116:119], v[76:79], v[148:151]
    ds_read_b64_tr_b16 v[62:63], v14 offset:1024
    v_mfma_f32_16x16x32_bf16 v[144:147], v[112:115], v[76:79], v[144:147]
    ds_read_b64_tr_b16 v[64:65], v15 offset:0
    v_mfma_f32_16x16x32_bf16 v[140:143], v[108:111], v[76:79], v[140:143]
    ds_read_b64_tr_b16 v[66:67], v15 offset:1024
    v_mfma_f32_16x16x32_bf16 v[136:139], v[104:107], v[76:79], v[136:139]
    ds_read_b64_tr_b16 v[68:69], v16 offset:0
    v_mfma_f32_16x16x32_bf16 v[152:155], v[104:107], v[80:83], v[152:155]
    ds_read_b64_tr_b16 v[70:71], v16 offset:1024
    v_mfma_f32_16x16x32_bf16 v[156:159], v[108:111], v[80:83], v[156:159]
    ds_read_b128 v[28:31], v8 offset:256
    v_mfma_f32_16x16x32_bf16 v[160:163], v[112:115], v[80:83], v[160:163]
    ds_read_b128 v[32:35], v8 offset:4096
    v_mfma_f32_16x16x32_bf16 v[164:167], v[116:119], v[80:83], v[164:167]
    ds_read_b128 v[36:39], v8 offset:4352
    v_mfma_f32_16x16x32_bf16 v[180:183], v[116:119], v[84:87], v[180:183]
    ds_read_b128 v[40:43], v8 offset:8192
    v_mfma_f32_16x16x32_bf16 v[176:179], v[112:115], v[84:87], v[176:179]
    ds_read_b128 v[44:47], v8 offset:8448
    v_mfma_f32_16x16x32_bf16 v[172:175], v[108:111], v[84:87], v[172:175]
    ds_read_b128 v[48:51], v8 offset:12288
    v_mfma_f32_16x16x32_bf16 v[168:171], v[104:107], v[84:87], v[168:171]
    ds_read_b128 v[52:55], v8 offset:12544
    v_mfma_f32_16x16x32_bf16 v[184:187], v[104:107], v[88:91], v[184:187]
    v_mfma_f32_16x16x32_bf16 v[188:191], v[108:111], v[88:91], v[188:191]
    v_mfma_f32_16x16x32_bf16 v[192:195], v[112:115], v[88:91], v[192:195]
    v_mfma_f32_16x16x32_bf16 v[196:199], v[116:119], v[88:91], v[196:199]
    v_mfma_f32_16x16x32_bf16 v[212:215], v[116:119], v[92:95], v[212:215]
    v_mfma_f32_16x16x32_bf16 v[208:211], v[112:115], v[92:95], v[208:211]
    v_mfma_f32_16x16x32_bf16 v[204:207], v[108:111], v[92:95], v[204:207]
    v_mfma_f32_16x16x32_bf16 v[200:203], v[104:107], v[92:95], v[200:203]
    v_mfma_f32_16x16x32_bf16 v[216:219], v[104:107], v[96:99], v[216:219]
    v_mfma_f32_16x16x32_bf16 v[220:223], v[108:111], v[96:99], v[220:223]
    v_mfma_f32_16x16x32_bf16 v[224:227], v[112:115], v[96:99], v[224:227]
    v_mfma_f32_16x16x32_bf16 v[228:231], v[116:119], v[96:99], v[228:231]
    v_mfma_f32_16x16x32_bf16 v[244:247], v[116:119], v[100:103], v[244:247]
    v_mfma_f32_16x16x32_bf16 v[240:243], v[112:115], v[100:103], v[240:243]
    v_mfma_f32_16x16x32_bf16 v[236:239], v[108:111], v[100:103], v[236:239]
    v_mfma_f32_16x16x32_bf16 v[232:235], v[104:107], v[100:103], v[232:235]
    s_waitcnt lgkmcnt(13)
    v_mfma_f32_16x16x32_bf16 v[120:123], v[56:59], v[24:27], v[120:123]
    ds_read_b128 v[72:75], v8 offset:2048
    s_waitcnt lgkmcnt(12)
    v_mfma_f32_16x16x32_bf16 v[124:127], v[60:63], v[24:27], v[124:127]
    ds_read_b64_tr_b16 v[104:105], v13 offset:8192
    s_waitcnt lgkmcnt(11)
    v_mfma_f32_16x16x32_bf16 v[128:131], v[64:67], v[24:27], v[128:131]
    ds_read_b64_tr_b16 v[106:107], v13 offset:9216
    s_waitcnt lgkmcnt(10)
    v_mfma_f32_16x16x32_bf16 v[132:135], v[68:71], v[24:27], v[132:135]
    ds_read_b64_tr_b16 v[108:109], v14 offset:8192
    s_waitcnt lgkmcnt(10)
    v_mfma_f32_16x16x32_bf16 v[148:151], v[68:71], v[28:31], v[148:151]
    ds_read_b64_tr_b16 v[110:111], v14 offset:9216
    v_mfma_f32_16x16x32_bf16 v[144:147], v[64:67], v[28:31], v[144:147]
    ds_read_b64_tr_b16 v[112:113], v15 offset:8192
    v_mfma_f32_16x16x32_bf16 v[140:143], v[60:63], v[28:31], v[140:143]
    ds_read_b64_tr_b16 v[114:115], v15 offset:9216
    v_mfma_f32_16x16x32_bf16 v[136:139], v[56:59], v[28:31], v[136:139]
    ds_read_b64_tr_b16 v[116:117], v16 offset:8192
    s_waitcnt lgkmcnt(13)
    v_mfma_f32_16x16x32_bf16 v[152:155], v[56:59], v[32:35], v[152:155]
    ds_read_b64_tr_b16 v[118:119], v16 offset:9216
    v_mfma_f32_16x16x32_bf16 v[156:159], v[60:63], v[32:35], v[156:159]
    ds_read_b128 v[76:79], v8 offset:2304
    v_mfma_f32_16x16x32_bf16 v[160:163], v[64:67], v[32:35], v[160:163]
    ds_read_b128 v[80:83], v8 offset:6144
    v_mfma_f32_16x16x32_bf16 v[164:167], v[68:71], v[32:35], v[164:167]
    ds_read_b128 v[84:87], v8 offset:6400
    s_waitcnt lgkmcnt(15)
    v_mfma_f32_16x16x32_bf16 v[180:183], v[68:71], v[36:39], v[180:183]
    ds_read_b128 v[88:91], v8 offset:10240
    v_mfma_f32_16x16x32_bf16 v[176:179], v[64:67], v[36:39], v[176:179]
    ds_read_b128 v[92:95], v8 offset:10496
    v_mfma_f32_16x16x32_bf16 v[172:175], v[60:63], v[36:39], v[172:175]
    ds_read_b128 v[96:99], v8 offset:14336
    v_mfma_f32_16x16x32_bf16 v[168:171], v[56:59], v[36:39], v[168:171]
    ds_read_b128 v[100:103], v8 offset:14592
    s_mov_b32 s21, s22
    s_add_u32 s22, s22, 49152
    s_cmp_eq_u32 s22, 147456
    s_cselect_b32 s22, 0, s22
    s_waitcnt lgkmcnt(15)
    v_mfma_f32_16x16x32_bf16 v[184:187], v[56:59], v[40:43], v[184:187]
    v_add_u32 v8, s22, v7
    v_add_u32 v13, s22, v3
    v_mfma_f32_16x16x32_bf16 v[188:191], v[60:63], v[40:43], v[188:191]
    v_add_u32 v14, s22, v4
    v_add_u32 v15, s22, v5
    v_mfma_f32_16x16x32_bf16 v[192:195], v[64:67], v[40:43], v[192:195]
    v_add_u32 v16, s22, v6
    v_mfma_f32_16x16x32_bf16 v[196:199], v[68:71], v[40:43], v[196:199]
    s_waitcnt lgkmcnt(15)
    v_mfma_f32_16x16x32_bf16 v[212:215], v[68:71], v[44:47], v[212:215]
    v_mfma_f32_16x16x32_bf16 v[208:211], v[64:67], v[44:47], v[208:211]
    v_mfma_f32_16x16x32_bf16 v[204:207], v[60:63], v[44:47], v[204:207]
    v_mfma_f32_16x16x32_bf16 v[200:203], v[56:59], v[44:47], v[200:203]
    s_waitcnt lgkmcnt(15)
    v_mfma_f32_16x16x32_bf16 v[216:219], v[56:59], v[48:51], v[216:219]
    v_mfma_f32_16x16x32_bf16 v[220:223], v[60:63], v[48:51], v[220:223]
    v_mfma_f32_16x16x32_bf16 v[224:227], v[64:67], v[48:51], v[224:227]
    v_mfma_f32_16x16x32_bf16 v[228:231], v[68:71], v[48:51], v[228:231]
    s_waitcnt lgkmcnt(15)
    v_mfma_f32_16x16x32_bf16 v[244:247], v[68:71], v[52:55], v[244:247]
    v_mfma_f32_16x16x32_bf16 v[240:243], v[64:67], v[52:55], v[240:243]
    v_mfma_f32_16x16x32_bf16 v[236:239], v[60:63], v[52:55], v[236:239]
    v_mfma_f32_16x16x32_bf16 v[232:235], v[56:59], v[52:55], v[232:235]
    s_waitcnt vmcnt(63) lgkmcnt(0)
    s_barrier
    v_mfma_f32_16x16x32_bf16 v[120:123], v[104:107], v[72:75], v[120:123]
    ds_read_b128 v[24:27], v8 offset:0
    v_mfma_f32_16x16x32_bf16 v[124:127], v[108:111], v[72:75], v[124:127]
    ds_read_b64_tr_b16 v[56:57], v13 offset:0
    v_mfma_f32_16x16x32_bf16 v[128:131], v[112:115], v[72:75], v[128:131]
    ds_read_b64_tr_b16 v[58:59], v13 offset:1024
    v_mfma_f32_16x16x32_bf16 v[132:135], v[116:119], v[72:75], v[132:135]
    ds_read_b64_tr_b16 v[60:61], v14 offset:0
    v_mfma_f32_16x16x32_bf16 v[148:151], v[116:119], v[76:79], v[148:151]
    ds_read_b64_tr_b16 v[62:63], v14 offset:1024
    v_mfma_f32_16x16x32_bf16 v[144:147], v[112:115], v[76:79], v[144:147]
    ds_read_b64_tr_b16 v[64:65], v15 offset:0
    v_mfma_f32_16x16x32_bf16 v[140:143], v[108:111], v[76:79], v[140:143]
    ds_read_b64_tr_b16 v[66:67], v15 offset:1024
    v_mfma_f32_16x16x32_bf16 v[136:139], v[104:107], v[76:79], v[136:139]
    ds_read_b64_tr_b16 v[68:69], v16 offset:0
    v_mfma_f32_16x16x32_bf16 v[152:155], v[104:107], v[80:83], v[152:155]
    ds_read_b64_tr_b16 v[70:71], v16 offset:1024
    v_mfma_f32_16x16x32_bf16 v[156:159], v[108:111], v[80:83], v[156:159]
    ds_read_b128 v[28:31], v8 offset:256
    v_mfma_f32_16x16x32_bf16 v[160:163], v[112:115], v[80:83], v[160:163]
    ds_read_b128 v[32:35], v8 offset:4096
    v_mfma_f32_16x16x32_bf16 v[164:167], v[116:119], v[80:83], v[164:167]
    ds_read_b128 v[36:39], v8 offset:4352
    v_mfma_f32_16x16x32_bf16 v[180:183], v[116:119], v[84:87], v[180:183]
    ds_read_b128 v[40:43], v8 offset:8192
    v_mfma_f32_16x16x32_bf16 v[176:179], v[112:115], v[84:87], v[176:179]
    ds_read_b128 v[44:47], v8 offset:8448
    v_mfma_f32_16x16x32_bf16 v[172:175], v[108:111], v[84:87], v[172:175]
    ds_read_b128 v[48:51], v8 offset:12288
    v_mfma_f32_16x16x32_bf16 v[168:171], v[104:107], v[84:87], v[168:171]
    ds_read_b128 v[52:55], v8 offset:12544
    v_mfma_f32_16x16x32_bf16 v[184:187], v[104:107], v[88:91], v[184:187]
    v_mfma_f32_16x16x32_bf16 v[188:191], v[108:111], v[88:91], v[188:191]
    v_mfma_f32_16x16x32_bf16 v[192:195], v[112:115], v[88:91], v[192:195]
    v_mfma_f32_16x16x32_bf16 v[196:199], v[116:119], v[88:91], v[196:199]
    v_mfma_f32_16x16x32_bf16 v[212:215], v[116:119], v[92:95], v[212:215]
    v_mfma_f32_16x16x32_bf16 v[208:211], v[112:115], v[92:95], v[208:211]
    v_mfma_f32_16x16x32_bf16 v[204:207], v[108:111], v[92:95], v[204:207]
    v_mfma_f32_16x16x32_bf16 v[200:203], v[104:107], v[92:95], v[200:203]
    v_mfma_f32_16x16x32_bf16 v[216:219], v[104:107], v[96:99], v[216:219]
    v_mfma_f32_16x16x32_bf16 v[220:223], v[108:111], v[96:99], v[220:223]
    v_mfma_f32_16x16x32_bf16 v[224:227], v[112:115], v[96:99], v[224:227]
    v_mfma_f32_16x16x32_bf16 v[228:231], v[116:119], v[96:99], v[228:231]
    v_mfma_f32_16x16x32_bf16 v[244:247], v[116:119], v[100:103], v[244:247]
    v_mfma_f32_16x16x32_bf16 v[240:243], v[112:115], v[100:103], v[240:243]
    v_mfma_f32_16x16x32_bf16 v[236:239], v[108:111], v[100:103], v[236:239]
    v_mfma_f32_16x16x32_bf16 v[232:235], v[104:107], v[100:103], v[232:235]
    s_waitcnt lgkmcnt(13)
    v_mfma_f32_16x16x32_bf16 v[120:123], v[56:59], v[24:27], v[120:123]
    ds_read_b128 v[72:75], v8 offset:2048
    s_waitcnt lgkmcnt(12)
    v_mfma_f32_16x16x32_bf16 v[124:127], v[60:63], v[24:27], v[124:127]
    ds_read_b64_tr_b16 v[104:105], v13 offset:8192
    s_waitcnt lgkmcnt(11)
    v_mfma_f32_16x16x32_bf16 v[128:131], v[64:67], v[24:27], v[128:131]
    ds_read_b64_tr_b16 v[106:107], v13 offset:9216
    s_waitcnt lgkmcnt(10)
    v_mfma_f32_16x16x32_bf16 v[132:135], v[68:71], v[24:27], v[132:135]
    ds_read_b64_tr_b16 v[108:109], v14 offset:8192
    s_waitcnt lgkmcnt(10)
    v_mfma_f32_16x16x32_bf16 v[148:151], v[68:71], v[28:31], v[148:151]
    ds_read_b64_tr_b16 v[110:111], v14 offset:9216
    v_mfma_f32_16x16x32_bf16 v[144:147], v[64:67], v[28:31], v[144:147]
    ds_read_b64_tr_b16 v[112:113], v15 offset:8192
    v_mfma_f32_16x16x32_bf16 v[140:143], v[60:63], v[28:31], v[140:143]
    ds_read_b64_tr_b16 v[114:115], v15 offset:9216
    v_mfma_f32_16x16x32_bf16 v[136:139], v[56:59], v[28:31], v[136:139]
    ds_read_b64_tr_b16 v[116:117], v16 offset:8192
    s_waitcnt lgkmcnt(13)
    v_mfma_f32_16x16x32_bf16 v[152:155], v[56:59], v[32:35], v[152:155]
    ds_read_b64_tr_b16 v[118:119], v16 offset:9216
    v_mfma_f32_16x16x32_bf16 v[156:159], v[60:63], v[32:35], v[156:159]
    ds_read_b128 v[76:79], v8 offset:2304
    v_mfma_f32_16x16x32_bf16 v[160:163], v[64:67], v[32:35], v[160:163]
    ds_read_b128 v[80:83], v8 offset:6144
    v_mfma_f32_16x16x32_bf16 v[164:167], v[68:71], v[32:35], v[164:167]
    ds_read_b128 v[84:87], v8 offset:6400
    s_waitcnt lgkmcnt(15)
    v_mfma_f32_16x16x32_bf16 v[180:183], v[68:71], v[36:39], v[180:183]
    ds_read_b128 v[88:91], v8 offset:10240
    v_mfma_f32_16x16x32_bf16 v[176:179], v[64:67], v[36:39], v[176:179]
    ds_read_b128 v[92:95], v8 offset:10496
    v_mfma_f32_16x16x32_bf16 v[172:175], v[60:63], v[36:39], v[172:175]
    ds_read_b128 v[96:99], v8 offset:14336
    v_mfma_f32_16x16x32_bf16 v[168:171], v[56:59], v[36:39], v[168:171]
    ds_read_b128 v[100:103], v8 offset:14592
    s_mov_b32 s21, s22
    s_add_u32 s22, s22, 49152
    s_cmp_eq_u32 s22, 147456
    s_cselect_b32 s22, 0, s22
    s_waitcnt lgkmcnt(15)
    v_mfma_f32_16x16x32_bf16 v[184:187], v[56:59], v[40:43], v[184:187]
    v_add_u32 v8, s22, v7
    v_add_u32 v13, s22, v3
    v_mfma_f32_16x16x32_bf16 v[188:191], v[60:63], v[40:43], v[188:191]
    v_add_u32 v14, s22, v4
    v_add_u32 v15, s22, v5
    v_mfma_f32_16x16x32_bf16 v[192:195], v[64:67], v[40:43], v[192:195]
    v_add_u32 v16, s22, v6
    v_mfma_f32_16x16x32_bf16 v[196:199], v[68:71], v[40:43], v[196:199]
    s_waitcnt lgkmcnt(15)
    v_mfma_f32_16x16x32_bf16 v[212:215], v[68:71], v[44:47], v[212:215]
    v_mfma_f32_16x16x32_bf16 v[208:211], v[64:67], v[44:47], v[208:211]
    v_mfma_f32_16x16x32_bf16 v[204:207], v[60:63], v[44:47], v[204:207]
    v_mfma_f32_16x16x32_bf16 v[200:203], v[56:59], v[44:47], v[200:203]
    s_waitcnt lgkmcnt(15)
    v_mfma_f32_16x16x32_bf16 v[216:219], v[56:59], v[48:51], v[216:219]
    v_mfma_f32_16x16x32_bf16 v[220:223], v[60:63], v[48:51], v[220:223]
    v_mfma_f32_16x16x32_bf16 v[224:227], v[64:67], v[48:51], v[224:227]
    v_mfma_f32_16x16x32_bf16 v[228:231], v[68:71], v[48:51], v[228:231]
    s_waitcnt lgkmcnt(15)
    v_mfma_f32_16x16x32_bf16 v[244:247], v[68:71], v[52:55], v[244:247]
    v_mfma_f32_16x16x32_bf16 v[240:243], v[64:67], v[52:55], v[240:243]
    v_mfma_f32_16x16x32_bf16 v[236:239], v[60:63], v[52:55], v[236:239]
    v_mfma_f32_16x16x32_bf16 v[232:235], v[56:59], v[52:55], v[232:235]
    s_waitcnt vmcnt(63) lgkmcnt(0)
    s_barrier
    v_mfma_f32_16x16x32_bf16 v[120:123], v[104:107], v[72:75], v[120:123]
    ds_read_b128 v[24:27], v8 offset:0
    v_mfma_f32_16x16x32_bf16 v[124:127], v[108:111], v[72:75], v[124:127]
    ds_read_b64_tr_b16 v[56:57], v13 offset:0
    v_mfma_f32_16x16x32_bf16 v[128:131], v[112:115], v[72:75], v[128:131]
    ds_read_b64_tr_b16 v[58:59], v13 offset:1024
    v_mfma_f32_16x16x32_bf16 v[132:135], v[116:119], v[72:75], v[132:135]
    ds_read_b64_tr_b16 v[60:61], v14 offset:0
    v_mfma_f32_16x16x32_bf16 v[148:151], v[116:119], v[76:79], v[148:151]
    ds_read_b64_tr_b16 v[62:63], v14 offset:1024
    v_mfma_f32_16x16x32_bf16 v[144:147], v[112:115], v[76:79], v[144:147]
    ds_read_b64_tr_b16 v[64:65], v15 offset:0
    v_mfma_f32_16x16x32_bf16 v[140:143], v[108:111], v[76:79], v[140:143]
    ds_read_b64_tr_b16 v[66:67], v15 offset:1024
    v_mfma_f32_16x16x32_bf16 v[136:139], v[104:107], v[76:79], v[136:139]
    ds_read_b64_tr_b16 v[68:69], v16 offset:0
    v_mfma_f32_16x16x32_bf16 v[152:155], v[104:107], v[80:83], v[152:155]
    ds_read_b64_tr_b16 v[70:71], v16 offset:1024
    v_mfma_f32_16x16x32_bf16 v[156:159], v[108:111], v[80:83], v[156:159]
    ds_read_b128 v[28:31], v8 offset:256
    v_mfma_f32_16x16x32_bf16 v[160:163], v[112:115], v[80:83], v[160:163]
    ds_read_b128 v[32:35], v8 offset:4096
    v_mfma_f32_16x16x32_bf16 v[164:167], v[116:119], v[80:83], v[164:167]
    ds_read_b128 v[36:39], v8 offset:4352
    v_mfma_f32_16x16x32_bf16 v[180:183], v[116:119], v[84:87], v[180:183]
    ds_read_b128 v[40:43], v8 offset:8192
    v_mfma_f32_16x16x32_bf16 v[176:179], v[112:115], v[84:87], v[176:179]
    ds_read_b128 v[44:47], v8 offset:8448
    v_mfma_f32_16x16x32_bf16 v[172:175], v[108:111], v[84:87], v[172:175]
    ds_read_b128 v[48:51], v8 offset:12288
    v_mfma_f32_16x16x32_bf16 v[168:171], v[104:107], v[84:87], v[168:171]
    ds_read_b128 v[52:55], v8 offset:12544
    v_mfma_f32_16x16x32_bf16 v[184:187], v[104:107], v[88:91], v[184:187]
    v_mfma_f32_16x16x32_bf16 v[188:191], v[108:111], v[88:91], v[188:191]
    v_mfma_f32_16x16x32_bf16 v[192:195], v[112:115], v[88:91], v[192:195]
    v_mfma_f32_16x16x32_bf16 v[196:199], v[116:119], v[88:91], v[196:199]
    v_mfma_f32_16x16x32_bf16 v[212:215], v[116:119], v[92:95], v[212:215]
    v_mfma_f32_16x16x32_bf16 v[208:211], v[112:115], v[92:95], v[208:211]
    v_mfma_f32_16x16x32_bf16 v[204:207], v[108:111], v[92:95], v[204:207]
    v_mfma_f32_16x16x32_bf16 v[200:203], v[104:107], v[92:95], v[200:203]
    v_mfma_f32_16x16x32_bf16 v[216:219], v[104:107], v[96:99], v[216:219]
    v_mfma_f32_16x16x32_bf16 v[220:223], v[108:111], v[96:99], v[220:223]
    v_mfma_f32_16x16x32_bf16 v[224:227], v[112:115], v[96:99], v[224:227]
    v_mfma_f32_16x16x32_bf16 v[228:231], v[116:119], v[96:99], v[228:231]
    v_mfma_f32_16x16x32_bf16 v[244:247], v[116:119], v[100:103], v[244:247]
    v_mfma_f32_16x16x32_bf16 v[240:243], v[112:115], v[100:103], v[240:243]
    v_mfma_f32_16x16x32_bf16 v[236:239], v[108:111], v[100:103], v[236:239]
    v_mfma_f32_16x16x32_bf16 v[232:235], v[104:107], v[100:103], v[232:235]
    s_waitcnt lgkmcnt(13)
    v_mfma_f32_16x16x32_bf16 v[120:123], v[56:59], v[24:27], v[120:123]
    ds_read_b128 v[72:75], v8 offset:2048
    s_waitcnt lgkmcnt(12)
    v_mfma_f32_16x16x32_bf16 v[124:127], v[60:63], v[24:27], v[124:127]
    ds_read_b64_tr_b16 v[104:105], v13 offset:8192
    s_waitcnt lgkmcnt(11)
    v_mfma_f32_16x16x32_bf16 v[128:131], v[64:67], v[24:27], v[128:131]
    ds_read_b64_tr_b16 v[106:107], v13 offset:9216
    s_waitcnt lgkmcnt(10)
    v_mfma_f32_16x16x32_bf16 v[132:135], v[68:71], v[24:27], v[132:135]
    ds_read_b64_tr_b16 v[108:109], v14 offset:8192
    s_waitcnt lgkmcnt(10)
    v_mfma_f32_16x16x32_bf16 v[148:151], v[68:71], v[28:31], v[148:151]
    ds_read_b64_tr_b16 v[110:111], v14 offset:9216
    v_mfma_f32_16x16x32_bf16 v[144:147], v[64:67], v[28:31], v[144:147]
    ds_read_b64_tr_b16 v[112:113], v15 offset:8192
    v_mfma_f32_16x16x32_bf16 v[140:143], v[60:63], v[28:31], v[140:143]
    ds_read_b64_tr_b16 v[114:115], v15 offset:9216
    v_mfma_f32_16x16x32_bf16 v[136:139], v[56:59], v[28:31], v[136:139]
    ds_read_b64_tr_b16 v[116:117], v16 offset:8192
    s_waitcnt lgkmcnt(13)
    v_mfma_f32_16x16x32_bf16 v[152:155], v[56:59], v[32:35], v[152:155]
    ds_read_b64_tr_b16 v[118:119], v16 offset:9216
    v_mfma_f32_16x16x32_bf16 v[156:159], v[60:63], v[32:35], v[156:159]
    ds_read_b128 v[76:79], v8 offset:2304
    v_mfma_f32_16x16x32_bf16 v[160:163], v[64:67], v[32:35], v[160:163]
    ds_read_b128 v[80:83], v8 offset:6144
    v_mfma_f32_16x16x32_bf16 v[164:167], v[68:71], v[32:35], v[164:167]
    ds_read_b128 v[84:87], v8 offset:6400
    s_waitcnt lgkmcnt(15)
    v_mfma_f32_16x16x32_bf16 v[180:183], v[68:71], v[36:39], v[180:183]
    ds_read_b128 v[88:91], v8 offset:10240
    v_mfma_f32_16x16x32_bf16 v[176:179], v[64:67], v[36:39], v[176:179]
    ds_read_b128 v[92:95], v8 offset:10496
    v_mfma_f32_16x16x32_bf16 v[172:175], v[60:63], v[36:39], v[172:175]
    ds_read_b128 v[96:99], v8 offset:14336
    v_mfma_f32_16x16x32_bf16 v[168:171], v[56:59], v[36:39], v[168:171]
    ds_read_b128 v[100:103], v8 offset:14592
    s_mov_b32 s21, s22
    s_add_u32 s22, s22, 49152
    s_cmp_eq_u32 s22, 147456
    s_cselect_b32 s22, 0, s22
    s_waitcnt lgkmcnt(15)
    v_mfma_f32_16x16x32_bf16 v[184:187], v[56:59], v[40:43], v[184:187]
    v_add_u32 v8, s22, v7
    v_add_u32 v13, s22, v3
    v_mfma_f32_16x16x32_bf16 v[188:191], v[60:63], v[40:43], v[188:191]
    v_add_u32 v14, s22, v4
    v_add_u32 v15, s22, v5
    v_mfma_f32_16x16x32_bf16 v[192:195], v[64:67], v[40:43], v[192:195]
    v_add_u32 v16, s22, v6
    v_mfma_f32_16x16x32_bf16 v[196:199], v[68:71], v[40:43], v[196:199]
    s_waitcnt lgkmcnt(15)
    v_mfma_f32_16x16x32_bf16 v[212:215], v[68:71], v[44:47], v[212:215]
    v_mfma_f32_16x16x32_bf16 v[208:211], v[64:67], v[44:47], v[208:211]
    v_mfma_f32_16x16x32_bf16 v[204:207], v[60:63], v[44:47], v[204:207]
    v_mfma_f32_16x16x32_bf16 v[200:203], v[56:59], v[44:47], v[200:203]
    s_waitcnt lgkmcnt(15)
    v_mfma_f32_16x16x32_bf16 v[216:219], v[56:59], v[48:51], v[216:219]
    v_mfma_f32_16x16x32_bf16 v[220:223], v[60:63], v[48:51], v[220:223]
    v_mfma_f32_16x16x32_bf16 v[224:227], v[64:67], v[48:51], v[224:227]
    v_mfma_f32_16x16x32_bf16 v[228:231], v[68:71], v[48:51], v[228:231]
    s_waitcnt lgkmcnt(15)
    v_mfma_f32_16x16x32_bf16 v[244:247], v[68:71], v[52:55], v[244:247]
    v_mfma_f32_16x16x32_bf16 v[240:243], v[64:67], v[52:55], v[240:243]
    v_mfma_f32_16x16x32_bf16 v[236:239], v[60:63], v[52:55], v[236:239]
    v_mfma_f32_16x16x32_bf16 v[232:235], v[56:59], v[52:55], v[232:235]
    s_waitcnt vmcnt(63) lgkmcnt(0)
    s_barrier
    v_mfma_f32_16x16x32_bf16 v[120:123], v[104:107], v[72:75], v[120:123]
    ds_read_b128 v[24:27], v8 offset:0
    v_mfma_f32_16x16x32_bf16 v[124:127], v[108:111], v[72:75], v[124:127]
    ds_read_b64_tr_b16 v[56:57], v13 offset:0
    v_mfma_f32_16x16x32_bf16 v[128:131], v[112:115], v[72:75], v[128:131]
    ds_read_b64_tr_b16 v[58:59], v13 offset:1024
    v_mfma_f32_16x16x32_bf16 v[132:135], v[116:119], v[72:75], v[132:135]
    ds_read_b64_tr_b16 v[60:61], v14 offset:0
    v_mfma_f32_16x16x32_bf16 v[148:151], v[116:119], v[76:79], v[148:151]
    ds_read_b64_tr_b16 v[62:63], v14 offset:1024
    v_mfma_f32_16x16x32_bf16 v[144:147], v[112:115], v[76:79], v[144:147]
    ds_read_b64_tr_b16 v[64:65], v15 offset:0
    v_mfma_f32_16x16x32_bf16 v[140:143], v[108:111], v[76:79], v[140:143]
    ds_read_b64_tr_b16 v[66:67], v15 offset:1024
    v_mfma_f32_16x16x32_bf16 v[136:139], v[104:107], v[76:79], v[136:139]
    ds_read_b64_tr_b16 v[68:69], v16 offset:0
    v_mfma_f32_16x16x32_bf16 v[152:155], v[104:107], v[80:83], v[152:155]
    ds_read_b64_tr_b16 v[70:71], v16 offset:1024
    v_mfma_f32_16x16x32_bf16 v[156:159], v[108:111], v[80:83], v[156:159]
    ds_read_b128 v[28:31], v8 offset:256
    v_mfma_f32_16x16x32_bf16 v[160:163], v[112:115], v[80:83], v[160:163]
    ds_read_b128 v[32:35], v8 offset:4096
    v_mfma_f32_16x16x32_bf16 v[164:167], v[116:119], v[80:83], v[164:167]
    ds_read_b128 v[36:39], v8 offset:4352
    v_mfma_f32_16x16x32_bf16 v[180:183], v[116:119], v[84:87], v[180:183]
    ds_read_b128 v[40:43], v8 offset:8192
    v_mfma_f32_16x16x32_bf16 v[176:179], v[112:115], v[84:87], v[176:179]
    ds_read_b128 v[44:47], v8 offset:8448
    v_mfma_f32_16x16x32_bf16 v[172:175], v[108:111], v[84:87], v[172:175]
    ds_read_b128 v[48:51], v8 offset:12288
    v_mfma_f32_16x16x32_bf16 v[168:171], v[104:107], v[84:87], v[168:171]
    ds_read_b128 v[52:55], v8 offset:12544
    v_mfma_f32_16x16x32_bf16 v[184:187], v[104:107], v[88:91], v[184:187]
    v_mfma_f32_16x16x32_bf16 v[188:191], v[108:111], v[88:91], v[188:191]
    v_mfma_f32_16x16x32_bf16 v[192:195], v[112:115], v[88:91], v[192:195]
    v_mfma_f32_16x16x32_bf16 v[196:199], v[116:119], v[88:91], v[196:199]
    v_mfma_f32_16x16x32_bf16 v[212:215], v[116:119], v[92:95], v[212:215]
    v_mfma_f32_16x16x32_bf16 v[208:211], v[112:115], v[92:95], v[208:211]
    v_mfma_f32_16x16x32_bf16 v[204:207], v[108:111], v[92:95], v[204:207]
    v_mfma_f32_16x16x32_bf16 v[200:203], v[104:107], v[92:95], v[200:203]
    v_mfma_f32_16x16x32_bf16 v[216:219], v[104:107], v[96:99], v[216:219]
    v_mfma_f32_16x16x32_bf16 v[220:223], v[108:111], v[96:99], v[220:223]
    v_mfma_f32_16x16x32_bf16 v[224:227], v[112:115], v[96:99], v[224:227]
    v_mfma_f32_16x16x32_bf16 v[228:231], v[116:119], v[96:99], v[228:231]
    v_mfma_f32_16x16x32_bf16 v[244:247], v[116:119], v[100:103], v[244:247]
    v_mfma_f32_16x16x32_bf16 v[240:243], v[112:115], v[100:103], v[240:243]
    v_mfma_f32_16x16x32_bf16 v[236:239], v[108:111], v[100:103], v[236:239]
    v_mfma_f32_16x16x32_bf16 v[232:235], v[104:107], v[100:103], v[232:235]
    s_sub_u32 s49, s49, 1
    s_cmp_lg_u32 s49, 0
    s_cbranch_scc1 L_parallel_sum__sliding_block__mixer_token_mlp__prompt_kernel_mcl
    s_waitcnt lgkmcnt(0)
    s_barrier
    s_mov_b32 s61, 1
    s_nop 7
    s_mov_b32 s43, 0xbdd2d3e8
    s_mul_i32 s40, s38, 1835008
    s_lshl_b32 s41, s39, 1
    s_add_u32 s41, s41, s25
    s_lshl_b32 s41, s41, 15
    s_add_u32 s40, s40, s41
    s_lshl_b32 s41, s24, 14
    s_add_u32 s40, s40, s41
    v_mov_b32 v15, s43
    v_lshrrev_b32 v17, 4, v1
    v_and_b32 v18, 15, v1
    v_lshlrev_b32 v18, 4, v18
    v_lshl_add_u32 v17, v17, 9, v18
    v_mul_f32 v24, v120, v120
    v_mul_f32 v25, v121, v121
    v_mul_f32 v26, v122, v122
    v_mul_f32 v27, v123, v123
    v_mul_f32 v28, v124, v124
    v_mul_f32 v29, v125, v125
    v_mul_f32 v30, v126, v126
    v_mul_f32 v31, v127, v127
    v_mul_f32 v32, v128, v128
    v_mul_f32 v33, v129, v129
    v_mul_f32 v34, v130, v130
    v_mul_f32 v35, v131, v131
    v_mul_f32 v36, v132, v132
    v_mul_f32 v37, v133, v133
    v_mul_f32 v38, v134, v134
    v_mul_f32 v39, v135, v135
    v_fmaak_f32 v24, v15, v24, 0xc0135761
    v_fmaak_f32 v25, v15, v25, 0xc0135761
    v_fmaak_f32 v26, v15, v26, 0xc0135761
    v_fmaak_f32 v27, v15, v27, 0xc0135761
    v_fmaak_f32 v28, v15, v28, 0xc0135761
    v_fmaak_f32 v29, v15, v29, 0xc0135761
    v_fmaak_f32 v30, v15, v30, 0xc0135761
    v_fmaak_f32 v31, v15, v31, 0xc0135761
    v_fmaak_f32 v32, v15, v32, 0xc0135761
    v_fmaak_f32 v33, v15, v33, 0xc0135761
    v_fmaak_f32 v34, v15, v34, 0xc0135761
    v_fmaak_f32 v35, v15, v35, 0xc0135761
    v_fmaak_f32 v36, v15, v36, 0xc0135761
    v_fmaak_f32 v37, v15, v37, 0xc0135761
    v_fmaak_f32 v38, v15, v38, 0xc0135761
    v_fmaak_f32 v39, v15, v39, 0xc0135761
    v_mul_f32 v24, v24, v120
    v_mul_f32 v25, v25, v121
    v_mul_f32 v26, v26, v122
    v_mul_f32 v27, v27, v123
    v_mul_f32 v28, v28, v124
    v_mul_f32 v29, v29, v125
    v_mul_f32 v30, v30, v126
    v_mul_f32 v31, v31, v127
    v_mul_f32 v32, v32, v128
    v_mul_f32 v33, v33, v129
    v_mul_f32 v34, v34, v130
    v_mul_f32 v35, v35, v131
    v_mul_f32 v36, v36, v132
    v_mul_f32 v37, v37, v133
    v_mul_f32 v38, v38, v134
    v_mul_f32 v39, v39, v135
    v_exp_f32 v24, v24
    v_exp_f32 v25, v25
    v_exp_f32 v26, v26
    v_exp_f32 v27, v27
    v_exp_f32 v28, v28
    v_exp_f32 v29, v29
    v_exp_f32 v30, v30
    v_exp_f32 v31, v31
    v_exp_f32 v32, v32
    v_exp_f32 v33, v33
    v_exp_f32 v34, v34
    v_exp_f32 v35, v35
    v_exp_f32 v36, v36
    v_exp_f32 v37, v37
    v_exp_f32 v38, v38
    v_exp_f32 v39, v39
    v_add_f32 v24, 1.0, v24
    v_add_f32 v25, 1.0, v25
    v_add_f32 v26, 1.0, v26
    v_add_f32 v27, 1.0, v27
    v_add_f32 v28, 1.0, v28
    v_add_f32 v29, 1.0, v29
    v_add_f32 v30, 1.0, v30
    v_add_f32 v31, 1.0, v31
    v_add_f32 v32, 1.0, v32
    v_add_f32 v33, 1.0, v33
    v_add_f32 v34, 1.0, v34
    v_add_f32 v35, 1.0, v35
    v_add_f32 v36, 1.0, v36
    v_add_f32 v37, 1.0, v37
    v_add_f32 v38, 1.0, v38
    v_add_f32 v39, 1.0, v39
    v_rcp_f32 v24, v24
    v_rcp_f32 v25, v25
    v_rcp_f32 v26, v26
    v_rcp_f32 v27, v27
    v_rcp_f32 v28, v28
    v_rcp_f32 v29, v29
    v_rcp_f32 v30, v30
    v_rcp_f32 v31, v31
    v_rcp_f32 v32, v32
    v_rcp_f32 v33, v33
    v_rcp_f32 v34, v34
    v_rcp_f32 v35, v35
    v_rcp_f32 v36, v36
    v_rcp_f32 v37, v37
    v_rcp_f32 v38, v38
    v_rcp_f32 v39, v39
    v_mul_f32 v120, v120, v24
    v_mul_f32 v121, v121, v25
    v_mul_f32 v122, v122, v26
    v_mul_f32 v123, v123, v27
    v_mul_f32 v124, v124, v28
    v_mul_f32 v125, v125, v29
    v_mul_f32 v126, v126, v30
    v_mul_f32 v127, v127, v31
    v_mul_f32 v128, v128, v32
    v_mul_f32 v129, v129, v33
    v_mul_f32 v130, v130, v34
    v_mul_f32 v131, v131, v35
    v_mul_f32 v132, v132, v36
    v_mul_f32 v133, v133, v37
    v_mul_f32 v134, v134, v38
    v_mul_f32 v135, v135, v39
    v_cvt_pk_bf16_f32 v120, v120, v121
    v_cvt_pk_bf16_f32 v121, v122, v123
    v_cvt_pk_bf16_f32 v122, v124, v125
    v_cvt_pk_bf16_f32 v123, v126, v127
    v_cvt_pk_bf16_f32 v124, v128, v129
    v_cvt_pk_bf16_f32 v125, v130, v131
    v_cvt_pk_bf16_f32 v126, v132, v133
    v_cvt_pk_bf16_f32 v127, v134, v135
    buffer_store_dwordx4 v[120:123], v17, s[12:15], s40 offen offset:0 sc1
    buffer_store_dwordx4 v[124:127], v17, s[12:15], s40 offen offset:2048 sc1
    v_mul_f32 v40, v136, v136
    v_mul_f32 v41, v137, v137
    v_mul_f32 v42, v138, v138
    v_mul_f32 v43, v139, v139
    v_mul_f32 v44, v140, v140
    v_mul_f32 v45, v141, v141
    v_mul_f32 v46, v142, v142
    v_mul_f32 v47, v143, v143
    v_mul_f32 v48, v144, v144
    v_mul_f32 v49, v145, v145
    v_mul_f32 v50, v146, v146
    v_mul_f32 v51, v147, v147
    v_mul_f32 v52, v148, v148
    v_mul_f32 v53, v149, v149
    v_mul_f32 v54, v150, v150
    v_mul_f32 v55, v151, v151
    v_fmaak_f32 v40, v15, v40, 0xc0135761
    v_fmaak_f32 v41, v15, v41, 0xc0135761
    v_fmaak_f32 v42, v15, v42, 0xc0135761
    v_fmaak_f32 v43, v15, v43, 0xc0135761
    v_fmaak_f32 v44, v15, v44, 0xc0135761
    v_fmaak_f32 v45, v15, v45, 0xc0135761
    v_fmaak_f32 v46, v15, v46, 0xc0135761
    v_fmaak_f32 v47, v15, v47, 0xc0135761
    v_fmaak_f32 v48, v15, v48, 0xc0135761
    v_fmaak_f32 v49, v15, v49, 0xc0135761
    v_fmaak_f32 v50, v15, v50, 0xc0135761
    v_fmaak_f32 v51, v15, v51, 0xc0135761
    v_fmaak_f32 v52, v15, v52, 0xc0135761
    v_fmaak_f32 v53, v15, v53, 0xc0135761
    v_fmaak_f32 v54, v15, v54, 0xc0135761
    v_fmaak_f32 v55, v15, v55, 0xc0135761
    v_mul_f32 v40, v40, v136
    v_mul_f32 v41, v41, v137
    v_mul_f32 v42, v42, v138
    v_mul_f32 v43, v43, v139
    v_mul_f32 v44, v44, v140
    v_mul_f32 v45, v45, v141
    v_mul_f32 v46, v46, v142
    v_mul_f32 v47, v47, v143
    v_mul_f32 v48, v48, v144
    v_mul_f32 v49, v49, v145
    v_mul_f32 v50, v50, v146
    v_mul_f32 v51, v51, v147
    v_mul_f32 v52, v52, v148
    v_mul_f32 v53, v53, v149
    v_mul_f32 v54, v54, v150
    v_mul_f32 v55, v55, v151
    v_exp_f32 v40, v40
    v_exp_f32 v41, v41
    v_exp_f32 v42, v42
    v_exp_f32 v43, v43
    v_exp_f32 v44, v44
    v_exp_f32 v45, v45
    v_exp_f32 v46, v46
    v_exp_f32 v47, v47
    v_exp_f32 v48, v48
    v_exp_f32 v49, v49
    v_exp_f32 v50, v50
    v_exp_f32 v51, v51
    v_exp_f32 v52, v52
    v_exp_f32 v53, v53
    v_exp_f32 v54, v54
    v_exp_f32 v55, v55
    v_add_f32 v40, 1.0, v40
    v_add_f32 v41, 1.0, v41
    v_add_f32 v42, 1.0, v42
    v_add_f32 v43, 1.0, v43
    v_add_f32 v44, 1.0, v44
    v_add_f32 v45, 1.0, v45
    v_add_f32 v46, 1.0, v46
    v_add_f32 v47, 1.0, v47
    v_add_f32 v48, 1.0, v48
    v_add_f32 v49, 1.0, v49
    v_add_f32 v50, 1.0, v50
    v_add_f32 v51, 1.0, v51
    v_add_f32 v52, 1.0, v52
    v_add_f32 v53, 1.0, v53
    v_add_f32 v54, 1.0, v54
    v_add_f32 v55, 1.0, v55
    v_rcp_f32 v40, v40
    v_rcp_f32 v41, v41
    v_rcp_f32 v42, v42
    v_rcp_f32 v43, v43
    v_rcp_f32 v44, v44
    v_rcp_f32 v45, v45
    v_rcp_f32 v46, v46
    v_rcp_f32 v47, v47
    v_rcp_f32 v48, v48
    v_rcp_f32 v49, v49
    v_rcp_f32 v50, v50
    v_rcp_f32 v51, v51
    v_rcp_f32 v52, v52
    v_rcp_f32 v53, v53
    v_rcp_f32 v54, v54
    v_rcp_f32 v55, v55
    v_mul_f32 v136, v136, v40
    v_mul_f32 v137, v137, v41
    v_mul_f32 v138, v138, v42
    v_mul_f32 v139, v139, v43
    v_mul_f32 v140, v140, v44
    v_mul_f32 v141, v141, v45
    v_mul_f32 v142, v142, v46
    v_mul_f32 v143, v143, v47
    v_mul_f32 v144, v144, v48
    v_mul_f32 v145, v145, v49
    v_mul_f32 v146, v146, v50
    v_mul_f32 v147, v147, v51
    v_mul_f32 v148, v148, v52
    v_mul_f32 v149, v149, v53
    v_mul_f32 v150, v150, v54
    v_mul_f32 v151, v151, v55
    v_cvt_pk_bf16_f32 v136, v136, v137
    v_cvt_pk_bf16_f32 v137, v138, v139
    v_cvt_pk_bf16_f32 v138, v140, v141
    v_cvt_pk_bf16_f32 v139, v142, v143
    v_cvt_pk_bf16_f32 v140, v144, v145
    v_cvt_pk_bf16_f32 v141, v146, v147
    v_cvt_pk_bf16_f32 v142, v148, v149
    v_cvt_pk_bf16_f32 v143, v150, v151
    buffer_store_dwordx4 v[136:139], v17, s[12:15], s40 offen offset:256 sc1
    buffer_store_dwordx4 v[140:143], v17, s[12:15], s40 offen offset:2304 sc1
    s_add_u32 s40, s40, 4096
    v_mul_f32 v24, v152, v152
    v_mul_f32 v25, v153, v153
    v_mul_f32 v26, v154, v154
    v_mul_f32 v27, v155, v155
    v_mul_f32 v28, v156, v156
    v_mul_f32 v29, v157, v157
    v_mul_f32 v30, v158, v158
    v_mul_f32 v31, v159, v159
    v_mul_f32 v32, v160, v160
    v_mul_f32 v33, v161, v161
    v_mul_f32 v34, v162, v162
    v_mul_f32 v35, v163, v163
    v_mul_f32 v36, v164, v164
    v_mul_f32 v37, v165, v165
    v_mul_f32 v38, v166, v166
    v_mul_f32 v39, v167, v167
    v_fmaak_f32 v24, v15, v24, 0xc0135761
    v_fmaak_f32 v25, v15, v25, 0xc0135761
    v_fmaak_f32 v26, v15, v26, 0xc0135761
    v_fmaak_f32 v27, v15, v27, 0xc0135761
    v_fmaak_f32 v28, v15, v28, 0xc0135761
    v_fmaak_f32 v29, v15, v29, 0xc0135761
    v_fmaak_f32 v30, v15, v30, 0xc0135761
    v_fmaak_f32 v31, v15, v31, 0xc0135761
    v_fmaak_f32 v32, v15, v32, 0xc0135761
    v_fmaak_f32 v33, v15, v33, 0xc0135761
    v_fmaak_f32 v34, v15, v34, 0xc0135761
    v_fmaak_f32 v35, v15, v35, 0xc0135761
    v_fmaak_f32 v36, v15, v36, 0xc0135761
    v_fmaak_f32 v37, v15, v37, 0xc0135761
    v_fmaak_f32 v38, v15, v38, 0xc0135761
    v_fmaak_f32 v39, v15, v39, 0xc0135761
    v_mul_f32 v24, v24, v152
    v_mul_f32 v25, v25, v153
    v_mul_f32 v26, v26, v154
    v_mul_f32 v27, v27, v155
    v_mul_f32 v28, v28, v156
    v_mul_f32 v29, v29, v157
    v_mul_f32 v30, v30, v158
    v_mul_f32 v31, v31, v159
    v_mul_f32 v32, v32, v160
    v_mul_f32 v33, v33, v161
    v_mul_f32 v34, v34, v162
    v_mul_f32 v35, v35, v163
    v_mul_f32 v36, v36, v164
    v_mul_f32 v37, v37, v165
    v_mul_f32 v38, v38, v166
    v_mul_f32 v39, v39, v167
    v_exp_f32 v24, v24
    v_exp_f32 v25, v25
    v_exp_f32 v26, v26
    v_exp_f32 v27, v27
    v_exp_f32 v28, v28
    v_exp_f32 v29, v29
    v_exp_f32 v30, v30
    v_exp_f32 v31, v31
    v_exp_f32 v32, v32
    v_exp_f32 v33, v33
    v_exp_f32 v34, v34
    v_exp_f32 v35, v35
    v_exp_f32 v36, v36
    v_exp_f32 v37, v37
    v_exp_f32 v38, v38
    v_exp_f32 v39, v39
    v_add_f32 v24, 1.0, v24
    v_add_f32 v25, 1.0, v25
    v_add_f32 v26, 1.0, v26
    v_add_f32 v27, 1.0, v27
    v_add_f32 v28, 1.0, v28
    v_add_f32 v29, 1.0, v29
    v_add_f32 v30, 1.0, v30
    v_add_f32 v31, 1.0, v31
    v_add_f32 v32, 1.0, v32
    v_add_f32 v33, 1.0, v33
    v_add_f32 v34, 1.0, v34
    v_add_f32 v35, 1.0, v35
    v_add_f32 v36, 1.0, v36
    v_add_f32 v37, 1.0, v37
    v_add_f32 v38, 1.0, v38
    v_add_f32 v39, 1.0, v39
    v_rcp_f32 v24, v24
    v_rcp_f32 v25, v25
    v_rcp_f32 v26, v26
    v_rcp_f32 v27, v27
    v_rcp_f32 v28, v28
    v_rcp_f32 v29, v29
    v_rcp_f32 v30, v30
    v_rcp_f32 v31, v31
    v_rcp_f32 v32, v32
    v_rcp_f32 v33, v33
    v_rcp_f32 v34, v34
    v_rcp_f32 v35, v35
    v_rcp_f32 v36, v36
    v_rcp_f32 v37, v37
    v_rcp_f32 v38, v38
    v_rcp_f32 v39, v39
    v_mul_f32 v152, v152, v24
    v_mul_f32 v153, v153, v25
    v_mul_f32 v154, v154, v26
    v_mul_f32 v155, v155, v27
    v_mul_f32 v156, v156, v28
    v_mul_f32 v157, v157, v29
    v_mul_f32 v158, v158, v30
    v_mul_f32 v159, v159, v31
    v_mul_f32 v160, v160, v32
    v_mul_f32 v161, v161, v33
    v_mul_f32 v162, v162, v34
    v_mul_f32 v163, v163, v35
    v_mul_f32 v164, v164, v36
    v_mul_f32 v165, v165, v37
    v_mul_f32 v166, v166, v38
    v_mul_f32 v167, v167, v39
    v_cvt_pk_bf16_f32 v152, v152, v153
    v_cvt_pk_bf16_f32 v153, v154, v155
    v_cvt_pk_bf16_f32 v154, v156, v157
    v_cvt_pk_bf16_f32 v155, v158, v159
    v_cvt_pk_bf16_f32 v156, v160, v161
    v_cvt_pk_bf16_f32 v157, v162, v163
    v_cvt_pk_bf16_f32 v158, v164, v165
    v_cvt_pk_bf16_f32 v159, v166, v167
    buffer_store_dwordx4 v[152:155], v17, s[12:15], s40 offen offset:0 sc1
    buffer_store_dwordx4 v[156:159], v17, s[12:15], s40 offen offset:2048 sc1
    v_mul_f32 v40, v168, v168
    v_mul_f32 v41, v169, v169
    v_mul_f32 v42, v170, v170
    v_mul_f32 v43, v171, v171
    v_mul_f32 v44, v172, v172
    v_mul_f32 v45, v173, v173
    v_mul_f32 v46, v174, v174
    v_mul_f32 v47, v175, v175
    v_mul_f32 v48, v176, v176
    v_mul_f32 v49, v177, v177
    v_mul_f32 v50, v178, v178
    v_mul_f32 v51, v179, v179
    v_mul_f32 v52, v180, v180
    v_mul_f32 v53, v181, v181
    v_mul_f32 v54, v182, v182
    v_mul_f32 v55, v183, v183
    v_fmaak_f32 v40, v15, v40, 0xc0135761
    v_fmaak_f32 v41, v15, v41, 0xc0135761
    v_fmaak_f32 v42, v15, v42, 0xc0135761
    v_fmaak_f32 v43, v15, v43, 0xc0135761
    v_fmaak_f32 v44, v15, v44, 0xc0135761
    v_fmaak_f32 v45, v15, v45, 0xc0135761
    v_fmaak_f32 v46, v15, v46, 0xc0135761
    v_fmaak_f32 v47, v15, v47, 0xc0135761
    v_fmaak_f32 v48, v15, v48, 0xc0135761
    v_fmaak_f32 v49, v15, v49, 0xc0135761
    v_fmaak_f32 v50, v15, v50, 0xc0135761
    v_fmaak_f32 v51, v15, v51, 0xc0135761
    v_fmaak_f32 v52, v15, v52, 0xc0135761
    v_fmaak_f32 v53, v15, v53, 0xc0135761
    v_fmaak_f32 v54, v15, v54, 0xc0135761
    v_fmaak_f32 v55, v15, v55, 0xc0135761
    v_mul_f32 v40, v40, v168
    v_mul_f32 v41, v41, v169
    v_mul_f32 v42, v42, v170
    v_mul_f32 v43, v43, v171
    v_mul_f32 v44, v44, v172
    v_mul_f32 v45, v45, v173
    v_mul_f32 v46, v46, v174
    v_mul_f32 v47, v47, v175
    v_mul_f32 v48, v48, v176
    v_mul_f32 v49, v49, v177
    v_mul_f32 v50, v50, v178
    v_mul_f32 v51, v51, v179
    v_mul_f32 v52, v52, v180
    v_mul_f32 v53, v53, v181
    v_mul_f32 v54, v54, v182
    v_mul_f32 v55, v55, v183
    v_exp_f32 v40, v40
    v_exp_f32 v41, v41
    v_exp_f32 v42, v42
    v_exp_f32 v43, v43
    v_exp_f32 v44, v44
    v_exp_f32 v45, v45
    v_exp_f32 v46, v46
    v_exp_f32 v47, v47
    v_exp_f32 v48, v48
    v_exp_f32 v49, v49
    v_exp_f32 v50, v50
    v_exp_f32 v51, v51
    v_exp_f32 v52, v52
    v_exp_f32 v53, v53
    v_exp_f32 v54, v54
    v_exp_f32 v55, v55
    v_add_f32 v40, 1.0, v40
    v_add_f32 v41, 1.0, v41
    v_add_f32 v42, 1.0, v42
    v_add_f32 v43, 1.0, v43
    v_add_f32 v44, 1.0, v44
    v_add_f32 v45, 1.0, v45
    v_add_f32 v46, 1.0, v46
    v_add_f32 v47, 1.0, v47
    v_add_f32 v48, 1.0, v48
    v_add_f32 v49, 1.0, v49
    v_add_f32 v50, 1.0, v50
    v_add_f32 v51, 1.0, v51
    v_add_f32 v52, 1.0, v52
    v_add_f32 v53, 1.0, v53
    v_add_f32 v54, 1.0, v54
    v_add_f32 v55, 1.0, v55
    v_rcp_f32 v40, v40
    v_rcp_f32 v41, v41
    v_rcp_f32 v42, v42
    v_rcp_f32 v43, v43
    v_rcp_f32 v44, v44
    v_rcp_f32 v45, v45
    v_rcp_f32 v46, v46
    v_rcp_f32 v47, v47
    v_rcp_f32 v48, v48
    v_rcp_f32 v49, v49
    v_rcp_f32 v50, v50
    v_rcp_f32 v51, v51
    v_rcp_f32 v52, v52
    v_rcp_f32 v53, v53
    v_rcp_f32 v54, v54
    v_rcp_f32 v55, v55
    v_mul_f32 v168, v168, v40
    v_mul_f32 v169, v169, v41
    v_mul_f32 v170, v170, v42
    v_mul_f32 v171, v171, v43
    v_mul_f32 v172, v172, v44
    v_mul_f32 v173, v173, v45
    v_mul_f32 v174, v174, v46
    v_mul_f32 v175, v175, v47
    v_mul_f32 v176, v176, v48
    v_mul_f32 v177, v177, v49
    v_mul_f32 v178, v178, v50
    v_mul_f32 v179, v179, v51
    v_mul_f32 v180, v180, v52
    v_mul_f32 v181, v181, v53
    v_mul_f32 v182, v182, v54
    v_mul_f32 v183, v183, v55
    v_cvt_pk_bf16_f32 v168, v168, v169
    v_cvt_pk_bf16_f32 v169, v170, v171
    v_cvt_pk_bf16_f32 v170, v172, v173
    v_cvt_pk_bf16_f32 v171, v174, v175
    v_cvt_pk_bf16_f32 v172, v176, v177
    v_cvt_pk_bf16_f32 v173, v178, v179
    v_cvt_pk_bf16_f32 v174, v180, v181
    v_cvt_pk_bf16_f32 v175, v182, v183
    buffer_store_dwordx4 v[168:171], v17, s[12:15], s40 offen offset:256 sc1
    buffer_store_dwordx4 v[172:175], v17, s[12:15], s40 offen offset:2304 sc1
    s_add_u32 s40, s40, 4096
    v_mul_f32 v24, v184, v184
    v_mul_f32 v25, v185, v185
    v_mul_f32 v26, v186, v186
    v_mul_f32 v27, v187, v187
    v_mul_f32 v28, v188, v188
    v_mul_f32 v29, v189, v189
    v_mul_f32 v30, v190, v190
    v_mul_f32 v31, v191, v191
    v_mul_f32 v32, v192, v192
    v_mul_f32 v33, v193, v193
    v_mul_f32 v34, v194, v194
    v_mul_f32 v35, v195, v195
    v_mul_f32 v36, v196, v196
    v_mul_f32 v37, v197, v197
    v_mul_f32 v38, v198, v198
    v_mul_f32 v39, v199, v199
    v_fmaak_f32 v24, v15, v24, 0xc0135761
    v_fmaak_f32 v25, v15, v25, 0xc0135761
    v_fmaak_f32 v26, v15, v26, 0xc0135761
    v_fmaak_f32 v27, v15, v27, 0xc0135761
    v_fmaak_f32 v28, v15, v28, 0xc0135761
    v_fmaak_f32 v29, v15, v29, 0xc0135761
    v_fmaak_f32 v30, v15, v30, 0xc0135761
    v_fmaak_f32 v31, v15, v31, 0xc0135761
    v_fmaak_f32 v32, v15, v32, 0xc0135761
    v_fmaak_f32 v33, v15, v33, 0xc0135761
    v_fmaak_f32 v34, v15, v34, 0xc0135761
    v_fmaak_f32 v35, v15, v35, 0xc0135761
    v_fmaak_f32 v36, v15, v36, 0xc0135761
    v_fmaak_f32 v37, v15, v37, 0xc0135761
    v_fmaak_f32 v38, v15, v38, 0xc0135761
    v_fmaak_f32 v39, v15, v39, 0xc0135761
    v_mul_f32 v24, v24, v184
    v_mul_f32 v25, v25, v185
    v_mul_f32 v26, v26, v186
    v_mul_f32 v27, v27, v187
    v_mul_f32 v28, v28, v188
    v_mul_f32 v29, v29, v189
    v_mul_f32 v30, v30, v190
    v_mul_f32 v31, v31, v191
    v_mul_f32 v32, v32, v192
    v_mul_f32 v33, v33, v193
    v_mul_f32 v34, v34, v194
    v_mul_f32 v35, v35, v195
    v_mul_f32 v36, v36, v196
    v_mul_f32 v37, v37, v197
    v_mul_f32 v38, v38, v198
    v_mul_f32 v39, v39, v199
    v_exp_f32 v24, v24
    v_exp_f32 v25, v25
    v_exp_f32 v26, v26
    v_exp_f32 v27, v27
    v_exp_f32 v28, v28
    v_exp_f32 v29, v29
    v_exp_f32 v30, v30
    v_exp_f32 v31, v31
    v_exp_f32 v32, v32
    v_exp_f32 v33, v33
    v_exp_f32 v34, v34
    v_exp_f32 v35, v35
    v_exp_f32 v36, v36
    v_exp_f32 v37, v37
    v_exp_f32 v38, v38
    v_exp_f32 v39, v39
    v_add_f32 v24, 1.0, v24
    v_add_f32 v25, 1.0, v25
    v_add_f32 v26, 1.0, v26
    v_add_f32 v27, 1.0, v27
    v_add_f32 v28, 1.0, v28
    v_add_f32 v29, 1.0, v29
    v_add_f32 v30, 1.0, v30
    v_add_f32 v31, 1.0, v31
    v_add_f32 v32, 1.0, v32
    v_add_f32 v33, 1.0, v33
    v_add_f32 v34, 1.0, v34
    v_add_f32 v35, 1.0, v35
    v_add_f32 v36, 1.0, v36
    v_add_f32 v37, 1.0, v37
    v_add_f32 v38, 1.0, v38
    v_add_f32 v39, 1.0, v39
    v_rcp_f32 v24, v24
    v_rcp_f32 v25, v25
    v_rcp_f32 v26, v26
    v_rcp_f32 v27, v27
    v_rcp_f32 v28, v28
    v_rcp_f32 v29, v29
    v_rcp_f32 v30, v30
    v_rcp_f32 v31, v31
    v_rcp_f32 v32, v32
    v_rcp_f32 v33, v33
    v_rcp_f32 v34, v34
    v_rcp_f32 v35, v35
    v_rcp_f32 v36, v36
    v_rcp_f32 v37, v37
    v_rcp_f32 v38, v38
    v_rcp_f32 v39, v39
    v_mul_f32 v184, v184, v24
    v_mul_f32 v185, v185, v25
    v_mul_f32 v186, v186, v26
    v_mul_f32 v187, v187, v27
    v_mul_f32 v188, v188, v28
    v_mul_f32 v189, v189, v29
    v_mul_f32 v190, v190, v30
    v_mul_f32 v191, v191, v31
    v_mul_f32 v192, v192, v32
    v_mul_f32 v193, v193, v33
    v_mul_f32 v194, v194, v34
    v_mul_f32 v195, v195, v35
    v_mul_f32 v196, v196, v36
    v_mul_f32 v197, v197, v37
    v_mul_f32 v198, v198, v38
    v_mul_f32 v199, v199, v39
    v_cvt_pk_bf16_f32 v184, v184, v185
    v_cvt_pk_bf16_f32 v185, v186, v187
    v_cvt_pk_bf16_f32 v186, v188, v189
    v_cvt_pk_bf16_f32 v187, v190, v191
    v_cvt_pk_bf16_f32 v188, v192, v193
    v_cvt_pk_bf16_f32 v189, v194, v195
    v_cvt_pk_bf16_f32 v190, v196, v197
    v_cvt_pk_bf16_f32 v191, v198, v199
    buffer_store_dwordx4 v[184:187], v17, s[12:15], s40 offen offset:0 sc1
    buffer_store_dwordx4 v[188:191], v17, s[12:15], s40 offen offset:2048 sc1
    v_mul_f32 v40, v200, v200
    v_mul_f32 v41, v201, v201
    v_mul_f32 v42, v202, v202
    v_mul_f32 v43, v203, v203
    v_mul_f32 v44, v204, v204
    v_mul_f32 v45, v205, v205
    v_mul_f32 v46, v206, v206
    v_mul_f32 v47, v207, v207
    v_mul_f32 v48, v208, v208
    v_mul_f32 v49, v209, v209
    v_mul_f32 v50, v210, v210
    v_mul_f32 v51, v211, v211
    v_mul_f32 v52, v212, v212
    v_mul_f32 v53, v213, v213
    v_mul_f32 v54, v214, v214
    v_mul_f32 v55, v215, v215
    v_fmaak_f32 v40, v15, v40, 0xc0135761
    v_fmaak_f32 v41, v15, v41, 0xc0135761
    v_fmaak_f32 v42, v15, v42, 0xc0135761
    v_fmaak_f32 v43, v15, v43, 0xc0135761
    v_fmaak_f32 v44, v15, v44, 0xc0135761
    v_fmaak_f32 v45, v15, v45, 0xc0135761
    v_fmaak_f32 v46, v15, v46, 0xc0135761
    v_fmaak_f32 v47, v15, v47, 0xc0135761
    v_fmaak_f32 v48, v15, v48, 0xc0135761
    v_fmaak_f32 v49, v15, v49, 0xc0135761
    v_fmaak_f32 v50, v15, v50, 0xc0135761
    v_fmaak_f32 v51, v15, v51, 0xc0135761
    v_fmaak_f32 v52, v15, v52, 0xc0135761
    v_fmaak_f32 v53, v15, v53, 0xc0135761
    v_fmaak_f32 v54, v15, v54, 0xc0135761
    v_fmaak_f32 v55, v15, v55, 0xc0135761
    v_mul_f32 v40, v40, v200
    v_mul_f32 v41, v41, v201
    v_mul_f32 v42, v42, v202
    v_mul_f32 v43, v43, v203
    v_mul_f32 v44, v44, v204
    v_mul_f32 v45, v45, v205
    v_mul_f32 v46, v46, v206
    v_mul_f32 v47, v47, v207
    v_mul_f32 v48, v48, v208
    v_mul_f32 v49, v49, v209
    v_mul_f32 v50, v50, v210
    v_mul_f32 v51, v51, v211
    v_mul_f32 v52, v52, v212
    v_mul_f32 v53, v53, v213
    v_mul_f32 v54, v54, v214
    v_mul_f32 v55, v55, v215
    v_exp_f32 v40, v40
    v_exp_f32 v41, v41
    v_exp_f32 v42, v42
    v_exp_f32 v43, v43
    v_exp_f32 v44, v44
    v_exp_f32 v45, v45
    v_exp_f32 v46, v46
    v_exp_f32 v47, v47
    v_exp_f32 v48, v48
    v_exp_f32 v49, v49
    v_exp_f32 v50, v50
    v_exp_f32 v51, v51
    v_exp_f32 v52, v52
    v_exp_f32 v53, v53
    v_exp_f32 v54, v54
    v_exp_f32 v55, v55
    v_add_f32 v40, 1.0, v40
    v_add_f32 v41, 1.0, v41
    v_add_f32 v42, 1.0, v42
    v_add_f32 v43, 1.0, v43
    v_add_f32 v44, 1.0, v44
    v_add_f32 v45, 1.0, v45
    v_add_f32 v46, 1.0, v46
    v_add_f32 v47, 1.0, v47
    v_add_f32 v48, 1.0, v48
    v_add_f32 v49, 1.0, v49
    v_add_f32 v50, 1.0, v50
    v_add_f32 v51, 1.0, v51
    v_add_f32 v52, 1.0, v52
    v_add_f32 v53, 1.0, v53
    v_add_f32 v54, 1.0, v54
    v_add_f32 v55, 1.0, v55
    v_rcp_f32 v40, v40
    v_rcp_f32 v41, v41
    v_rcp_f32 v42, v42
    v_rcp_f32 v43, v43
    v_rcp_f32 v44, v44
    v_rcp_f32 v45, v45
    v_rcp_f32 v46, v46
    v_rcp_f32 v47, v47
    v_rcp_f32 v48, v48
    v_rcp_f32 v49, v49
    v_rcp_f32 v50, v50
    v_rcp_f32 v51, v51
    v_rcp_f32 v52, v52
    v_rcp_f32 v53, v53
    v_rcp_f32 v54, v54
    v_rcp_f32 v55, v55
    v_mul_f32 v200, v200, v40
    v_mul_f32 v201, v201, v41
    v_mul_f32 v202, v202, v42
    v_mul_f32 v203, v203, v43
    v_mul_f32 v204, v204, v44
    v_mul_f32 v205, v205, v45
    v_mul_f32 v206, v206, v46
    v_mul_f32 v207, v207, v47
    v_mul_f32 v208, v208, v48
    v_mul_f32 v209, v209, v49
    v_mul_f32 v210, v210, v50
    v_mul_f32 v211, v211, v51
    v_mul_f32 v212, v212, v52
    v_mul_f32 v213, v213, v53
    v_mul_f32 v214, v214, v54
    v_mul_f32 v215, v215, v55
    v_cvt_pk_bf16_f32 v200, v200, v201
    v_cvt_pk_bf16_f32 v201, v202, v203
    v_cvt_pk_bf16_f32 v202, v204, v205
    v_cvt_pk_bf16_f32 v203, v206, v207
    v_cvt_pk_bf16_f32 v204, v208, v209
    v_cvt_pk_bf16_f32 v205, v210, v211
    v_cvt_pk_bf16_f32 v206, v212, v213
    v_cvt_pk_bf16_f32 v207, v214, v215
    buffer_store_dwordx4 v[200:203], v17, s[12:15], s40 offen offset:256 sc1
    buffer_store_dwordx4 v[204:207], v17, s[12:15], s40 offen offset:2304 sc1
    s_add_u32 s40, s40, 4096
    v_mul_f32 v24, v216, v216
    v_mul_f32 v25, v217, v217
    v_mul_f32 v26, v218, v218
    v_mul_f32 v27, v219, v219
    v_mul_f32 v28, v220, v220
    v_mul_f32 v29, v221, v221
    v_mul_f32 v30, v222, v222
    v_mul_f32 v31, v223, v223
    v_mul_f32 v32, v224, v224
    v_mul_f32 v33, v225, v225
    v_mul_f32 v34, v226, v226
    v_mul_f32 v35, v227, v227
    v_mul_f32 v36, v228, v228
    v_mul_f32 v37, v229, v229
    v_mul_f32 v38, v230, v230
    v_mul_f32 v39, v231, v231
    v_fmaak_f32 v24, v15, v24, 0xc0135761
    v_fmaak_f32 v25, v15, v25, 0xc0135761
    v_fmaak_f32 v26, v15, v26, 0xc0135761
    v_fmaak_f32 v27, v15, v27, 0xc0135761
    v_fmaak_f32 v28, v15, v28, 0xc0135761
    v_fmaak_f32 v29, v15, v29, 0xc0135761
    v_fmaak_f32 v30, v15, v30, 0xc0135761
    v_fmaak_f32 v31, v15, v31, 0xc0135761
    v_fmaak_f32 v32, v15, v32, 0xc0135761
    v_fmaak_f32 v33, v15, v33, 0xc0135761
    v_fmaak_f32 v34, v15, v34, 0xc0135761
    v_fmaak_f32 v35, v15, v35, 0xc0135761
    v_fmaak_f32 v36, v15, v36, 0xc0135761
    v_fmaak_f32 v37, v15, v37, 0xc0135761
    v_fmaak_f32 v38, v15, v38, 0xc0135761
    v_fmaak_f32 v39, v15, v39, 0xc0135761
    v_mul_f32 v24, v24, v216
    v_mul_f32 v25, v25, v217
    v_mul_f32 v26, v26, v218
    v_mul_f32 v27, v27, v219
    v_mul_f32 v28, v28, v220
    v_mul_f32 v29, v29, v221
    v_mul_f32 v30, v30, v222
    v_mul_f32 v31, v31, v223
    v_mul_f32 v32, v32, v224
    v_mul_f32 v33, v33, v225
    v_mul_f32 v34, v34, v226
    v_mul_f32 v35, v35, v227
    v_mul_f32 v36, v36, v228
    v_mul_f32 v37, v37, v229
    v_mul_f32 v38, v38, v230
    v_mul_f32 v39, v39, v231
    v_exp_f32 v24, v24
    v_exp_f32 v25, v25
    v_exp_f32 v26, v26
    v_exp_f32 v27, v27
    v_exp_f32 v28, v28
    v_exp_f32 v29, v29
    v_exp_f32 v30, v30
    v_exp_f32 v31, v31
    v_exp_f32 v32, v32
    v_exp_f32 v33, v33
    v_exp_f32 v34, v34
    v_exp_f32 v35, v35
    v_exp_f32 v36, v36
    v_exp_f32 v37, v37
    v_exp_f32 v38, v38
    v_exp_f32 v39, v39
    v_add_f32 v24, 1.0, v24
    v_add_f32 v25, 1.0, v25
    v_add_f32 v26, 1.0, v26
    v_add_f32 v27, 1.0, v27
    v_add_f32 v28, 1.0, v28
    v_add_f32 v29, 1.0, v29
    v_add_f32 v30, 1.0, v30
    v_add_f32 v31, 1.0, v31
    v_add_f32 v32, 1.0, v32
    v_add_f32 v33, 1.0, v33
    v_add_f32 v34, 1.0, v34
    v_add_f32 v35, 1.0, v35
    v_add_f32 v36, 1.0, v36
    v_add_f32 v37, 1.0, v37
    v_add_f32 v38, 1.0, v38
    v_add_f32 v39, 1.0, v39
    v_rcp_f32 v24, v24
    v_rcp_f32 v25, v25
    v_rcp_f32 v26, v26
    v_rcp_f32 v27, v27
    v_rcp_f32 v28, v28
    v_rcp_f32 v29, v29
    v_rcp_f32 v30, v30
    v_rcp_f32 v31, v31
    v_rcp_f32 v32, v32
    v_rcp_f32 v33, v33
    v_rcp_f32 v34, v34
    v_rcp_f32 v35, v35
    v_rcp_f32 v36, v36
    v_rcp_f32 v37, v37
    v_rcp_f32 v38, v38
    v_rcp_f32 v39, v39
    v_mul_f32 v216, v216, v24
    v_mul_f32 v217, v217, v25
    v_mul_f32 v218, v218, v26
    v_mul_f32 v219, v219, v27
    v_mul_f32 v220, v220, v28
    v_mul_f32 v221, v221, v29
    v_mul_f32 v222, v222, v30
    v_mul_f32 v223, v223, v31
    v_mul_f32 v224, v224, v32
    v_mul_f32 v225, v225, v33
    v_mul_f32 v226, v226, v34
    v_mul_f32 v227, v227, v35
    v_mul_f32 v228, v228, v36
    v_mul_f32 v229, v229, v37
    v_mul_f32 v230, v230, v38
    v_mul_f32 v231, v231, v39
    v_cvt_pk_bf16_f32 v216, v216, v217
    v_cvt_pk_bf16_f32 v217, v218, v219
    v_cvt_pk_bf16_f32 v218, v220, v221
    v_cvt_pk_bf16_f32 v219, v222, v223
    v_cvt_pk_bf16_f32 v220, v224, v225
    v_cvt_pk_bf16_f32 v221, v226, v227
    v_cvt_pk_bf16_f32 v222, v228, v229
    v_cvt_pk_bf16_f32 v223, v230, v231
    buffer_store_dwordx4 v[216:219], v17, s[12:15], s40 offen offset:0 sc1
    buffer_store_dwordx4 v[220:223], v17, s[12:15], s40 offen offset:2048 sc1
    v_mul_f32 v40, v232, v232
    v_mul_f32 v41, v233, v233
    v_mul_f32 v42, v234, v234
    v_mul_f32 v43, v235, v235
    v_mul_f32 v44, v236, v236
    v_mul_f32 v45, v237, v237
    v_mul_f32 v46, v238, v238
    v_mul_f32 v47, v239, v239
    v_mul_f32 v48, v240, v240
    v_mul_f32 v49, v241, v241
    v_mul_f32 v50, v242, v242
    v_mul_f32 v51, v243, v243
    v_mul_f32 v52, v244, v244
    v_mul_f32 v53, v245, v245
    v_mul_f32 v54, v246, v246
    v_mul_f32 v55, v247, v247
    v_fmaak_f32 v40, v15, v40, 0xc0135761
    v_fmaak_f32 v41, v15, v41, 0xc0135761
    v_fmaak_f32 v42, v15, v42, 0xc0135761
    v_fmaak_f32 v43, v15, v43, 0xc0135761
    v_fmaak_f32 v44, v15, v44, 0xc0135761
    v_fmaak_f32 v45, v15, v45, 0xc0135761
    v_fmaak_f32 v46, v15, v46, 0xc0135761
    v_fmaak_f32 v47, v15, v47, 0xc0135761
    v_fmaak_f32 v48, v15, v48, 0xc0135761
    v_fmaak_f32 v49, v15, v49, 0xc0135761
    v_fmaak_f32 v50, v15, v50, 0xc0135761
    v_fmaak_f32 v51, v15, v51, 0xc0135761
    v_fmaak_f32 v52, v15, v52, 0xc0135761
    v_fmaak_f32 v53, v15, v53, 0xc0135761
    v_fmaak_f32 v54, v15, v54, 0xc0135761
    v_fmaak_f32 v55, v15, v55, 0xc0135761
    v_mul_f32 v40, v40, v232
    v_mul_f32 v41, v41, v233
    v_mul_f32 v42, v42, v234
    v_mul_f32 v43, v43, v235
    v_mul_f32 v44, v44, v236
    v_mul_f32 v45, v45, v237
    v_mul_f32 v46, v46, v238
    v_mul_f32 v47, v47, v239
    v_mul_f32 v48, v48, v240
    v_mul_f32 v49, v49, v241
    v_mul_f32 v50, v50, v242
    v_mul_f32 v51, v51, v243
    v_mul_f32 v52, v52, v244
    v_mul_f32 v53, v53, v245
    v_mul_f32 v54, v54, v246
    v_mul_f32 v55, v55, v247
    v_exp_f32 v40, v40
    v_exp_f32 v41, v41
    v_exp_f32 v42, v42
    v_exp_f32 v43, v43
    v_exp_f32 v44, v44
    v_exp_f32 v45, v45
    v_exp_f32 v46, v46
    v_exp_f32 v47, v47
    v_exp_f32 v48, v48
    v_exp_f32 v49, v49
    v_exp_f32 v50, v50
    v_exp_f32 v51, v51
    v_exp_f32 v52, v52
    v_exp_f32 v53, v53
    v_exp_f32 v54, v54
    v_exp_f32 v55, v55
    v_add_f32 v40, 1.0, v40
    v_add_f32 v41, 1.0, v41
    v_add_f32 v42, 1.0, v42
    v_add_f32 v43, 1.0, v43
    v_add_f32 v44, 1.0, v44
    v_add_f32 v45, 1.0, v45
    v_add_f32 v46, 1.0, v46
    v_add_f32 v47, 1.0, v47
    v_add_f32 v48, 1.0, v48
    v_add_f32 v49, 1.0, v49
    v_add_f32 v50, 1.0, v50
    v_add_f32 v51, 1.0, v51
    v_add_f32 v52, 1.0, v52
    v_add_f32 v53, 1.0, v53
    v_add_f32 v54, 1.0, v54
    v_add_f32 v55, 1.0, v55
    v_rcp_f32 v40, v40
    v_rcp_f32 v41, v41
    v_rcp_f32 v42, v42
    v_rcp_f32 v43, v43
    v_rcp_f32 v44, v44
    v_rcp_f32 v45, v45
    v_rcp_f32 v46, v46
    v_rcp_f32 v47, v47
    v_rcp_f32 v48, v48
    v_rcp_f32 v49, v49
    v_rcp_f32 v50, v50
    v_rcp_f32 v51, v51
    v_rcp_f32 v52, v52
    v_rcp_f32 v53, v53
    v_rcp_f32 v54, v54
    v_rcp_f32 v55, v55
    v_mul_f32 v232, v232, v40
    v_mul_f32 v233, v233, v41
    v_mul_f32 v234, v234, v42
    v_mul_f32 v235, v235, v43
    v_mul_f32 v236, v236, v44
    v_mul_f32 v237, v237, v45
    v_mul_f32 v238, v238, v46
    v_mul_f32 v239, v239, v47
    v_mul_f32 v240, v240, v48
    v_mul_f32 v241, v241, v49
    v_mul_f32 v242, v242, v50
    v_mul_f32 v243, v243, v51
    v_mul_f32 v244, v244, v52
    v_mul_f32 v245, v245, v53
    v_mul_f32 v246, v246, v54
    v_mul_f32 v247, v247, v55
    v_cvt_pk_bf16_f32 v232, v232, v233
    v_cvt_pk_bf16_f32 v233, v234, v235
    v_cvt_pk_bf16_f32 v234, v236, v237
    v_cvt_pk_bf16_f32 v235, v238, v239
    v_cvt_pk_bf16_f32 v236, v240, v241
    v_cvt_pk_bf16_f32 v237, v242, v243
    v_cvt_pk_bf16_f32 v238, v244, v245
    v_cvt_pk_bf16_f32 v239, v246, v247
    buffer_store_dwordx4 v[232:235], v17, s[12:15], s40 offen offset:256 sc1
    buffer_store_dwordx4 v[236:239], v17, s[12:15], s40 offen offset:2304 sc1
    s_add_u32 s40, s40, 4096
    s_branch L_parallel_sum__sliding_block__mixer_token_mlp__prompt_kernel_mdone
L_parallel_sum__sliding_block__mixer_token_mlp__prompt_kernel_mload:
    s_lshl_b32 s40, s38, 20
    s_add_u32 s40, s40, 4194304
    s_add_u32 s4, s28, s40
    s_addc_u32 s5, s29, 0
    s_and_b32 s5, s5, 0xffff
    s_mov_b32 s6, 1048576
    s_mov_b32 s7, 0x20000
    s_lshl_b32 s17, s50, 13
    s_add_u32 s44, s28, 52428800
    s_addc_u32 s45, s29, 0
    s_and_b32 s45, s45, 0xffff
    s_mov_b32 s46, 32768
    s_mov_b32 s47, 0x20000
    v_mov_b32 v10, 0
    s_lshl_b32 s41, s70, 8
    s_mov_b32 s42, 0x40000
L_parallel_sum__sliding_block__mixer_token_mlp__prompt_kernel_mgo:
    buffer_load_dword v9, v10, s[44:47], s41 offen sc1
    s_waitcnt vmcnt(0)
    v_readfirstlane_b32 s40, v9
    s_nop 0
    s_cmp_lg_u32 s40, s71
    s_cbranch_scc1 L_parallel_sum__sliding_block__mixer_token_mlp__prompt_kernel_mgo_ok
    s_sleep 2
    s_sub_u32 s42, s42, 1
    s_cmp_lg_u32 s42, 0
    s_cbranch_scc1 L_parallel_sum__sliding_block__mixer_token_mlp__prompt_kernel_mgo
L_parallel_sum__sliding_block__mixer_token_mlp__prompt_kernel_mgo_ok:
    s_add_u32 m0, s52, 0
    s_nop 0
    buffer_load_dwordx4 v104, s[4:7], s17 offen offset:0 sc1 lds
    buffer_load_dwordx4 v104, s[4:7], s17 offen offset:1024 sc1 lds
    buffer_load_dwordx4 v104, s[4:7], s17 offen offset:2048 sc1 lds
    buffer_load_dwordx4 v104, s[4:7], s17 offen offset:3072 sc1 lds
    s_add_u32 m0, m0, 4096
    s_add_u32 s51, s17, 4096
    buffer_load_dwordx4 v104, s[4:7], s51 offen offset:0 sc1 lds
    buffer_load_dwordx4 v104, s[4:7], s51 offen offset:1024 sc1 lds
    buffer_load_dwordx4 v104, s[4:7], s51 offen offset:2048 sc1 lds
    buffer_load_dwordx4 v104, s[4:7], s51 offen offset:3072 sc1 lds
    s_add_u32 s17, s17, 32768
    s_add_u32 m0, s52, 49152
    s_nop 0
    buffer_load_dwordx4 v104, s[4:7], s17 offen offset:0 sc1 lds
    buffer_load_dwordx4 v104, s[4:7], s17 offen offset:1024 sc1 lds
    buffer_load_dwordx4 v104, s[4:7], s17 offen offset:2048 sc1 lds
    buffer_load_dwordx4 v104, s[4:7], s17 offen offset:3072 sc1 lds
    s_add_u32 m0, m0, 4096
    s_add_u32 s51, s17, 4096
    buffer_load_dwordx4 v104, s[4:7], s51 offen offset:0 sc1 lds
    buffer_load_dwordx4 v104, s[4:7], s51 offen offset:1024 sc1 lds
    buffer_load_dwordx4 v104, s[4:7], s51 offen offset:2048 sc1 lds
    buffer_load_dwordx4 v104, s[4:7], s51 offen offset:3072 sc1 lds
    s_add_u32 s17, s17, 32768
    s_add_u32 m0, s52, 98304
    s_nop 0
    buffer_load_dwordx4 v104, s[4:7], s17 offen offset:0 sc1 lds
    buffer_load_dwordx4 v104, s[4:7], s17 offen offset:1024 sc1 lds
    buffer_load_dwordx4 v104, s[4:7], s17 offen offset:2048 sc1 lds
    buffer_load_dwordx4 v104, s[4:7], s17 offen offset:3072 sc1 lds
    s_add_u32 m0, m0, 4096
    s_add_u32 s51, s17, 4096
    buffer_load_dwordx4 v104, s[4:7], s51 offen offset:0 sc1 lds
    buffer_load_dwordx4 v104, s[4:7], s51 offen offset:1024 sc1 lds
    buffer_load_dwordx4 v104, s[4:7], s51 offen offset:2048 sc1 lds
    buffer_load_dwordx4 v104, s[4:7], s51 offen offset:3072 sc1 lds
    s_add_u32 s17, s17, 32768
    s_waitcnt vmcnt(16)
    s_barrier
    s_waitcnt vmcnt(8)
    s_barrier
    s_add_u32 m0, s53, 0
    s_nop 0
    buffer_load_dwordx4 v100, s[56:59], s54 offen offset:0 lds
    buffer_load_dwordx4 v101, s[56:59], s54 offen offset:1024 lds
    buffer_load_dwordx4 v102, s[56:59], s54 offen offset:2048 lds
    buffer_load_dwordx4 v103, s[56:59], s54 offen offset:3072 lds
    s_add_u32 s54, s54, 458752
    s_add_u32 m0, s52, 0
    s_nop 0
    buffer_load_dwordx4 v104, s[4:7], s17 offen offset:0 sc1 lds
    buffer_load_dwordx4 v104, s[4:7], s17 offen offset:1024 sc1 lds
    buffer_load_dwordx4 v104, s[4:7], s17 offen offset:2048 sc1 lds
    buffer_load_dwordx4 v104, s[4:7], s17 offen offset:3072 sc1 lds
    s_add_u32 m0, m0, 4096
    s_add_u32 s51, s17, 4096
    buffer_load_dwordx4 v104, s[4:7], s51 offen offset:0 sc1 lds
    buffer_load_dwordx4 v104, s[4:7], s51 offen offset:1024 sc1 lds
    buffer_load_dwordx4 v104, s[4:7], s51 offen offset:2048 sc1 lds
    buffer_load_dwordx4 v104, s[4:7], s51 offen offset:3072 sc1 lds
    s_add_u32 s17, s17, 32768
    s_mov_b32 s21, 49152
    s_mov_b32 s23, 28
L_parallel_sum__sliding_block__mixer_token_mlp__prompt_kernel_ml:
    s_waitcnt vmcnt(12)
    s_barrier
    s_add_u32 m0, s53, s21
    s_nop 0
    buffer_load_dwordx4 v100, s[56:59], s54 offen offset:0 lds
    buffer_load_dwordx4 v101, s[56:59], s54 offen offset:1024 lds
    buffer_load_dwordx4 v102, s[56:59], s54 offen offset:2048 lds
    buffer_load_dwordx4 v103, s[56:59], s54 offen offset:3072 lds
    s_add_u32 s54, s54, 458752
    s_add_u32 m0, s52, s21
    s_nop 0
    buffer_load_dwordx4 v104, s[4:7], s17 offen offset:0 sc1 lds
    buffer_load_dwordx4 v104, s[4:7], s17 offen offset:1024 sc1 lds
    buffer_load_dwordx4 v104, s[4:7], s17 offen offset:2048 sc1 lds
    buffer_load_dwordx4 v104, s[4:7], s17 offen offset:3072 sc1 lds
    s_add_u32 m0, m0, 4096
    s_add_u32 s51, s17, 4096
    buffer_load_dwordx4 v104, s[4:7], s51 offen offset:0 sc1 lds
    buffer_load_dwordx4 v104, s[4:7], s51 offen offset:1024 sc1 lds
    buffer_load_dwordx4 v104, s[4:7], s51 offen offset:2048 sc1 lds
    buffer_load_dwordx4 v104, s[4:7], s51 offen offset:3072 sc1 lds
    s_add_u32 s17, s17, 32768
    s_add_u32 s21, s21, 49152
    s_cmp_eq_u32 s21, 147456
    s_cselect_b32 s21, 0, s21
    s_sub_u32 s23, s23, 1
    s_cmp_lg_u32 s23, 0
    s_cbranch_scc1 L_parallel_sum__sliding_block__mixer_token_mlp__prompt_kernel_ml
    s_waitcnt vmcnt(12)
    s_barrier
    s_waitcnt vmcnt(0)
    s_barrier
    s_barrier
    s_mov_b32 s61, 0
L_parallel_sum__sliding_block__mixer_token_mlp__prompt_kernel_mdone:
    s_lshl_b32 s63, s38, 12
    s_add_u32 s63, s63, 32768
    s_mov_b64 s[58:59], 0xffff
    s_mov_b32 s62, 0
L_parallel_sum__sliding_block__mixer_token_mlp__prompt_kernel_p2:
    s_load_dwordx2 s[30:31], s[0:1], 48
    s_load_dwordx2 s[32:33], s[0:1], 16
    s_and_b32 s38, s37, 3
    s_lshr_b32 s39, s36, 1
    s_lshl_b32 s39, s39, 2
    s_lshr_b32 s40, s37, 2
    s_add_u32 s39, s39, s40
    s_and_b32 s56, s36, 1
    s_cmp_eq_u32 s62, 0
    s_cbranch_scc1 L_parallel_sum__sliding_block__mixer_token_mlp__prompt_kernel_emap
    s_and_b32 s38, s69, 3
    s_lshr_b32 s39, s69, 4
    s_lshl_b32 s39, s39, 1
    s_bfe_u32 s40, s69, 0x10002
    s_add_u32 s39, s39, s40
    s_bfe_u32 s56, s69, 0x10003
L_parallel_sum__sliding_block__mixer_token_mlp__prompt_kernel_emap:
    s_lshl_b32 s42, s62, 1
    s_add_u32 s42, s42, s56
    s_cmp_eq_u32 s56, 0
    s_cselect_b32 s57, 0, 18
    s_cselect_b32 s60, 18, 18
    s_cselect_b32 s40, 36, 46
    s_cselect_b32 s41, 10, 10
    s_cmp_eq_u32 s62, 0
    s_cselect_b32 s57, s57, s40
    s_cselect_b32 s60, s60, s41
    s_and_b32 s50, s16, 3
    s_lshr_b32 s24, s50, 1
    s_and_b32 s25, s50, 1
    v_lshlrev_b32 v2, 4, v1
    v_mov_b32 v10, 0
    s_add_u32 s64, s28, 50331648
    s_addc_u32 s65, s29, 0
    s_and_b32 s65, s65, 0xffff
    s_mov_b32 s66, 131072
    s_mov_b32 s67, 0x20000
    s_add_u32 s12, s28, 33554432
    s_addc_u32 s13, s29, 0
    s_and_b32 s13, s13, 0xffff
    s_mov_b32 s14, 16777216
    s_mov_b32 s15, 0x20000
    s_lshl_b32 s77, s38, 4
    s_add_u32 s77, s77, s39
    s_lshl_b32 s77, s77, 2
    s_add_u32 s77, s77, s50
    s_lshl_b32 s76, s77, 14
    s_lshl_b32 s77, s77, 7
    s_add_u32 s77, s77, 65536
    s_cmp_eq_u32 s61, 1
    s_cbranch_scc1 L_parallel_sum__sliding_block__mixer_token_mlp__prompt_kernel_nob0
    s_barrier
L_parallel_sum__sliding_block__mixer_token_mlp__prompt_kernel_nob0:
    s_cmp_ge_u32 s16, 4
    s_cbranch_scc1 L_parallel_sum__sliding_block__mixer_token_mlp__prompt_kernel_ld
    s_cmp_eq_u32 s63, -1
    s_cbranch_scc1 L_parallel_sum__sliding_block__mixer_token_mlp__prompt_kernel_cnosig
    s_waitcnt vmcnt(0)
    s_mov_b64 exec, 1
    v_mov_b32 v11, 159748
    v_mov_b32 v9, 1
    ds_add_rtn_u32 v9, v11, v9
    s_waitcnt lgkmcnt(0)
    v_readfirstlane_b32 s40, v9
    s_mov_b64 exec, -1
    v_mov_b32 v9, 1
    v_lshlrev_b32 v11, 8, v1
    s_cmp_lg_u32 s40, 7
    s_cbranch_scc1 L_parallel_sum__sliding_block__mixer_token_mlp__prompt_kernel_arr1
    s_mov_b64 exec, s[58:59]
    buffer_atomic_add v9, v11, s[64:67], s63 offen sc1
    s_mov_b64 exec, -1
L_parallel_sum__sliding_block__mixer_token_mlp__prompt_kernel_arr1:
L_parallel_sum__sliding_block__mixer_token_mlp__prompt_kernel_cnosig:
    s_cmp_lg_u32 s16, 1
    s_cbranch_scc1 L_parallel_sum__sliding_block__mixer_token_mlp__prompt_kernel_pd_ok
    s_mov_b32 s52, s74
    s_and_b32 s53, s75, 0xffff
    s_mov_b32 s54, 256
    s_mov_b32 s55, 0x20000
    s_mov_b32 s45, 132
    s_mov_b32 s41, 262144
L_parallel_sum__sliding_block__mixer_token_mlp__prompt_kernel_pd:
    buffer_load_dword v9, v10, s[52:55], s45 offen sc1
    s_waitcnt vmcnt(0)
    v_readfirstlane_b32 s40, v9
    s_nop 0
    s_cmp_ge_u32 s40, 128
    s_cbranch_scc1 L_parallel_sum__sliding_block__mixer_token_mlp__prompt_kernel_pd_ok
    s_sleep 8
    s_sub_u32 s41, s41, 1
    s_cmp_lg_u32 s41, 0
    s_cbranch_scc1 L_parallel_sum__sliding_block__mixer_token_mlp__prompt_kernel_pd
L_parallel_sum__sliding_block__mixer_token_mlp__prompt_kernel_pd_ok:
    s_cmp_lg_u32 s16, 0
    s_cbranch_scc1 L_parallel_sum__sliding_block__mixer_token_mlp__prompt_kernel_pu_ok
    s_lshl_b32 s43, s38, 4
    s_lshl_b32 s40, s36, 1
    s_add_u32 s43, s43, s40
    s_lshl_b32 s43, s43, 8
    s_add_u32 s43, s43, 32768
    s_cmp_lg_u32 s62, 0
    s_cbranch_scc1 L_parallel_sum__sliding_block__mixer_token_mlp__prompt_kernel_pu_ok
    s_mov_b32 s41, 262144
L_parallel_sum__sliding_block__mixer_token_mlp__prompt_kernel_pu:
    buffer_load_dword v9, v10, s[64:67], s43 offen sc1
    s_waitcnt vmcnt(0)
    v_readfirstlane_b32 s40, v9
    s_nop 0
    s_cmp_ge_u32 s40, 28
    s_cbranch_scc1 L_parallel_sum__sliding_block__mixer_token_mlp__prompt_kernel_pu_ok
    s_sleep 4
    s_sub_u32 s41, s41, 1
    s_cmp_lg_u32 s41, 0
    s_cbranch_scc1 L_parallel_sum__sliding_block__mixer_token_mlp__prompt_kernel_pu
L_parallel_sum__sliding_block__mixer_token_mlp__prompt_kernel_pu_ok:
    s_barrier
    v_lshrrev_b32 v16, 4, v1
    v_and_b32 v17, 15, v1
    v_lshlrev_b32 v17, 4, v17
    v_lshl_add_u32 v17, v16, 9, v17
    s_mul_i32 s27, s24, 16384
    v_add_u32 v3, s27, v17
    v_lshlrev_b32 v17, 2, v16
    v_bfe_u32 v18, v1, 2, 2
    v_add_u32 v17, v17, v18
    v_lshlrev_b32 v17, 8, v17
    v_and_b32 v19, 3, v1
    v_lshl_add_u32 v17, v19, 3, v17
    v_add_u32 v17, 32768, v17
    v_and_b32 v16, 1, v16
    v_lshl_add_u32 v16, v18, 1, v16
    s_mul_i32 s27, s25, 4
    s_add_u32 s3, s27, 0
    v_xor_b32 v18, s3, v16
    v_lshl_add_u32 v4, v18, 5, v17
    s_add_u32 s3, s27, 1
    v_xor_b32 v18, s3, v16
    v_lshl_add_u32 v5, v18, 5, v17
    s_add_u32 s3, s27, 2
    v_xor_b32 v18, s3, v16
    v_lshl_add_u32 v6, v18, 5, v17
    s_add_u32 s3, s27, 3
    v_xor_b32 v18, s3, v16
    v_lshl_add_u32 v7, v18, 5, v17
    s_mov_b32 s51, 4294868992
    v_mov_b32 v112, 0
    v_mov_b32 v113, 0
    v_mov_b32 v114, 0
    v_mov_b32 v115, 0
    v_mov_b32 v116, 0
    v_mov_b32 v117, 0
    v_mov_b32 v118, 0
    v_mov_b32 v119, 0
    v_mov_b32 v120, 0
    v_mov_b32 v121, 0
    v_mov_b32 v122, 0
    v_mov_b32 v123, 0
    v_mov_b32 v124, 0
    v_mov_b32 v125, 0
    v_mov_b32 v126, 0
    v_mov_b32 v127, 0
    v_mov_b32 v128, 0
    v_mov_b32 v129, 0
    v_mov_b32 v130, 0
    v_mov_b32 v131, 0
    v_mov_b32 v132, 0
    v_mov_b32 v133, 0
    v_mov_b32 v134, 0
    v_mov_b32 v135, 0
    v_mov_b32 v136, 0
    v_mov_b32 v137, 0
    v_mov_b32 v138, 0
    v_mov_b32 v139, 0
    v_mov_b32 v140, 0
    v_mov_b32 v141, 0
    v_mov_b32 v142, 0
    v_mov_b32 v143, 0
    v_mov_b32 v144, 0
    v_mov_b32 v145, 0
    v_mov_b32 v146, 0
    v_mov_b32 v147, 0
    v_mov_b32 v148, 0
    v_mov_b32 v149, 0
    v_mov_b32 v150, 0
    v_mov_b32 v151, 0
    v_mov_b32 v152, 0
    v_mov_b32 v153, 0
    v_mov_b32 v154, 0
    v_mov_b32 v155, 0
    v_mov_b32 v156, 0
    v_mov_b32 v157, 0
    v_mov_b32 v158, 0
    v_mov_b32 v159, 0
    v_mov_b32 v160, 0
    v_mov_b32 v161, 0
    v_mov_b32 v162, 0
    v_mov_b32 v163, 0
    v_mov_b32 v164, 0
    v_mov_b32 v165, 0
    v_mov_b32 v166, 0
    v_mov_b32 v167, 0
    v_mov_b32 v168, 0
    v_mov_b32 v169, 0
    v_mov_b32 v170, 0
    v_mov_b32 v171, 0
    v_mov_b32 v172, 0
    v_mov_b32 v173, 0
    v_mov_b32 v174, 0
    v_mov_b32 v175, 0
    v_mov_b32 v176, 0
    v_mov_b32 v177, 0
    v_mov_b32 v178, 0
    v_mov_b32 v179, 0
    v_mov_b32 v180, 0
    v_mov_b32 v181, 0
    v_mov_b32 v182, 0
    v_mov_b32 v183, 0
    v_mov_b32 v184, 0
    v_mov_b32 v185, 0
    v_mov_b32 v186, 0
    v_mov_b32 v187, 0
    v_mov_b32 v188, 0
    v_mov_b32 v189, 0
    v_mov_b32 v190, 0
    v_mov_b32 v191, 0
    v_mov_b32 v192, 0
    v_mov_b32 v193, 0
    v_mov_b32 v194, 0
    v_mov_b32 v195, 0
    v_mov_b32 v196, 0
    v_mov_b32 v197, 0
    v_mov_b32 v198, 0
    v_mov_b32 v199, 0
    v_mov_b32 v200, 0
    v_mov_b32 v201, 0
    v_mov_b32 v202, 0
    v_mov_b32 v203, 0
    v_mov_b32 v204, 0
    v_mov_b32 v205, 0
    v_mov_b32 v206, 0
    v_mov_b32 v207, 0
    v_mov_b32 v208, 0
    v_mov_b32 v209, 0
    v_mov_b32 v210, 0
    v_mov_b32 v211, 0
    v_mov_b32 v212, 0
    v_mov_b32 v213, 0
    v_mov_b32 v214, 0
    v_mov_b32 v215, 0
    v_mov_b32 v216, 0
    v_mov_b32 v217, 0
    v_mov_b32 v218, 0
    v_mov_b32 v219, 0
    v_mov_b32 v220, 0
    v_mov_b32 v221, 0
    v_mov_b32 v222, 0
    v_mov_b32 v223, 0
    v_mov_b32 v224, 0
    v_mov_b32 v225, 0
    v_mov_b32 v226, 0
    v_mov_b32 v227, 0
    v_mov_b32 v228, 0
    v_mov_b32 v229, 0
    v_mov_b32 v230, 0
    v_mov_b32 v231, 0
    v_mov_b32 v232, 0
    v_mov_b32 v233, 0
    v_mov_b32 v234, 0
    v_mov_b32 v235, 0
    v_mov_b32 v236, 0
    v_mov_b32 v237, 0
    v_mov_b32 v238, 0
    v_mov_b32 v239, 0
    s_cmp_lg_u32 s62, 0
    s_cbranch_scc1 L_parallel_sum__sliding_block__mixer_token_mlp__prompt_kernel_clate
    s_cmp_eq_u32 s56, 0
    s_cbranch_scc1 L_parallel_sum__sliding_block__mixer_token_mlp__prompt_kernel_nosw
    v_swap_b32 v4, v6
    v_swap_b32 v5, v7
L_parallel_sum__sliding_block__mixer_token_mlp__prompt_kernel_nosw:
    s_xor_b32 s45, s56, 1
    s_lshl_b32 s45, s45, 13
    s_add_u32 s45, s45, s76
    s_lshl_b32 s40, s56, 22
    s_add_u32 s45, s45, s40
    s_lshl_b32 s40, s50, 14
    v_add_u32 v12, s40, v2
    s_mov_b32 s22, 0
    s_waitcnt vmcnt(63)
    s_barrier
    ds_read_b128 v[16:19], v3 offset:0
    ds_read_b64_tr_b16 v[48:49], v4 offset:0
    ds_read_b64_tr_b16 v[50:51], v4 offset:4096
    ds_read_b64_tr_b16 v[52:53], v5 offset:0
    ds_read_b64_tr_b16 v[54:55], v5 offset:4096
    ds_read_b64_tr_b16 v[56:57], v6 offset:0
    ds_read_b64_tr_b16 v[58:59], v6 offset:4096
    ds_read_b64_tr_b16 v[60:61], v7 offset:0
    ds_read_b64_tr_b16 v[62:63], v7 offset:4096
    ds_read_b128 v[20:23], v3 offset:256
    ds_read_b128 v[24:27], v3 offset:4096
    ds_read_b128 v[28:31], v3 offset:4352
    ds_read_b128 v[32:35], v3 offset:8192
    ds_read_b128 v[36:39], v3 offset:8448
    ds_read_b128 v[40:43], v3 offset:12288
    ds_read_b128 v[44:47], v3 offset:12544
    s_and_b32 s40, s60, 1
    s_add_u32 s49, s60, 1
    s_lshr_b32 s49, s49, 1
    s_cmp_lg_u32 s40, 0
    s_cbranch_scc1 L_parallel_sum__sliding_block__mixer_token_mlp__prompt_kernel_ce_b
L_parallel_sum__sliding_block__mixer_token_mlp__prompt_kernel_ce_a:
    s_waitcnt lgkmcnt(13)
    v_mfma_f32_16x16x32_bf16 v[112:115], v[16:19], v[48:51], v[112:115]
    ds_read_b128 v[64:67], v3 offset:2048
    s_waitcnt lgkmcnt(12)
    v_mfma_f32_16x16x32_bf16 v[144:147], v[16:19], v[52:55], v[144:147]
    ds_read_b64_tr_b16 v[96:97], v4 offset:8192
    s_waitcnt lgkmcnt(11)
    v_mfma_f32_16x16x32_bf16 v[176:179], v[16:19], v[56:59], v[176:179]
    ds_read_b64_tr_b16 v[98:99], v4 offset:12288
    s_waitcnt lgkmcnt(10)
    v_mfma_f32_16x16x32_bf16 v[208:211], v[16:19], v[60:63], v[208:211]
    ds_read_b64_tr_b16 v[100:101], v5 offset:8192
    s_waitcnt lgkmcnt(10)
    v_mfma_f32_16x16x32_bf16 v[212:215], v[20:23], v[60:63], v[212:215]
    ds_read_b64_tr_b16 v[102:103], v5 offset:12288
    v_mfma_f32_16x16x32_bf16 v[180:183], v[20:23], v[56:59], v[180:183]
    ds_read_b64_tr_b16 v[104:105], v6 offset:8192
    v_mfma_f32_16x16x32_bf16 v[148:151], v[20:23], v[52:55], v[148:151]
    ds_read_b64_tr_b16 v[106:107], v6 offset:12288
    v_mfma_f32_16x16x32_bf16 v[116:119], v[20:23], v[48:51], v[116:119]
    ds_read_b64_tr_b16 v[108:109], v7 offset:8192
    s_waitcnt lgkmcnt(13)
    v_mfma_f32_16x16x32_bf16 v[120:123], v[24:27], v[48:51], v[120:123]
    ds_read_b64_tr_b16 v[110:111], v7 offset:12288
    v_mfma_f32_16x16x32_bf16 v[152:155], v[24:27], v[52:55], v[152:155]
    ds_read_b128 v[68:71], v3 offset:2304
    v_mfma_f32_16x16x32_bf16 v[184:187], v[24:27], v[56:59], v[184:187]
    ds_read_b128 v[72:75], v3 offset:6144
    v_mfma_f32_16x16x32_bf16 v[216:219], v[24:27], v[60:63], v[216:219]
    ds_read_b128 v[76:79], v3 offset:6400
    s_waitcnt lgkmcnt(15)
    v_mfma_f32_16x16x32_bf16 v[220:223], v[28:31], v[60:63], v[220:223]
    ds_read_b128 v[80:83], v3 offset:10240
    v_mfma_f32_16x16x32_bf16 v[188:191], v[28:31], v[56:59], v[188:191]
    ds_read_b128 v[84:87], v3 offset:10496
    v_mfma_f32_16x16x32_bf16 v[156:159], v[28:31], v[52:55], v[156:159]
    ds_read_b128 v[88:91], v3 offset:14336
    v_mfma_f32_16x16x32_bf16 v[124:127], v[28:31], v[48:51], v[124:127]
    ds_read_b128 v[92:95], v3 offset:14592
    s_add_u32 s22, s22, 49152
    s_cmp_eq_u32 s22, 147456
    s_cselect_b32 s22, 0, s22
    s_cselect_b32 s21, s51, 49152
    s_waitcnt lgkmcnt(15)
    v_mfma_f32_16x16x32_bf16 v[128:131], v[32:35], v[48:51], v[128:131]
    v_add_u32 v3, s21, v3
    v_add_u32 v4, s21, v4
    v_mfma_f32_16x16x32_bf16 v[160:163], v[32:35], v[52:55], v[160:163]
    v_add_u32 v5, s21, v5
    v_add_u32 v6, s21, v6
    v_mfma_f32_16x16x32_bf16 v[192:195], v[32:35], v[56:59], v[192:195]
    v_add_u32 v7, s21, v7
    v_mfma_f32_16x16x32_bf16 v[224:227], v[32:35], v[60:63], v[224:227]
    s_waitcnt lgkmcnt(15)
    v_mfma_f32_16x16x32_bf16 v[228:231], v[36:39], v[60:63], v[228:231]
    v_mfma_f32_16x16x32_bf16 v[196:199], v[36:39], v[56:59], v[196:199]
    v_mfma_f32_16x16x32_bf16 v[164:167], v[36:39], v[52:55], v[164:167]
    v_mfma_f32_16x16x32_bf16 v[132:135], v[36:39], v[48:51], v[132:135]
    s_waitcnt lgkmcnt(15)
    v_mfma_f32_16x16x32_bf16 v[136:139], v[40:43], v[48:51], v[136:139]
    v_mfma_f32_16x16x32_bf16 v[168:171], v[40:43], v[52:55], v[168:171]
    v_mfma_f32_16x16x32_bf16 v[200:203], v[40:43], v[56:59], v[200:203]
    v_mfma_f32_16x16x32_bf16 v[232:235], v[40:43], v[60:63], v[232:235]
    s_waitcnt lgkmcnt(15)
    v_mfma_f32_16x16x32_bf16 v[236:239], v[44:47], v[60:63], v[236:239]
    v_mfma_f32_16x16x32_bf16 v[204:207], v[44:47], v[56:59], v[204:207]
    v_mfma_f32_16x16x32_bf16 v[172:175], v[44:47], v[52:55], v[172:175]
    v_mfma_f32_16x16x32_bf16 v[140:143], v[44:47], v[48:51], v[140:143]
    s_waitcnt vmcnt(63) lgkmcnt(0)
    s_barrier
    v_mfma_f32_16x16x32_bf16 v[112:115], v[64:67], v[96:99], v[112:115]
    ds_read_b128 v[16:19], v3 offset:0
    v_mfma_f32_16x16x32_bf16 v[144:147], v[64:67], v[100:103], v[144:147]
    ds_read_b64_tr_b16 v[48:49], v4 offset:0
    v_mfma_f32_16x16x32_bf16 v[176:179], v[64:67], v[104:107], v[176:179]
    ds_read_b64_tr_b16 v[50:51], v4 offset:4096
    v_mfma_f32_16x16x32_bf16 v[208:211], v[64:67], v[108:111], v[208:211]
    ds_read_b64_tr_b16 v[52:53], v5 offset:0
    v_mfma_f32_16x16x32_bf16 v[212:215], v[68:71], v[108:111], v[212:215]
    ds_read_b64_tr_b16 v[54:55], v5 offset:4096
    v_mfma_f32_16x16x32_bf16 v[180:183], v[68:71], v[104:107], v[180:183]
    ds_read_b64_tr_b16 v[56:57], v6 offset:0
    v_mfma_f32_16x16x32_bf16 v[148:151], v[68:71], v[100:103], v[148:151]
    ds_read_b64_tr_b16 v[58:59], v6 offset:4096
    v_mfma_f32_16x16x32_bf16 v[116:119], v[68:71], v[96:99], v[116:119]
    ds_read_b64_tr_b16 v[60:61], v7 offset:0
    v_mfma_f32_16x16x32_bf16 v[120:123], v[72:75], v[96:99], v[120:123]
    ds_read_b64_tr_b16 v[62:63], v7 offset:4096
    v_mfma_f32_16x16x32_bf16 v[152:155], v[72:75], v[100:103], v[152:155]
    ds_read_b128 v[20:23], v3 offset:256
    v_mfma_f32_16x16x32_bf16 v[184:187], v[72:75], v[104:107], v[184:187]
    ds_read_b128 v[24:27], v3 offset:4096
    v_mfma_f32_16x16x32_bf16 v[216:219], v[72:75], v[108:111], v[216:219]
    ds_read_b128 v[28:31], v3 offset:4352
    v_mfma_f32_16x16x32_bf16 v[220:223], v[76:79], v[108:111], v[220:223]
    ds_read_b128 v[32:35], v3 offset:8192
    v_mfma_f32_16x16x32_bf16 v[188:191], v[76:79], v[104:107], v[188:191]
    ds_read_b128 v[36:39], v3 offset:8448
    v_mfma_f32_16x16x32_bf16 v[156:159], v[76:79], v[100:103], v[156:159]
    ds_read_b128 v[40:43], v3 offset:12288
    v_mfma_f32_16x16x32_bf16 v[124:127], v[76:79], v[96:99], v[124:127]
    ds_read_b128 v[44:47], v3 offset:12544
    v_mfma_f32_16x16x32_bf16 v[128:131], v[80:83], v[96:99], v[128:131]
    v_mfma_f32_16x16x32_bf16 v[160:163], v[80:83], v[100:103], v[160:163]
    v_mfma_f32_16x16x32_bf16 v[192:195], v[80:83], v[104:107], v[192:195]
    v_mfma_f32_16x16x32_bf16 v[224:227], v[80:83], v[108:111], v[224:227]
    v_mfma_f32_16x16x32_bf16 v[228:231], v[84:87], v[108:111], v[228:231]
    v_mfma_f32_16x16x32_bf16 v[196:199], v[84:87], v[104:107], v[196:199]
    v_mfma_f32_16x16x32_bf16 v[164:167], v[84:87], v[100:103], v[164:167]
    v_mfma_f32_16x16x32_bf16 v[132:135], v[84:87], v[96:99], v[132:135]
    v_mfma_f32_16x16x32_bf16 v[136:139], v[88:91], v[96:99], v[136:139]
    v_mfma_f32_16x16x32_bf16 v[168:171], v[88:91], v[100:103], v[168:171]
    v_mfma_f32_16x16x32_bf16 v[200:203], v[88:91], v[104:107], v[200:203]
    v_mfma_f32_16x16x32_bf16 v[232:235], v[88:91], v[108:111], v[232:235]
    v_mfma_f32_16x16x32_bf16 v[236:239], v[92:95], v[108:111], v[236:239]
    v_mfma_f32_16x16x32_bf16 v[204:207], v[92:95], v[104:107], v[204:207]
    v_mfma_f32_16x16x32_bf16 v[172:175], v[92:95], v[100:103], v[172:175]
    v_mfma_f32_16x16x32_bf16 v[140:143], v[92:95], v[96:99], v[140:143]
L_parallel_sum__sliding_block__mixer_token_mlp__prompt_kernel_ce_b:
    s_waitcnt lgkmcnt(13)
    v_mfma_f32_16x16x32_bf16 v[112:115], v[16:19], v[48:51], v[112:115]
    ds_read_b128 v[64:67], v3 offset:2048
    s_waitcnt lgkmcnt(12)
    v_mfma_f32_16x16x32_bf16 v[144:147], v[16:19], v[52:55], v[144:147]
    ds_read_b64_tr_b16 v[96:97], v4 offset:8192
    s_waitcnt lgkmcnt(11)
    v_mfma_f32_16x16x32_bf16 v[176:179], v[16:19], v[56:59], v[176:179]
    ds_read_b64_tr_b16 v[98:99], v4 offset:12288
    s_waitcnt lgkmcnt(10)
    v_mfma_f32_16x16x32_bf16 v[208:211], v[16:19], v[60:63], v[208:211]
    ds_read_b64_tr_b16 v[100:101], v5 offset:8192
    s_waitcnt lgkmcnt(10)
    v_mfma_f32_16x16x32_bf16 v[212:215], v[20:23], v[60:63], v[212:215]
    ds_read_b64_tr_b16 v[102:103], v5 offset:12288
    v_mfma_f32_16x16x32_bf16 v[180:183], v[20:23], v[56:59], v[180:183]
    ds_read_b64_tr_b16 v[104:105], v6 offset:8192
    v_mfma_f32_16x16x32_bf16 v[148:151], v[20:23], v[52:55], v[148:151]
    ds_read_b64_tr_b16 v[106:107], v6 offset:12288
    v_mfma_f32_16x16x32_bf16 v[116:119], v[20:23], v[48:51], v[116:119]
    ds_read_b64_tr_b16 v[108:109], v7 offset:8192
    s_waitcnt lgkmcnt(13)
    v_mfma_f32_16x16x32_bf16 v[120:123], v[24:27], v[48:51], v[120:123]
    ds_read_b64_tr_b16 v[110:111], v7 offset:12288
    v_mfma_f32_16x16x32_bf16 v[152:155], v[24:27], v[52:55], v[152:155]
    ds_read_b128 v[68:71], v3 offset:2304
    v_mfma_f32_16x16x32_bf16 v[184:187], v[24:27], v[56:59], v[184:187]
    ds_read_b128 v[72:75], v3 offset:6144
    v_mfma_f32_16x16x32_bf16 v[216:219], v[24:27], v[60:63], v[216:219]
    ds_read_b128 v[76:79], v3 offset:6400
    s_waitcnt lgkmcnt(15)
    v_mfma_f32_16x16x32_bf16 v[220:223], v[28:31], v[60:63], v[220:223]
    ds_read_b128 v[80:83], v3 offset:10240
    v_mfma_f32_16x16x32_bf16 v[188:191], v[28:31], v[56:59], v[188:191]
    ds_read_b128 v[84:87], v3 offset:10496
    v_mfma_f32_16x16x32_bf16 v[156:159], v[28:31], v[52:55], v[156:159]
    ds_read_b128 v[88:91], v3 offset:14336
    v_mfma_f32_16x16x32_bf16 v[124:127], v[28:31], v[48:51], v[124:127]
    ds_read_b128 v[92:95], v3 offset:14592
    s_add_u32 s22, s22, 49152
    s_cmp_eq_u32 s22, 147456
    s_cselect_b32 s22, 0, s22
    s_cselect_b32 s21, s51, 49152
    s_waitcnt lgkmcnt(15)
    v_mfma_f32_16x16x32_bf16 v[128:131], v[32:35], v[48:51], v[128:131]
    v_add_u32 v3, s21, v3
    v_add_u32 v4, s21, v4
    v_mfma_f32_16x16x32_bf16 v[160:163], v[32:35], v[52:55], v[160:163]
    v_add_u32 v5, s21, v5
    v_add_u32 v6, s21, v6
    v_mfma_f32_16x16x32_bf16 v[192:195], v[32:35], v[56:59], v[192:195]
    v_add_u32 v7, s21, v7
    v_mfma_f32_16x16x32_bf16 v[224:227], v[32:35], v[60:63], v[224:227]
    s_waitcnt lgkmcnt(15)
    v_mfma_f32_16x16x32_bf16 v[228:231], v[36:39], v[60:63], v[228:231]
    v_mfma_f32_16x16x32_bf16 v[196:199], v[36:39], v[56:59], v[196:199]
    v_mfma_f32_16x16x32_bf16 v[164:167], v[36:39], v[52:55], v[164:167]
    v_mfma_f32_16x16x32_bf16 v[132:135], v[36:39], v[48:51], v[132:135]
    s_waitcnt lgkmcnt(15)
    v_mfma_f32_16x16x32_bf16 v[136:139], v[40:43], v[48:51], v[136:139]
    v_mfma_f32_16x16x32_bf16 v[168:171], v[40:43], v[52:55], v[168:171]
    v_mfma_f32_16x16x32_bf16 v[200:203], v[40:43], v[56:59], v[200:203]
    v_mfma_f32_16x16x32_bf16 v[232:235], v[40:43], v[60:63], v[232:235]
    s_waitcnt lgkmcnt(15)
    v_mfma_f32_16x16x32_bf16 v[236:239], v[44:47], v[60:63], v[236:239]
    v_mfma_f32_16x16x32_bf16 v[204:207], v[44:47], v[56:59], v[204:207]
    v_mfma_f32_16x16x32_bf16 v[172:175], v[44:47], v[52:55], v[172:175]
    v_mfma_f32_16x16x32_bf16 v[140:143], v[44:47], v[48:51], v[140:143]
    s_waitcnt vmcnt(63) lgkmcnt(0)
    s_barrier
    v_mfma_f32_16x16x32_bf16 v[112:115], v[64:67], v[96:99], v[112:115]
    ds_read_b128 v[16:19], v3 offset:0
    v_mfma_f32_16x16x32_bf16 v[144:147], v[64:67], v[100:103], v[144:147]
    ds_read_b64_tr_b16 v[48:49], v4 offset:0
    v_mfma_f32_16x16x32_bf16 v[176:179], v[64:67], v[104:107], v[176:179]
    ds_read_b64_tr_b16 v[50:51], v4 offset:4096
    v_mfma_f32_16x16x32_bf16 v[208:211], v[64:67], v[108:111], v[208:211]
    ds_read_b64_tr_b16 v[52:53], v5 offset:0
    v_mfma_f32_16x16x32_bf16 v[212:215], v[68:71], v[108:111], v[212:215]
    ds_read_b64_tr_b16 v[54:55], v5 offset:4096
    v_mfma_f32_16x16x32_bf16 v[180:183], v[68:71], v[104:107], v[180:183]
    ds_read_b64_tr_b16 v[56:57], v6 offset:0
    v_mfma_f32_16x16x32_bf16 v[148:151], v[68:71], v[100:103], v[148:151]
    ds_read_b64_tr_b16 v[58:59], v6 offset:4096
    v_mfma_f32_16x16x32_bf16 v[116:119], v[68:71], v[96:99], v[116:119]
    ds_read_b64_tr_b16 v[60:61], v7 offset:0
    v_mfma_f32_16x16x32_bf16 v[120:123], v[72:75], v[96:99], v[120:123]
    ds_read_b64_tr_b16 v[62:63], v7 offset:4096
    v_mfma_f32_16x16x32_bf16 v[152:155], v[72:75], v[100:103], v[152:155]
    ds_read_b128 v[20:23], v3 offset:256
    v_mfma_f32_16x16x32_bf16 v[184:187], v[72:75], v[104:107], v[184:187]
    ds_read_b128 v[24:27], v3 offset:4096
    v_mfma_f32_16x16x32_bf16 v[216:219], v[72:75], v[108:111], v[216:219]
    ds_read_b128 v[28:31], v3 offset:4352
    v_mfma_f32_16x16x32_bf16 v[220:223], v[76:79], v[108:111], v[220:223]
    ds_read_b128 v[32:35], v3 offset:8192
    v_mfma_f32_16x16x32_bf16 v[188:191], v[76:79], v[104:107], v[188:191]
    ds_read_b128 v[36:39], v3 offset:8448
    v_mfma_f32_16x16x32_bf16 v[156:159], v[76:79], v[100:103], v[156:159]
    ds_read_b128 v[40:43], v3 offset:12288
    v_mfma_f32_16x16x32_bf16 v[124:127], v[76:79], v[96:99], v[124:127]
    ds_read_b128 v[44:47], v3 offset:12544
    v_mfma_f32_16x16x32_bf16 v[128:131], v[80:83], v[96:99], v[128:131]
    v_mfma_f32_16x16x32_bf16 v[160:163], v[80:83], v[100:103], v[160:163]
    v_mfma_f32_16x16x32_bf16 v[192:195], v[80:83], v[104:107], v[192:195]
    v_mfma_f32_16x16x32_bf16 v[224:227], v[80:83], v[108:111], v[224:227]
    v_mfma_f32_16x16x32_bf16 v[228:231], v[84:87], v[108:111], v[228:231]
    v_mfma_f32_16x16x32_bf16 v[196:199], v[84:87], v[104:107], v[196:199]
    v_mfma_f32_16x16x32_bf16 v[164:167], v[84:87], v[100:103], v[164:167]
    v_mfma_f32_16x16x32_bf16 v[132:135], v[84:87], v[96:99], v[132:135]
    v_mfma_f32_16x16x32_bf16 v[136:139], v[88:91], v[96:99], v[136:139]
    v_mfma_f32_16x16x32_bf16 v[168:171], v[88:91], v[100:103], v[168:171]
    v_mfma_f32_16x16x32_bf16 v[200:203], v[88:91], v[104:107], v[200:203]
    v_mfma_f32_16x16x32_bf16 v[232:235], v[88:91], v[108:111], v[232:235]
    v_mfma_f32_16x16x32_bf16 v[236:239], v[92:95], v[108:111], v[236:239]
    v_mfma_f32_16x16x32_bf16 v[204:207], v[92:95], v[104:107], v[204:207]
    v_mfma_f32_16x16x32_bf16 v[172:175], v[92:95], v[100:103], v[172:175]
    v_mfma_f32_16x16x32_bf16 v[140:143], v[92:95], v[96:99], v[140:143]
    s_sub_u32 s49, s49, 1
    s_cmp_lg_u32 s49, 0
    s_cbranch_scc1 L_parallel_sum__sliding_block__mixer_token_mlp__prompt_kernel_ce_a
    s_waitcnt lgkmcnt(0)
    s_nop 7
    v_cvt_pk_bf16_f32 v176, v176, v177
    v_cvt_pk_bf16_f32 v177, v178, v179
    v_cvt_pk_bf16_f32 v178, v180, v181
    v_cvt_pk_bf16_f32 v179, v182, v183
    buffer_store_dwordx4 v[176:179], v2, s[12:15], s45 offen offset:0 sc1
    v_cvt_pk_bf16_f32 v184, v184, v185
    v_cvt_pk_bf16_f32 v185, v186, v187
    v_cvt_pk_bf16_f32 v186, v188, v189
    v_cvt_pk_bf16_f32 v187, v190, v191
    buffer_store_dwordx4 v[184:187], v2, s[12:15], s45 offen offset:1024 sc1
    v_cvt_pk_bf16_f32 v192, v192, v193
    v_cvt_pk_bf16_f32 v193, v194, v195
    v_cvt_pk_bf16_f32 v194, v196, v197
    v_cvt_pk_bf16_f32 v195, v198, v199
    buffer_store_dwordx4 v[192:195], v2, s[12:15], s45 offen offset:2048 sc1
    v_cvt_pk_bf16_f32 v200, v200, v201
    v_cvt_pk_bf16_f32 v201, v202, v203
    v_cvt_pk_bf16_f32 v202, v204, v205
    v_cvt_pk_bf16_f32 v203, v206, v207
    buffer_store_dwordx4 v[200:203], v2, s[12:15], s45 offen offset:3072 sc1
    s_add_u32 s45, s45, 4096
    v_cvt_pk_bf16_f32 v208, v208, v209
    v_cvt_pk_bf16_f32 v209, v210, v211
    v_cvt_pk_bf16_f32 v210, v212, v213
    v_cvt_pk_bf16_f32 v211, v214, v215
    buffer_store_dwordx4 v[208:211], v2, s[12:15], s45 offen offset:0 sc1
    v_cvt_pk_bf16_f32 v216, v216, v217
    v_cvt_pk_bf16_f32 v217, v218, v219
    v_cvt_pk_bf16_f32 v218, v220, v221
    v_cvt_pk_bf16_f32 v219, v222, v223
    buffer_store_dwordx4 v[216:219], v2, s[12:15], s45 offen offset:1024 sc1
    v_cvt_pk_bf16_f32 v224, v224, v225
    v_cvt_pk_bf16_f32 v225, v226, v227
    v_cvt_pk_bf16_f32 v226, v228, v229
    v_cvt_pk_bf16_f32 v227, v230, v231
    buffer_store_dwordx4 v[224:227], v2, s[12:15], s45 offen offset:2048 sc1
    v_cvt_pk_bf16_f32 v232, v232, v233
    v_cvt_pk_bf16_f32 v233, v234, v235
    v_cvt_pk_bf16_f32 v234, v236, v237
    v_cvt_pk_bf16_f32 v235, v238, v239
    buffer_store_dwordx4 v[232:235], v2, s[12:15], s45 offen offset:3072 sc1
    ds_write_b128 v12, v[112:115] offset:0
    ds_write_b128 v12, v[116:119] offset:1024
    ds_write_b128 v12, v[120:123] offset:2048
    ds_write_b128 v12, v[124:127] offset:3072
    ds_write_b128 v12, v[128:131] offset:4096
    ds_write_b128 v12, v[132:135] offset:5120
    ds_write_b128 v12, v[136:139] offset:6144
    ds_write_b128 v12, v[140:143] offset:7168
    ds_write_b128 v12, v[144:147] offset:8192
    ds_write_b128 v12, v[148:151] offset:9216
    ds_write_b128 v12, v[152:155] offset:10240
    ds_write_b128 v12, v[156:159] offset:11264
    ds_write_b128 v12, v[160:163] offset:12288
    ds_write_b128 v12, v[164:167] offset:13312
    ds_write_b128 v12, v[168:171] offset:14336
    ds_write_b128 v12, v[172:175] offset:15360
    s_waitcnt lgkmcnt(0)
    s_barrier
    s_branch L_parallel_sum__sliding_block__mixer_token_mlp__prompt_kernel_done
L_parallel_sum__sliding_block__mixer_token_mlp__prompt_kernel_clate:
    v_lshrrev_b32 v16, 4, v1
    v_and_b32 v17, 15, v1
    v_lshlrev_b32 v17, 4, v17
    v_lshl_add_u32 v17, v16, 9, v17
    s_mul_i32 s27, s25, 8192
    v_add_u32 v8, s27, v17
    v_lshrrev_b32 v17, 1, v16
    v_lshlrev_b32 v17, 4, v17
    v_and_b32 v18, 1, v16
    v_lshl_add_u32 v17, v18, 2, v17
    v_bfe_u32 v18, v1, 2, 2
    v_add_u32 v17, v17, v18
    v_lshlrev_b32 v17, 9, v17
    v_and_b32 v19, 3, v1
    v_lshl_add_u32 v17, v19, 3, v17
    v_add_u32 v17, 16384, v17
    v_and_b32 v16, 1, v16
    v_lshl_add_u32 v16, v18, 1, v16
    s_mul_i32 s27, s24, 8
    s_add_u32 s3, s27, 0
    v_xor_b32 v18, s3, v16
    v_lshl_add_u32 v240, v18, 5, v17
    s_add_u32 s3, s27, 1
    v_xor_b32 v18, s3, v16
    v_lshl_add_u32 v241, v18, 5, v17
    s_add_u32 s3, s27, 2
    v_xor_b32 v18, s3, v16
    v_lshl_add_u32 v242, v18, 5, v17
    s_add_u32 s3, s27, 3
    v_xor_b32 v18, s3, v16
    v_lshl_add_u32 v243, v18, 5, v17
    s_add_u32 s3, s27, 4
    v_xor_b32 v18, s3, v16
    v_lshl_add_u32 v244, v18, 5, v17
    s_add_u32 s3, s27, 5
    v_xor_b32 v18, s3, v16
    v_lshl_add_u32 v245, v18, 5, v17
    s_add_u32 s3, s27, 6
    v_xor_b32 v18, s3, v16
    v_lshl_add_u32 v246, v18, 5, v17
    s_add_u32 s3, s27, 7
    v_xor_b32 v18, s3, v16
    v_lshl_add_u32 v247, v18, 5, v17
    s_mov_b32 s44, 7
    s_mov_b32 s22, 0
    s_waitcnt vmcnt(63)
    s_barrier
    ds_read_b128 v[16:19], v8 offset:0
    ds_read_b64_tr_b16 v[32:33], v240 offset:0
    ds_read_b64_tr_b16 v[34:35], v240 offset:4096
    ds_read_b64_tr_b16 v[36:37], v241 offset:0
    ds_read_b64_tr_b16 v[38:39], v241 offset:4096
    ds_read_b64_tr_b16 v[40:41], v242 offset:0
    ds_read_b64_tr_b16 v[42:43], v242 offset:4096
    ds_read_b64_tr_b16 v[44:45], v243 offset:0
    ds_read_b64_tr_b16 v[46:47], v243 offset:4096
    ds_read_b64_tr_b16 v[48:49], v244 offset:0
    ds_read_b64_tr_b16 v[50:51], v244 offset:4096
    ds_read_b64_tr_b16 v[52:53], v245 offset:0
    ds_read_b64_tr_b16 v[54:55], v245 offset:4096
    ds_read_b64_tr_b16 v[56:57], v246 offset:0
    ds_read_b64_tr_b16 v[58:59], v246 offset:4096
    ds_read_b64_tr_b16 v[60:61], v247 offset:0
    ds_read_b64_tr_b16 v[62:63], v247 offset:4096
    ds_read_b128 v[20:23], v8 offset:256
    ds_read_b128 v[24:27], v8 offset:4096
    ds_read_b128 v[28:31], v8 offset:4352
    s_and_b32 s40, s44, 1
    s_add_u32 s49, s44, 1
    s_lshr_b32 s49, s49, 1
    s_cmp_lg_u32 s40, 0
    s_cbranch_scc1 L_parallel_sum__sliding_block__mixer_token_mlp__prompt_kernel_cw_b
L_parallel_sum__sliding_block__mixer_token_mlp__prompt_kernel_cw_a:
    s_waitcnt lgkmcnt(15)
    v_mfma_f32_16x16x32_bf16 v[112:115], v[32:35], v[16:19], v[112:115]
    ds_read_b128 v[64:67], v8 offset:2048
    s_waitcnt lgkmcnt(15)
    v_mfma_f32_16x16x32_bf16 v[116:119], v[36:39], v[16:19], v[116:119]
    ds_read_b64_tr_b16 v[80:81], v240 offset:16384
    s_waitcnt lgkmcnt(15)
    v_mfma_f32_16x16x32_bf16 v[120:123], v[40:43], v[16:19], v[120:123]
    ds_read_b64_tr_b16 v[82:83], v240 offset:20480
    s_waitcnt lgkmcnt(14)
    v_mfma_f32_16x16x32_bf16 v[124:127], v[44:47], v[16:19], v[124:127]
    ds_read_b64_tr_b16 v[84:85], v241 offset:16384
    s_waitcnt lgkmcnt(13)
    v_mfma_f32_16x16x32_bf16 v[128:131], v[48:51], v[16:19], v[128:131]
    ds_read_b64_tr_b16 v[86:87], v241 offset:20480
    s_waitcnt lgkmcnt(12)
    v_mfma_f32_16x16x32_bf16 v[132:135], v[52:55], v[16:19], v[132:135]
    ds_read_b64_tr_b16 v[88:89], v242 offset:16384
    s_waitcnt lgkmcnt(11)
    v_mfma_f32_16x16x32_bf16 v[136:139], v[56:59], v[16:19], v[136:139]
    ds_read_b64_tr_b16 v[90:91], v242 offset:20480
    s_waitcnt lgkmcnt(10)
    v_mfma_f32_16x16x32_bf16 v[140:143], v[60:63], v[16:19], v[140:143]
    ds_read_b64_tr_b16 v[92:93], v243 offset:16384
    s_waitcnt lgkmcnt(10)
    v_mfma_f32_16x16x32_bf16 v[172:175], v[60:63], v[20:23], v[172:175]
    ds_read_b64_tr_b16 v[94:95], v243 offset:20480
    v_mfma_f32_16x16x32_bf16 v[168:171], v[56:59], v[20:23], v[168:171]
    ds_read_b64_tr_b16 v[96:97], v244 offset:16384
    v_mfma_f32_16x16x32_bf16 v[164:167], v[52:55], v[20:23], v[164:167]
    ds_read_b64_tr_b16 v[98:99], v244 offset:20480
    v_mfma_f32_16x16x32_bf16 v[160:163], v[48:51], v[20:23], v[160:163]
    ds_read_b64_tr_b16 v[100:101], v245 offset:16384
    v_mfma_f32_16x16x32_bf16 v[156:159], v[44:47], v[20:23], v[156:159]
    ds_read_b64_tr_b16 v[102:103], v245 offset:20480
    v_mfma_f32_16x16x32_bf16 v[152:155], v[40:43], v[20:23], v[152:155]
    ds_read_b64_tr_b16 v[104:105], v246 offset:16384
    v_mfma_f32_16x16x32_bf16 v[148:151], v[36:39], v[20:23], v[148:151]
    ds_read_b64_tr_b16 v[106:107], v246 offset:20480
    v_mfma_f32_16x16x32_bf16 v[144:147], v[32:35], v[20:23], v[144:147]
    ds_read_b64_tr_b16 v[108:109], v247 offset:16384
    s_waitcnt lgkmcnt(15)
    v_mfma_f32_16x16x32_bf16 v[176:179], v[32:35], v[24:27], v[176:179]
    ds_read_b64_tr_b16 v[110:111], v247 offset:20480
    v_mfma_f32_16x16x32_bf16 v[180:183], v[36:39], v[24:27], v[180:183]
    ds_read_b128 v[68:71], v8 offset:2304
    v_mfma_f32_16x16x32_bf16 v[184:187], v[40:43], v[24:27], v[184:187]
    ds_read_b128 v[72:75], v8 offset:6144
    v_mfma_f32_16x16x32_bf16 v[188:191], v[44:47], v[24:27], v[188:191]
    ds_read_b128 v[76:79], v8 offset:6400
    s_add_u32 s22, s22, 49152
    s_cmp_eq_u32 s22, 147456
    s_cselect_b32 s22, 0, s22
    s_cselect_b32 s21, s51, 49152
    v_mfma_f32_16x16x32_bf16 v[192:195], v[48:51], v[24:27], v[192:195]
    v_add_u32 v8, s21, v8
    v_add_u32 v240, s21, v240
    v_mfma_f32_16x16x32_bf16 v[196:199], v[52:55], v[24:27], v[196:199]
    v_add_u32 v241, s21, v241
    v_add_u32 v242, s21, v242
    v_mfma_f32_16x16x32_bf16 v[200:203], v[56:59], v[24:27], v[200:203]
    v_add_u32 v243, s21, v243
    v_add_u32 v244, s21, v244
    v_mfma_f32_16x16x32_bf16 v[204:207], v[60:63], v[24:27], v[204:207]
    v_add_u32 v245, s21, v245
    v_add_u32 v246, s21, v246
    s_waitcnt lgkmcnt(15)
    v_mfma_f32_16x16x32_bf16 v[236:239], v[60:63], v[28:31], v[236:239]
    v_add_u32 v247, s21, v247
    v_mfma_f32_16x16x32_bf16 v[232:235], v[56:59], v[28:31], v[232:235]
    v_mfma_f32_16x16x32_bf16 v[228:231], v[52:55], v[28:31], v[228:231]
    v_mfma_f32_16x16x32_bf16 v[224:227], v[48:51], v[28:31], v[224:227]
    v_mfma_f32_16x16x32_bf16 v[220:223], v[44:47], v[28:31], v[220:223]
    v_mfma_f32_16x16x32_bf16 v[216:219], v[40:43], v[28:31], v[216:219]
    v_mfma_f32_16x16x32_bf16 v[212:215], v[36:39], v[28:31], v[212:215]
    v_mfma_f32_16x16x32_bf16 v[208:211], v[32:35], v[28:31], v[208:211]
    s_waitcnt vmcnt(63) lgkmcnt(0)
    s_barrier
    v_mfma_f32_16x16x32_bf16 v[112:115], v[80:83], v[64:67], v[112:115]
    ds_read_b128 v[16:19], v8 offset:0
    v_mfma_f32_16x16x32_bf16 v[116:119], v[84:87], v[64:67], v[116:119]
    ds_read_b64_tr_b16 v[32:33], v240 offset:0
    v_mfma_f32_16x16x32_bf16 v[120:123], v[88:91], v[64:67], v[120:123]
    ds_read_b64_tr_b16 v[34:35], v240 offset:4096
    v_mfma_f32_16x16x32_bf16 v[124:127], v[92:95], v[64:67], v[124:127]
    ds_read_b64_tr_b16 v[36:37], v241 offset:0
    v_mfma_f32_16x16x32_bf16 v[128:131], v[96:99], v[64:67], v[128:131]
    ds_read_b64_tr_b16 v[38:39], v241 offset:4096
    v_mfma_f32_16x16x32_bf16 v[132:135], v[100:103], v[64:67], v[132:135]
    ds_read_b64_tr_b16 v[40:41], v242 offset:0
    v_mfma_f32_16x16x32_bf16 v[136:139], v[104:107], v[64:67], v[136:139]
    ds_read_b64_tr_b16 v[42:43], v242 offset:4096
    v_mfma_f32_16x16x32_bf16 v[140:143], v[108:111], v[64:67], v[140:143]
    ds_read_b64_tr_b16 v[44:45], v243 offset:0
    v_mfma_f32_16x16x32_bf16 v[172:175], v[108:111], v[68:71], v[172:175]
    ds_read_b64_tr_b16 v[46:47], v243 offset:4096
    v_mfma_f32_16x16x32_bf16 v[168:171], v[104:107], v[68:71], v[168:171]
    ds_read_b64_tr_b16 v[48:49], v244 offset:0
    v_mfma_f32_16x16x32_bf16 v[164:167], v[100:103], v[68:71], v[164:167]
    ds_read_b64_tr_b16 v[50:51], v244 offset:4096
    v_mfma_f32_16x16x32_bf16 v[160:163], v[96:99], v[68:71], v[160:163]
    ds_read_b64_tr_b16 v[52:53], v245 offset:0
    v_mfma_f32_16x16x32_bf16 v[156:159], v[92:95], v[68:71], v[156:159]
    ds_read_b64_tr_b16 v[54:55], v245 offset:4096
    v_mfma_f32_16x16x32_bf16 v[152:155], v[88:91], v[68:71], v[152:155]
    ds_read_b64_tr_b16 v[56:57], v246 offset:0
    v_mfma_f32_16x16x32_bf16 v[148:151], v[84:87], v[68:71], v[148:151]
    ds_read_b64_tr_b16 v[58:59], v246 offset:4096
    v_mfma_f32_16x16x32_bf16 v[144:147], v[80:83], v[68:71], v[144:147]
    ds_read_b64_tr_b16 v[60:61], v247 offset:0
    v_mfma_f32_16x16x32_bf16 v[176:179], v[80:83], v[72:75], v[176:179]
    ds_read_b64_tr_b16 v[62:63], v247 offset:4096
    v_mfma_f32_16x16x32_bf16 v[180:183], v[84:87], v[72:75], v[180:183]
    ds_read_b128 v[20:23], v8 offset:256
    v_mfma_f32_16x16x32_bf16 v[184:187], v[88:91], v[72:75], v[184:187]
    ds_read_b128 v[24:27], v8 offset:4096
    v_mfma_f32_16x16x32_bf16 v[188:191], v[92:95], v[72:75], v[188:191]
    ds_read_b128 v[28:31], v8 offset:4352
    v_mfma_f32_16x16x32_bf16 v[192:195], v[96:99], v[72:75], v[192:195]
    v_mfma_f32_16x16x32_bf16 v[196:199], v[100:103], v[72:75], v[196:199]
    v_mfma_f32_16x16x32_bf16 v[200:203], v[104:107], v[72:75], v[200:203]
    v_mfma_f32_16x16x32_bf16 v[204:207], v[108:111], v[72:75], v[204:207]
    v_mfma_f32_16x16x32_bf16 v[236:239], v[108:111], v[76:79], v[236:239]
    v_mfma_f32_16x16x32_bf16 v[232:235], v[104:107], v[76:79], v[232:235]
    v_mfma_f32_16x16x32_bf16 v[228:231], v[100:103], v[76:79], v[228:231]
    v_mfma_f32_16x16x32_bf16 v[224:227], v[96:99], v[76:79], v[224:227]
    v_mfma_f32_16x16x32_bf16 v[220:223], v[92:95], v[76:79], v[220:223]
    v_mfma_f32_16x16x32_bf16 v[216:219], v[88:91], v[76:79], v[216:219]
    v_mfma_f32_16x16x32_bf16 v[212:215], v[84:87], v[76:79], v[212:215]
    v_mfma_f32_16x16x32_bf16 v[208:211], v[80:83], v[76:79], v[208:211]
L_parallel_sum__sliding_block__mixer_token_mlp__prompt_kernel_cw_b:
    s_waitcnt lgkmcnt(15)
    v_mfma_f32_16x16x32_bf16 v[112:115], v[32:35], v[16:19], v[112:115]
    ds_read_b128 v[64:67], v8 offset:2048
    s_waitcnt lgkmcnt(15)
    v_mfma_f32_16x16x32_bf16 v[116:119], v[36:39], v[16:19], v[116:119]
    ds_read_b64_tr_b16 v[80:81], v240 offset:16384
    s_waitcnt lgkmcnt(15)
    v_mfma_f32_16x16x32_bf16 v[120:123], v[40:43], v[16:19], v[120:123]
    ds_read_b64_tr_b16 v[82:83], v240 offset:20480
    s_waitcnt lgkmcnt(14)
    v_mfma_f32_16x16x32_bf16 v[124:127], v[44:47], v[16:19], v[124:127]
    ds_read_b64_tr_b16 v[84:85], v241 offset:16384
    s_waitcnt lgkmcnt(13)
    v_mfma_f32_16x16x32_bf16 v[128:131], v[48:51], v[16:19], v[128:131]
    ds_read_b64_tr_b16 v[86:87], v241 offset:20480
    s_waitcnt lgkmcnt(12)
    v_mfma_f32_16x16x32_bf16 v[132:135], v[52:55], v[16:19], v[132:135]
    ds_read_b64_tr_b16 v[88:89], v242 offset:16384
    s_waitcnt lgkmcnt(11)
    v_mfma_f32_16x16x32_bf16 v[136:139], v[56:59], v[16:19], v[136:139]
    ds_read_b64_tr_b16 v[90:91], v242 offset:20480
    s_waitcnt lgkmcnt(10)
    v_mfma_f32_16x16x32_bf16 v[140:143], v[60:63], v[16:19], v[140:143]
    ds_read_b64_tr_b16 v[92:93], v243 offset:16384
    s_waitcnt lgkmcnt(10)
    v_mfma_f32_16x16x32_bf16 v[172:175], v[60:63], v[20:23], v[172:175]
    ds_read_b64_tr_b16 v[94:95], v243 offset:20480
    v_mfma_f32_16x16x32_bf16 v[168:171], v[56:59], v[20:23], v[168:171]
    ds_read_b64_tr_b16 v[96:97], v244 offset:16384
    v_mfma_f32_16x16x32_bf16 v[164:167], v[52:55], v[20:23], v[164:167]
    ds_read_b64_tr_b16 v[98:99], v244 offset:20480
    v_mfma_f32_16x16x32_bf16 v[160:163], v[48:51], v[20:23], v[160:163]
    ds_read_b64_tr_b16 v[100:101], v245 offset:16384
    v_mfma_f32_16x16x32_bf16 v[156:159], v[44:47], v[20:23], v[156:159]
    ds_read_b64_tr_b16 v[102:103], v245 offset:20480
    v_mfma_f32_16x16x32_bf16 v[152:155], v[40:43], v[20:23], v[152:155]
    ds_read_b64_tr_b16 v[104:105], v246 offset:16384
    v_mfma_f32_16x16x32_bf16 v[148:151], v[36:39], v[20:23], v[148:151]
    ds_read_b64_tr_b16 v[106:107], v246 offset:20480
    v_mfma_f32_16x16x32_bf16 v[144:147], v[32:35], v[20:23], v[144:147]
    ds_read_b64_tr_b16 v[108:109], v247 offset:16384
    s_waitcnt lgkmcnt(15)
    v_mfma_f32_16x16x32_bf16 v[176:179], v[32:35], v[24:27], v[176:179]
    ds_read_b64_tr_b16 v[110:111], v247 offset:20480
    v_mfma_f32_16x16x32_bf16 v[180:183], v[36:39], v[24:27], v[180:183]
    ds_read_b128 v[68:71], v8 offset:2304
    v_mfma_f32_16x16x32_bf16 v[184:187], v[40:43], v[24:27], v[184:187]
    ds_read_b128 v[72:75], v8 offset:6144
    v_mfma_f32_16x16x32_bf16 v[188:191], v[44:47], v[24:27], v[188:191]
    ds_read_b128 v[76:79], v8 offset:6400
    s_add_u32 s22, s22, 49152
    s_cmp_eq_u32 s22, 147456
    s_cselect_b32 s22, 0, s22
    s_cselect_b32 s21, s51, 49152
    v_mfma_f32_16x16x32_bf16 v[192:195], v[48:51], v[24:27], v[192:195]
    v_add_u32 v8, s21, v8
    v_add_u32 v240, s21, v240
    v_mfma_f32_16x16x32_bf16 v[196:199], v[52:55], v[24:27], v[196:199]
    v_add_u32 v241, s21, v241
    v_add_u32 v242, s21, v242
    v_mfma_f32_16x16x32_bf16 v[200:203], v[56:59], v[24:27], v[200:203]
    v_add_u32 v243, s21, v243
    v_add_u32 v244, s21, v244
    v_mfma_f32_16x16x32_bf16 v[204:207], v[60:63], v[24:27], v[204:207]
    v_add_u32 v245, s21, v245
    v_add_u32 v246, s21, v246
    s_waitcnt lgkmcnt(15)
    v_mfma_f32_16x16x32_bf16 v[236:239], v[60:63], v[28:31], v[236:239]
    v_add_u32 v247, s21, v247
    v_mfma_f32_16x16x32_bf16 v[232:235], v[56:59], v[28:31], v[232:235]
    v_mfma_f32_16x16x32_bf16 v[228:231], v[52:55], v[28:31], v[228:231]
    v_mfma_f32_16x16x32_bf16 v[224:227], v[48:51], v[28:31], v[224:227]
    v_mfma_f32_16x16x32_bf16 v[220:223], v[44:47], v[28:31], v[220:223]
    v_mfma_f32_16x16x32_bf16 v[216:219], v[40:43], v[28:31], v[216:219]
    v_mfma_f32_16x16x32_bf16 v[212:215], v[36:39], v[28:31], v[212:215]
    v_mfma_f32_16x16x32_bf16 v[208:211], v[32:35], v[28:31], v[208:211]
    s_waitcnt vmcnt(63) lgkmcnt(0)
    s_barrier
    v_mfma_f32_16x16x32_bf16 v[112:115], v[80:83], v[64:67], v[112:115]
    ds_read_b128 v[16:19], v8 offset:0
    v_mfma_f32_16x16x32_bf16 v[116:119], v[84:87], v[64:67], v[116:119]
    ds_read_b64_tr_b16 v[32:33], v240 offset:0
    v_mfma_f32_16x16x32_bf16 v[120:123], v[88:91], v[64:67], v[120:123]
    ds_read_b64_tr_b16 v[34:35], v240 offset:4096
    v_mfma_f32_16x16x32_bf16 v[124:127], v[92:95], v[64:67], v[124:127]
    ds_read_b64_tr_b16 v[36:37], v241 offset:0
    v_mfma_f32_16x16x32_bf16 v[128:131], v[96:99], v[64:67], v[128:131]
    ds_read_b64_tr_b16 v[38:39], v241 offset:4096
    v_mfma_f32_16x16x32_bf16 v[132:135], v[100:103], v[64:67], v[132:135]
    ds_read_b64_tr_b16 v[40:41], v242 offset:0
    v_mfma_f32_16x16x32_bf16 v[136:139], v[104:107], v[64:67], v[136:139]
    ds_read_b64_tr_b16 v[42:43], v242 offset:4096
    v_mfma_f32_16x16x32_bf16 v[140:143], v[108:111], v[64:67], v[140:143]
    ds_read_b64_tr_b16 v[44:45], v243 offset:0
    v_mfma_f32_16x16x32_bf16 v[172:175], v[108:111], v[68:71], v[172:175]
    ds_read_b64_tr_b16 v[46:47], v243 offset:4096
    v_mfma_f32_16x16x32_bf16 v[168:171], v[104:107], v[68:71], v[168:171]
    ds_read_b64_tr_b16 v[48:49], v244 offset:0
    v_mfma_f32_16x16x32_bf16 v[164:167], v[100:103], v[68:71], v[164:167]
    ds_read_b64_tr_b16 v[50:51], v244 offset:4096
    v_mfma_f32_16x16x32_bf16 v[160:163], v[96:99], v[68:71], v[160:163]
    ds_read_b64_tr_b16 v[52:53], v245 offset:0
    v_mfma_f32_16x16x32_bf16 v[156:159], v[92:95], v[68:71], v[156:159]
    ds_read_b64_tr_b16 v[54:55], v245 offset:4096
    v_mfma_f32_16x16x32_bf16 v[152:155], v[88:91], v[68:71], v[152:155]
    ds_read_b64_tr_b16 v[56:57], v246 offset:0
    v_mfma_f32_16x16x32_bf16 v[148:151], v[84:87], v[68:71], v[148:151]
    ds_read_b64_tr_b16 v[58:59], v246 offset:4096
    v_mfma_f32_16x16x32_bf16 v[144:147], v[80:83], v[68:71], v[144:147]
    ds_read_b64_tr_b16 v[60:61], v247 offset:0
    v_mfma_f32_16x16x32_bf16 v[176:179], v[80:83], v[72:75], v[176:179]
    ds_read_b64_tr_b16 v[62:63], v247 offset:4096
    v_mfma_f32_16x16x32_bf16 v[180:183], v[84:87], v[72:75], v[180:183]
    ds_read_b128 v[20:23], v8 offset:256
    v_mfma_f32_16x16x32_bf16 v[184:187], v[88:91], v[72:75], v[184:187]
    ds_read_b128 v[24:27], v8 offset:4096
    v_mfma_f32_16x16x32_bf16 v[188:191], v[92:95], v[72:75], v[188:191]
    ds_read_b128 v[28:31], v8 offset:4352
    v_mfma_f32_16x16x32_bf16 v[192:195], v[96:99], v[72:75], v[192:195]
    v_mfma_f32_16x16x32_bf16 v[196:199], v[100:103], v[72:75], v[196:199]
    v_mfma_f32_16x16x32_bf16 v[200:203], v[104:107], v[72:75], v[200:203]
    v_mfma_f32_16x16x32_bf16 v[204:207], v[108:111], v[72:75], v[204:207]
    v_mfma_f32_16x16x32_bf16 v[236:239], v[108:111], v[76:79], v[236:239]
    v_mfma_f32_16x16x32_bf16 v[232:235], v[104:107], v[76:79], v[232:235]
    v_mfma_f32_16x16x32_bf16 v[228:231], v[100:103], v[76:79], v[228:231]
    v_mfma_f32_16x16x32_bf16 v[224:227], v[96:99], v[76:79], v[224:227]
    v_mfma_f32_16x16x32_bf16 v[220:223], v[92:95], v[76:79], v[220:223]
    v_mfma_f32_16x16x32_bf16 v[216:219], v[88:91], v[76:79], v[216:219]
    v_mfma_f32_16x16x32_bf16 v[212:215], v[84:87], v[76:79], v[212:215]
    v_mfma_f32_16x16x32_bf16 v[208:211], v[80:83], v[76:79], v[208:211]
    s_sub_u32 s49, s49, 1
    s_cmp_lg_u32 s49, 0
    s_cbranch_scc1 L_parallel_sum__sliding_block__mixer_token_mlp__prompt_kernel_cw_a
    s_waitcnt lgkmcnt(15)
    v_mfma_f32_16x16x32_bf16 v[112:115], v[32:35], v[16:19], v[112:115]
    ds_read_b128 v[64:67], v8 offset:2048
    s_waitcnt lgkmcnt(15)
    v_mfma_f32_16x16x32_bf16 v[116:119], v[36:39], v[16:19], v[116:119]
    ds_read_b64_tr_b16 v[80:81], v240 offset:16384
    s_waitcnt lgkmcnt(15)
    v_mfma_f32_16x16x32_bf16 v[120:123], v[40:43], v[16:19], v[120:123]
    ds_read_b64_tr_b16 v[82:83], v240 offset:20480
    s_waitcnt lgkmcnt(14)
    v_mfma_f32_16x16x32_bf16 v[124:127], v[44:47], v[16:19], v[124:127]
    ds_read_b64_tr_b16 v[84:85], v241 offset:16384
    s_waitcnt lgkmcnt(13)
    v_mfma_f32_16x16x32_bf16 v[128:131], v[48:51], v[16:19], v[128:131]
    ds_read_b64_tr_b16 v[86:87], v241 offset:20480
    s_waitcnt lgkmcnt(12)
    v_mfma_f32_16x16x32_bf16 v[132:135], v[52:55], v[16:19], v[132:135]
    ds_read_b64_tr_b16 v[88:89], v242 offset:16384
    s_waitcnt lgkmcnt(11)
    v_mfma_f32_16x16x32_bf16 v[136:139], v[56:59], v[16:19], v[136:139]
    ds_read_b64_tr_b16 v[90:91], v242 offset:20480
    s_waitcnt lgkmcnt(10)
    v_mfma_f32_16x16x32_bf16 v[140:143], v[60:63], v[16:19], v[140:143]
    ds_read_b64_tr_b16 v[92:93], v243 offset:16384
    s_waitcnt lgkmcnt(10)
    v_mfma_f32_16x16x32_bf16 v[172:175], v[60:63], v[20:23], v[172:175]
    ds_read_b64_tr_b16 v[94:95], v243 offset:20480
    v_mfma_f32_16x16x32_bf16 v[168:171], v[56:59], v[20:23], v[168:171]
    ds_read_b64_tr_b16 v[96:97], v244 offset:16384
    v_mfma_f32_16x16x32_bf16 v[164:167], v[52:55], v[20:23], v[164:167]
    ds_read_b64_tr_b16 v[98:99], v244 offset:20480
    v_mfma_f32_16x16x32_bf16 v[160:163], v[48:51], v[20:23], v[160:163]
    ds_read_b64_tr_b16 v[100:101], v245 offset:16384
    v_mfma_f32_16x16x32_bf16 v[156:159], v[44:47], v[20:23], v[156:159]
    ds_read_b64_tr_b16 v[102:103], v245 offset:20480
    v_mfma_f32_16x16x32_bf16 v[152:155], v[40:43], v[20:23], v[152:155]
    ds_read_b64_tr_b16 v[104:105], v246 offset:16384
    v_mfma_f32_16x16x32_bf16 v[148:151], v[36:39], v[20:23], v[148:151]
    ds_read_b64_tr_b16 v[106:107], v246 offset:20480
    v_mfma_f32_16x16x32_bf16 v[144:147], v[32:35], v[20:23], v[144:147]
    ds_read_b64_tr_b16 v[108:109], v247 offset:16384
    s_waitcnt lgkmcnt(15)
    v_mfma_f32_16x16x32_bf16 v[176:179], v[32:35], v[24:27], v[176:179]
    ds_read_b64_tr_b16 v[110:111], v247 offset:20480
    v_mfma_f32_16x16x32_bf16 v[180:183], v[36:39], v[24:27], v[180:183]
    ds_read_b128 v[68:71], v8 offset:2304
    v_mfma_f32_16x16x32_bf16 v[184:187], v[40:43], v[24:27], v[184:187]
    ds_read_b128 v[72:75], v8 offset:6144
    v_mfma_f32_16x16x32_bf16 v[188:191], v[44:47], v[24:27], v[188:191]
    ds_read_b128 v[76:79], v8 offset:6400
    s_add_u32 s22, s22, 49152
    s_cmp_eq_u32 s22, 147456
    s_cselect_b32 s22, 0, s22
    s_cselect_b32 s21, s51, 49152
    v_mfma_f32_16x16x32_bf16 v[192:195], v[48:51], v[24:27], v[192:195]
    v_add_u32 v3, s22, v3
    v_add_u32 v4, s22, v4
    v_mfma_f32_16x16x32_bf16 v[196:199], v[52:55], v[24:27], v[196:199]
    v_add_u32 v5, s22, v5
    v_add_u32 v6, s22, v6
    v_mfma_f32_16x16x32_bf16 v[200:203], v[56:59], v[24:27], v[200:203]
    v_add_u32 v7, s22, v7
    v_mfma_f32_16x16x32_bf16 v[204:207], v[60:63], v[24:27], v[204:207]
    s_waitcnt lgkmcnt(15)
    v_mfma_f32_16x16x32_bf16 v[236:239], v[60:63], v[28:31], v[236:239]
    v_mfma_f32_16x16x32_bf16 v[232:235], v[56:59], v[28:31], v[232:235]
    v_mfma_f32_16x16x32_bf16 v[228:231], v[52:55], v[28:31], v[228:231]
    v_mfma_f32_16x16x32_bf16 v[224:227], v[48:51], v[28:31], v[224:227]
    v_mfma_f32_16x16x32_bf16 v[220:223], v[44:47], v[28:31], v[220:223]
    v_mfma_f32_16x16x32_bf16 v[216:219], v[40:43], v[28:31], v[216:219]
    v_mfma_f32_16x16x32_bf16 v[212:215], v[36:39], v[28:31], v[212:215]
    v_mfma_f32_16x16x32_bf16 v[208:211], v[32:35], v[28:31], v[208:211]
    s_waitcnt vmcnt(63) lgkmcnt(0)
    s_barrier
    v_mfma_f32_16x16x32_bf16 v[112:115], v[80:83], v[64:67], v[112:115]
    ds_read_b128 v[16:19], v3 offset:0
    v_mfma_f32_16x16x32_bf16 v[116:119], v[84:87], v[64:67], v[116:119]
    ds_read_b64_tr_b16 v[48:49], v4 offset:0
    v_mfma_f32_16x16x32_bf16 v[120:123], v[88:91], v[64:67], v[120:123]
    ds_read_b64_tr_b16 v[50:51], v4 offset:4096
    v_mfma_f32_16x16x32_bf16 v[124:127], v[92:95], v[64:67], v[124:127]
    ds_read_b64_tr_b16 v[52:53], v5 offset:0
    v_mfma_f32_16x16x32_bf16 v[128:131], v[96:99], v[64:67], v[128:131]
    ds_read_b64_tr_b16 v[54:55], v5 offset:4096
    v_mfma_f32_16x16x32_bf16 v[132:135], v[100:103], v[64:67], v[132:135]
    ds_read_b64_tr_b16 v[56:57], v6 offset:0
    v_mfma_f32_16x16x32_bf16 v[136:139], v[104:107], v[64:67], v[136:139]
    ds_read_b64_tr_b16 v[58:59], v6 offset:4096
    v_mfma_f32_16x16x32_bf16 v[140:143], v[108:111], v[64:67], v[140:143]
    ds_read_b64_tr_b16 v[60:61], v7 offset:0
    v_mfma_f32_16x16x32_bf16 v[172:175], v[108:111], v[68:71], v[172:175]
    ds_read_b64_tr_b16 v[62:63], v7 offset:4096
    v_mfma_f32_16x16x32_bf16 v[168:171], v[104:107], v[68:71], v[168:171]
    ds_read_b128 v[20:23], v3 offset:256
    v_mfma_f32_16x16x32_bf16 v[164:167], v[100:103], v[68:71], v[164:167]
    ds_read_b128 v[24:27], v3 offset:4096
    v_mfma_f32_16x16x32_bf16 v[160:163], v[96:99], v[68:71], v[160:163]
    ds_read_b128 v[28:31], v3 offset:4352
    v_mfma_f32_16x16x32_bf16 v[156:159], v[92:95], v[68:71], v[156:159]
    ds_read_b128 v[32:35], v3 offset:8192
    v_mfma_f32_16x16x32_bf16 v[152:155], v[88:91], v[68:71], v[152:155]
    ds_read_b128 v[36:39], v3 offset:8448
    v_mfma_f32_16x16x32_bf16 v[148:151], v[84:87], v[68:71], v[148:151]
    ds_read_b128 v[40:43], v3 offset:12288
    v_mfma_f32_16x16x32_bf16 v[144:147], v[80:83], v[68:71], v[144:147]
    ds_read_b128 v[44:47], v3 offset:12544
    v_mfma_f32_16x16x32_bf16 v[176:179], v[80:83], v[72:75], v[176:179]
    v_mfma_f32_16x16x32_bf16 v[180:183], v[84:87], v[72:75], v[180:183]
    v_mfma_f32_16x16x32_bf16 v[184:187], v[88:91], v[72:75], v[184:187]
    v_mfma_f32_16x16x32_bf16 v[188:191], v[92:95], v[72:75], v[188:191]
    v_mfma_f32_16x16x32_bf16 v[192:195], v[96:99], v[72:75], v[192:195]
    v_mfma_f32_16x16x32_bf16 v[196:199], v[100:103], v[72:75], v[196:199]
    v_mfma_f32_16x16x32_bf16 v[200:203], v[104:107], v[72:75], v[200:203]
    v_mfma_f32_16x16x32_bf16 v[204:207], v[108:111], v[72:75], v[204:207]
    v_mfma_f32_16x16x32_bf16 v[236:239], v[108:111], v[76:79], v[236:239]
    v_mfma_f32_16x16x32_bf16 v[232:235], v[104:107], v[76:79], v[232:235]
    v_mfma_f32_16x16x32_bf16 v[228:231], v[100:103], v[76:79], v[228:231]
    v_mfma_f32_16x16x32_bf16 v[224:227], v[96:99], v[76:79], v[224:227]
    v_mfma_f32_16x16x32_bf16 v[220:223], v[92:95], v[76:79], v[220:223]
    v_mfma_f32_16x16x32_bf16 v[216:219], v[88:91], v[76:79], v[216:219]
    v_mfma_f32_16x16x32_bf16 v[212:215], v[84:87], v[76:79], v[212:215]
    v_mfma_f32_16x16x32_bf16 v[208:211], v[80:83], v[76:79], v[208:211]
    s_and_b32 s40, s60, 1
    s_add_u32 s49, s60, 1
    s_lshr_b32 s49, s49, 1
    s_cmp_lg_u32 s40, 0
    s_cbranch_scc1 L_parallel_sum__sliding_block__mixer_token_mlp__prompt_kernel_cl_b
L_parallel_sum__sliding_block__mixer_token_mlp__prompt_kernel_cl_a:
    s_waitcnt lgkmcnt(13)
    v_mfma_f32_16x16x32_bf16 v[112:115], v[16:19], v[48:51], v[112:115]
    ds_read_b128 v[64:67], v3 offset:2048
    s_waitcnt lgkmcnt(12)
    v_mfma_f32_16x16x32_bf16 v[144:147], v[16:19], v[52:55], v[144:147]
    ds_read_b64_tr_b16 v[96:97], v4 offset:8192
    s_waitcnt lgkmcnt(11)
    v_mfma_f32_16x16x32_bf16 v[176:179], v[16:19], v[56:59], v[176:179]
    ds_read_b64_tr_b16 v[98:99], v4 offset:12288
    s_waitcnt lgkmcnt(10)
    v_mfma_f32_16x16x32_bf16 v[208:211], v[16:19], v[60:63], v[208:211]
    ds_read_b64_tr_b16 v[100:101], v5 offset:8192
    s_waitcnt lgkmcnt(10)
    v_mfma_f32_16x16x32_bf16 v[212:215], v[20:23], v[60:63], v[212:215]
    ds_read_b64_tr_b16 v[102:103], v5 offset:12288
    v_mfma_f32_16x16x32_bf16 v[180:183], v[20:23], v[56:59], v[180:183]
    ds_read_b64_tr_b16 v[104:105], v6 offset:8192
    v_mfma_f32_16x16x32_bf16 v[148:151], v[20:23], v[52:55], v[148:151]
    ds_read_b64_tr_b16 v[106:107], v6 offset:12288
    v_mfma_f32_16x16x32_bf16 v[116:119], v[20:23], v[48:51], v[116:119]
    ds_read_b64_tr_b16 v[108:109], v7 offset:8192
    s_waitcnt lgkmcnt(13)
    v_mfma_f32_16x16x32_bf16 v[120:123], v[24:27], v[48:51], v[120:123]
    ds_read_b64_tr_b16 v[110:111], v7 offset:12288
    v_mfma_f32_16x16x32_bf16 v[152:155], v[24:27], v[52:55], v[152:155]
    ds_read_b128 v[68:71], v3 offset:2304
    v_mfma_f32_16x16x32_bf16 v[184:187], v[24:27], v[56:59], v[184:187]
    ds_read_b128 v[72:75], v3 offset:6144
    v_mfma_f32_16x16x32_bf16 v[216:219], v[24:27], v[60:63], v[216:219]
    ds_read_b128 v[76:79], v3 offset:6400
    s_waitcnt lgkmcnt(15)
    v_mfma_f32_16x16x32_bf16 v[220:223], v[28:31], v[60:63], v[220:223]
    ds_read_b128 v[80:83], v3 offset:10240
    v_mfma_f32_16x16x32_bf16 v[188:191], v[28:31], v[56:59], v[188:191]
    ds_read_b128 v[84:87], v3 offset:10496
    v_mfma_f32_16x16x32_bf16 v[156:159], v[28:31], v[52:55], v[156:159]
    ds_read_b128 v[88:91], v3 offset:14336
    v_mfma_f32_16x16x32_bf16 v[124:127], v[28:31], v[48:51], v[124:127]
    ds_read_b128 v[92:95], v3 offset:14592
    s_add_u32 s22, s22, 49152
    s_cmp_eq_u32 s22, 147456
    s_cselect_b32 s22, 0, s22
    s_cselect_b32 s21, s51, 49152
    s_waitcnt lgkmcnt(15)
    v_mfma_f32_16x16x32_bf16 v[128:131], v[32:35], v[48:51], v[128:131]
    v_add_u32 v3, s21, v3
    v_add_u32 v4, s21, v4
    v_mfma_f32_16x16x32_bf16 v[160:163], v[32:35], v[52:55], v[160:163]
    v_add_u32 v5, s21, v5
    v_add_u32 v6, s21, v6
    v_mfma_f32_16x16x32_bf16 v[192:195], v[32:35], v[56:59], v[192:195]
    v_add_u32 v7, s21, v7
    v_mfma_f32_16x16x32_bf16 v[224:227], v[32:35], v[60:63], v[224:227]
    s_waitcnt lgkmcnt(15)
    v_mfma_f32_16x16x32_bf16 v[228:231], v[36:39], v[60:63], v[228:231]
    v_mfma_f32_16x16x32_bf16 v[196:199], v[36:39], v[56:59], v[196:199]
    v_mfma_f32_16x16x32_bf16 v[164:167], v[36:39], v[52:55], v[164:167]
    v_mfma_f32_16x16x32_bf16 v[132:135], v[36:39], v[48:51], v[132:135]
    s_waitcnt lgkmcnt(15)
    v_mfma_f32_16x16x32_bf16 v[136:139], v[40:43], v[48:51], v[136:139]
    v_mfma_f32_16x16x32_bf16 v[168:171], v[40:43], v[52:55], v[168:171]
    v_mfma_f32_16x16x32_bf16 v[200:203], v[40:43], v[56:59], v[200:203]
    v_mfma_f32_16x16x32_bf16 v[232:235], v[40:43], v[60:63], v[232:235]
    s_waitcnt lgkmcnt(15)
    v_mfma_f32_16x16x32_bf16 v[236:239], v[44:47], v[60:63], v[236:239]
    v_mfma_f32_16x16x32_bf16 v[204:207], v[44:47], v[56:59], v[204:207]
    v_mfma_f32_16x16x32_bf16 v[172:175], v[44:47], v[52:55], v[172:175]
    v_mfma_f32_16x16x32_bf16 v[140:143], v[44:47], v[48:51], v[140:143]
    s_waitcnt vmcnt(63) lgkmcnt(0)
    s_barrier
    v_mfma_f32_16x16x32_bf16 v[112:115], v[64:67], v[96:99], v[112:115]
    ds_read_b128 v[16:19], v3 offset:0
    v_mfma_f32_16x16x32_bf16 v[144:147], v[64:67], v[100:103], v[144:147]
    ds_read_b64_tr_b16 v[48:49], v4 offset:0
    v_mfma_f32_16x16x32_bf16 v[176:179], v[64:67], v[104:107], v[176:179]
    ds_read_b64_tr_b16 v[50:51], v4 offset:4096
    v_mfma_f32_16x16x32_bf16 v[208:211], v[64:67], v[108:111], v[208:211]
    ds_read_b64_tr_b16 v[52:53], v5 offset:0
    v_mfma_f32_16x16x32_bf16 v[212:215], v[68:71], v[108:111], v[212:215]
    ds_read_b64_tr_b16 v[54:55], v5 offset:4096
    v_mfma_f32_16x16x32_bf16 v[180:183], v[68:71], v[104:107], v[180:183]
    ds_read_b64_tr_b16 v[56:57], v6 offset:0
    v_mfma_f32_16x16x32_bf16 v[148:151], v[68:71], v[100:103], v[148:151]
    ds_read_b64_tr_b16 v[58:59], v6 offset:4096
    v_mfma_f32_16x16x32_bf16 v[116:119], v[68:71], v[96:99], v[116:119]
    ds_read_b64_tr_b16 v[60:61], v7 offset:0
    v_mfma_f32_16x16x32_bf16 v[120:123], v[72:75], v[96:99], v[120:123]
    ds_read_b64_tr_b16 v[62:63], v7 offset:4096
    v_mfma_f32_16x16x32_bf16 v[152:155], v[72:75], v[100:103], v[152:155]
    ds_read_b128 v[20:23], v3 offset:256
    v_mfma_f32_16x16x32_bf16 v[184:187], v[72:75], v[104:107], v[184:187]
    ds_read_b128 v[24:27], v3 offset:4096
    v_mfma_f32_16x16x32_bf16 v[216:219], v[72:75], v[108:111], v[216:219]
    ds_read_b128 v[28:31], v3 offset:4352
    v_mfma_f32_16x16x32_bf16 v[220:223], v[76:79], v[108:111], v[220:223]
    ds_read_b128 v[32:35], v3 offset:8192
    v_mfma_f32_16x16x32_bf16 v[188:191], v[76:79], v[104:107], v[188:191]
    ds_read_b128 v[36:39], v3 offset:8448
    v_mfma_f32_16x16x32_bf16 v[156:159], v[76:79], v[100:103], v[156:159]
    ds_read_b128 v[40:43], v3 offset:12288
    v_mfma_f32_16x16x32_bf16 v[124:127], v[76:79], v[96:99], v[124:127]
    ds_read_b128 v[44:47], v3 offset:12544
    v_mfma_f32_16x16x32_bf16 v[128:131], v[80:83], v[96:99], v[128:131]
    v_mfma_f32_16x16x32_bf16 v[160:163], v[80:83], v[100:103], v[160:163]
    v_mfma_f32_16x16x32_bf16 v[192:195], v[80:83], v[104:107], v[192:195]
    v_mfma_f32_16x16x32_bf16 v[224:227], v[80:83], v[108:111], v[224:227]
    v_mfma_f32_16x16x32_bf16 v[228:231], v[84:87], v[108:111], v[228:231]
    v_mfma_f32_16x16x32_bf16 v[196:199], v[84:87], v[104:107], v[196:199]
    v_mfma_f32_16x16x32_bf16 v[164:167], v[84:87], v[100:103], v[164:167]
    v_mfma_f32_16x16x32_bf16 v[132:135], v[84:87], v[96:99], v[132:135]
    v_mfma_f32_16x16x32_bf16 v[136:139], v[88:91], v[96:99], v[136:139]
    v_mfma_f32_16x16x32_bf16 v[168:171], v[88:91], v[100:103], v[168:171]
    v_mfma_f32_16x16x32_bf16 v[200:203], v[88:91], v[104:107], v[200:203]
    v_mfma_f32_16x16x32_bf16 v[232:235], v[88:91], v[108:111], v[232:235]
    v_mfma_f32_16x16x32_bf16 v[236:239], v[92:95], v[108:111], v[236:239]
    v_mfma_f32_16x16x32_bf16 v[204:207], v[92:95], v[104:107], v[204:207]
    v_mfma_f32_16x16x32_bf16 v[172:175], v[92:95], v[100:103], v[172:175]
    v_mfma_f32_16x16x32_bf16 v[140:143], v[92:95], v[96:99], v[140:143]
L_parallel_sum__sliding_block__mixer_token_mlp__prompt_kernel_cl_b:
    s_waitcnt lgkmcnt(13)
    v_mfma_f32_16x16x32_bf16 v[112:115], v[16:19], v[48:51], v[112:115]
    ds_read_b128 v[64:67], v3 offset:2048
    s_waitcnt lgkmcnt(12)
    v_mfma_f32_16x16x32_bf16 v[144:147], v[16:19], v[52:55], v[144:147]
    ds_read_b64_tr_b16 v[96:97], v4 offset:8192
    s_waitcnt lgkmcnt(11)
    v_mfma_f32_16x16x32_bf16 v[176:179], v[16:19], v[56:59], v[176:179]
    ds_read_b64_tr_b16 v[98:99], v4 offset:12288
    s_waitcnt lgkmcnt(10)
    v_mfma_f32_16x16x32_bf16 v[208:211], v[16:19], v[60:63], v[208:211]
    ds_read_b64_tr_b16 v[100:101], v5 offset:8192
    s_waitcnt lgkmcnt(10)
    v_mfma_f32_16x16x32_bf16 v[212:215], v[20:23], v[60:63], v[212:215]
    ds_read_b64_tr_b16 v[102:103], v5 offset:12288
    v_mfma_f32_16x16x32_bf16 v[180:183], v[20:23], v[56:59], v[180:183]
    ds_read_b64_tr_b16 v[104:105], v6 offset:8192
    v_mfma_f32_16x16x32_bf16 v[148:151], v[20:23], v[52:55], v[148:151]
    ds_read_b64_tr_b16 v[106:107], v6 offset:12288
    v_mfma_f32_16x16x32_bf16 v[116:119], v[20:23], v[48:51], v[116:119]
    ds_read_b64_tr_b16 v[108:109], v7 offset:8192
    s_waitcnt lgkmcnt(13)
    v_mfma_f32_16x16x32_bf16 v[120:123], v[24:27], v[48:51], v[120:123]
    ds_read_b64_tr_b16 v[110:111], v7 offset:12288
    v_mfma_f32_16x16x32_bf16 v[152:155], v[24:27], v[52:55], v[152:155]
    ds_read_b128 v[68:71], v3 offset:2304
    v_mfma_f32_16x16x32_bf16 v[184:187], v[24:27], v[56:59], v[184:187]
    ds_read_b128 v[72:75], v3 offset:6144
    v_mfma_f32_16x16x32_bf16 v[216:219], v[24:27], v[60:63], v[216:219]
    ds_read_b128 v[76:79], v3 offset:6400
    s_waitcnt lgkmcnt(15)
    v_mfma_f32_16x16x32_bf16 v[220:223], v[28:31], v[60:63], v[220:223]
    ds_read_b128 v[80:83], v3 offset:10240
    v_mfma_f32_16x16x32_bf16 v[188:191], v[28:31], v[56:59], v[188:191]
    ds_read_b128 v[84:87], v3 offset:10496
    v_mfma_f32_16x16x32_bf16 v[156:159], v[28:31], v[52:55], v[156:159]
    ds_read_b128 v[88:91], v3 offset:14336
    v_mfma_f32_16x16x32_bf16 v[124:127], v[28:31], v[48:51], v[124:127]
    ds_read_b128 v[92:95], v3 offset:14592
    s_add_u32 s22, s22, 49152
    s_cmp_eq_u32 s22, 147456
    s_cselect_b32 s22, 0, s22
    s_cselect_b32 s21, s51, 49152
    s_waitcnt lgkmcnt(15)
    v_mfma_f32_16x16x32_bf16 v[128:131], v[32:35], v[48:51], v[128:131]
    v_add_u32 v3, s21, v3
    v_add_u32 v4, s21, v4
    v_mfma_f32_16x16x32_bf16 v[160:163], v[32:35], v[52:55], v[160:163]
    v_add_u32 v5, s21, v5
    v_add_u32 v6, s21, v6
    v_mfma_f32_16x16x32_bf16 v[192:195], v[32:35], v[56:59], v[192:195]
    v_add_u32 v7, s21, v7
    v_mfma_f32_16x16x32_bf16 v[224:227], v[32:35], v[60:63], v[224:227]
    s_waitcnt lgkmcnt(15)
    v_mfma_f32_16x16x32_bf16 v[228:231], v[36:39], v[60:63], v[228:231]
    v_mfma_f32_16x16x32_bf16 v[196:199], v[36:39], v[56:59], v[196:199]
    v_mfma_f32_16x16x32_bf16 v[164:167], v[36:39], v[52:55], v[164:167]
    v_mfma_f32_16x16x32_bf16 v[132:135], v[36:39], v[48:51], v[132:135]
    s_waitcnt lgkmcnt(15)
    v_mfma_f32_16x16x32_bf16 v[136:139], v[40:43], v[48:51], v[136:139]
    v_mfma_f32_16x16x32_bf16 v[168:171], v[40:43], v[52:55], v[168:171]
    v_mfma_f32_16x16x32_bf16 v[200:203], v[40:43], v[56:59], v[200:203]
    v_mfma_f32_16x16x32_bf16 v[232:235], v[40:43], v[60:63], v[232:235]
    s_waitcnt lgkmcnt(15)
    v_mfma_f32_16x16x32_bf16 v[236:239], v[44:47], v[60:63], v[236:239]
    v_mfma_f32_16x16x32_bf16 v[204:207], v[44:47], v[56:59], v[204:207]
    v_mfma_f32_16x16x32_bf16 v[172:175], v[44:47], v[52:55], v[172:175]
    v_mfma_f32_16x16x32_bf16 v[140:143], v[44:47], v[48:51], v[140:143]
    s_waitcnt vmcnt(63) lgkmcnt(0)
    s_barrier
    v_mfma_f32_16x16x32_bf16 v[112:115], v[64:67], v[96:99], v[112:115]
    ds_read_b128 v[16:19], v3 offset:0
    v_mfma_f32_16x16x32_bf16 v[144:147], v[64:67], v[100:103], v[144:147]
    ds_read_b64_tr_b16 v[48:49], v4 offset:0
    v_mfma_f32_16x16x32_bf16 v[176:179], v[64:67], v[104:107], v[176:179]
    ds_read_b64_tr_b16 v[50:51], v4 offset:4096
    v_mfma_f32_16x16x32_bf16 v[208:211], v[64:67], v[108:111], v[208:211]
    ds_read_b64_tr_b16 v[52:53], v5 offset:0
    v_mfma_f32_16x16x32_bf16 v[212:215], v[68:71], v[108:111], v[212:215]
    ds_read_b64_tr_b16 v[54:55], v5 offset:4096
    v_mfma_f32_16x16x32_bf16 v[180:183], v[68:71], v[104:107], v[180:183]
    ds_read_b64_tr_b16 v[56:57], v6 offset:0
    v_mfma_f32_16x16x32_bf16 v[148:151], v[68:71], v[100:103], v[148:151]
    ds_read_b64_tr_b16 v[58:59], v6 offset:4096
    v_mfma_f32_16x16x32_bf16 v[116:119], v[68:71], v[96:99], v[116:119]
    ds_read_b64_tr_b16 v[60:61], v7 offset:0
    v_mfma_f32_16x16x32_bf16 v[120:123], v[72:75], v[96:99], v[120:123]
    ds_read_b64_tr_b16 v[62:63], v7 offset:4096
    v_mfma_f32_16x16x32_bf16 v[152:155], v[72:75], v[100:103], v[152:155]
    ds_read_b128 v[20:23], v3 offset:256
    v_mfma_f32_16x16x32_bf16 v[184:187], v[72:75], v[104:107], v[184:187]
    ds_read_b128 v[24:27], v3 offset:4096
    v_mfma_f32_16x16x32_bf16 v[216:219], v[72:75], v[108:111], v[216:219]
    ds_read_b128 v[28:31], v3 offset:4352
    v_mfma_f32_16x16x32_bf16 v[220:223], v[76:79], v[108:111], v[220:223]
    ds_read_b128 v[32:35], v3 offset:8192
    v_mfma_f32_16x16x32_bf16 v[188:191], v[76:79], v[104:107], v[188:191]
    ds_read_b128 v[36:39], v3 offset:8448
    v_mfma_f32_16x16x32_bf16 v[156:159], v[76:79], v[100:103], v[156:159]
    ds_read_b128 v[40:43], v3 offset:12288
    v_mfma_f32_16x16x32_bf16 v[124:127], v[76:79], v[96:99], v[124:127]
    ds_read_b128 v[44:47], v3 offset:12544
    v_mfma_f32_16x16x32_bf16 v[128:131], v[80:83], v[96:99], v[128:131]
    v_mfma_f32_16x16x32_bf16 v[160:163], v[80:83], v[100:103], v[160:163]
    v_mfma_f32_16x16x32_bf16 v[192:195], v[80:83], v[104:107], v[192:195]
    v_mfma_f32_16x16x32_bf16 v[224:227], v[80:83], v[108:111], v[224:227]
    v_mfma_f32_16x16x32_bf16 v[228:231], v[84:87], v[108:111], v[228:231]
    v_mfma_f32_16x16x32_bf16 v[196:199], v[84:87], v[104:107], v[196:199]
    v_mfma_f32_16x16x32_bf16 v[164:167], v[84:87], v[100:103], v[164:167]
    v_mfma_f32_16x16x32_bf16 v[132:135], v[84:87], v[96:99], v[132:135]
    v_mfma_f32_16x16x32_bf16 v[136:139], v[88:91], v[96:99], v[136:139]
    v_mfma_f32_16x16x32_bf16 v[168:171], v[88:91], v[100:103], v[168:171]
    v_mfma_f32_16x16x32_bf16 v[200:203], v[88:91], v[104:107], v[200:203]
    v_mfma_f32_16x16x32_bf16 v[232:235], v[88:91], v[108:111], v[232:235]
    v_mfma_f32_16x16x32_bf16 v[236:239], v[92:95], v[108:111], v[236:239]
    v_mfma_f32_16x16x32_bf16 v[204:207], v[92:95], v[104:107], v[204:207]
    v_mfma_f32_16x16x32_bf16 v[172:175], v[92:95], v[100:103], v[172:175]
    v_mfma_f32_16x16x32_bf16 v[140:143], v[92:95], v[96:99], v[140:143]
    s_sub_u32 s49, s49, 1
    s_cmp_lg_u32 s49, 0
    s_cbranch_scc1 L_parallel_sum__sliding_block__mixer_token_mlp__prompt_kernel_cl_a
    s_waitcnt lgkmcnt(0)
    s_nop 7
    s_lshl_b32 s41, s42, 22
    s_add_u32 s41, s41, s76
    v_cvt_pk_bf16_f32 v112, v112, v113
    v_cvt_pk_bf16_f32 v113, v114, v115
    v_cvt_pk_bf16_f32 v114, v116, v117
    v_cvt_pk_bf16_f32 v115, v118, v119
    buffer_store_dwordx4 v[112:115], v2, s[12:15], s41 offen offset:0 sc1
    v_cvt_pk_bf16_f32 v120, v120, v121
    v_cvt_pk_bf16_f32 v121, v122, v123
    v_cvt_pk_bf16_f32 v122, v124, v125
    v_cvt_pk_bf16_f32 v123, v126, v127
    buffer_store_dwordx4 v[120:123], v2, s[12:15], s41 offen offset:1024 sc1
    v_cvt_pk_bf16_f32 v128, v128, v129
    v_cvt_pk_bf16_f32 v129, v130, v131
    v_cvt_pk_bf16_f32 v130, v132, v133
    v_cvt_pk_bf16_f32 v131, v134, v135
    buffer_store_dwordx4 v[128:131], v2, s[12:15], s41 offen offset:2048 sc1
    v_cvt_pk_bf16_f32 v136, v136, v137
    v_cvt_pk_bf16_f32 v137, v138, v139
    v_cvt_pk_bf16_f32 v138, v140, v141
    v_cvt_pk_bf16_f32 v139, v142, v143
    buffer_store_dwordx4 v[136:139], v2, s[12:15], s41 offen offset:3072 sc1
    s_add_u32 s41, s41, 4096
    v_cvt_pk_bf16_f32 v144, v144, v145
    v_cvt_pk_bf16_f32 v145, v146, v147
    v_cvt_pk_bf16_f32 v146, v148, v149
    v_cvt_pk_bf16_f32 v147, v150, v151
    buffer_store_dwordx4 v[144:147], v2, s[12:15], s41 offen offset:0 sc1
    v_cvt_pk_bf16_f32 v152, v152, v153
    v_cvt_pk_bf16_f32 v153, v154, v155
    v_cvt_pk_bf16_f32 v154, v156, v157
    v_cvt_pk_bf16_f32 v155, v158, v159
    buffer_store_dwordx4 v[152:155], v2, s[12:15], s41 offen offset:1024 sc1
    v_cvt_pk_bf16_f32 v160, v160, v161
    v_cvt_pk_bf16_f32 v161, v162, v163
    v_cvt_pk_bf16_f32 v162, v164, v165
    v_cvt_pk_bf16_f32 v163, v166, v167
    buffer_store_dwordx4 v[160:163], v2, s[12:15], s41 offen offset:2048 sc1
    v_cvt_pk_bf16_f32 v168, v168, v169
    v_cvt_pk_bf16_f32 v169, v170, v171
    v_cvt_pk_bf16_f32 v170, v172, v173
    v_cvt_pk_bf16_f32 v171, v174, v175
    buffer_store_dwordx4 v[168:171], v2, s[12:15], s41 offen offset:3072 sc1
    s_add_u32 s41, s41, 4096
    v_cvt_pk_bf16_f32 v176, v176, v177
    v_cvt_pk_bf16_f32 v177, v178, v179
    v_cvt_pk_bf16_f32 v178, v180, v181
    v_cvt_pk_bf16_f32 v179, v182, v183
    buffer_store_dwordx4 v[176:179], v2, s[12:15], s41 offen offset:0 sc1
    v_cvt_pk_bf16_f32 v184, v184, v185
    v_cvt_pk_bf16_f32 v185, v186, v187
    v_cvt_pk_bf16_f32 v186, v188, v189
    v_cvt_pk_bf16_f32 v187, v190, v191
    buffer_store_dwordx4 v[184:187], v2, s[12:15], s41 offen offset:1024 sc1
    v_cvt_pk_bf16_f32 v192, v192, v193
    v_cvt_pk_bf16_f32 v193, v194, v195
    v_cvt_pk_bf16_f32 v194, v196, v197
    v_cvt_pk_bf16_f32 v195, v198, v199
    buffer_store_dwordx4 v[192:195], v2, s[12:15], s41 offen offset:2048 sc1
    v_cvt_pk_bf16_f32 v200, v200, v201
    v_cvt_pk_bf16_f32 v201, v202, v203
    v_cvt_pk_bf16_f32 v202, v204, v205
    v_cvt_pk_bf16_f32 v203, v206, v207
    buffer_store_dwordx4 v[200:203], v2, s[12:15], s41 offen offset:3072 sc1
    s_add_u32 s41, s41, 4096
    v_cvt_pk_bf16_f32 v208, v208, v209
    v_cvt_pk_bf16_f32 v209, v210, v211
    v_cvt_pk_bf16_f32 v210, v212, v213
    v_cvt_pk_bf16_f32 v211, v214, v215
    buffer_store_dwordx4 v[208:211], v2, s[12:15], s41 offen offset:0 sc1
    v_cvt_pk_bf16_f32 v216, v216, v217
    v_cvt_pk_bf16_f32 v217, v218, v219
    v_cvt_pk_bf16_f32 v218, v220, v221
    v_cvt_pk_bf16_f32 v219, v222, v223
    buffer_store_dwordx4 v[216:219], v2, s[12:15], s41 offen offset:1024 sc1
    v_cvt_pk_bf16_f32 v224, v224, v225
    v_cvt_pk_bf16_f32 v225, v226, v227
    v_cvt_pk_bf16_f32 v226, v228, v229
    v_cvt_pk_bf16_f32 v227, v230, v231
    buffer_store_dwordx4 v[224:227], v2, s[12:15], s41 offen offset:2048 sc1
    v_cvt_pk_bf16_f32 v232, v232, v233
    v_cvt_pk_bf16_f32 v233, v234, v235
    v_cvt_pk_bf16_f32 v234, v236, v237
    v_cvt_pk_bf16_f32 v235, v238, v239
    buffer_store_dwordx4 v[232:235], v2, s[12:15], s41 offen offset:3072 sc1
    v_mov_b32 v9, 1
    s_waitcnt vmcnt(0)
    s_mov_b64 exec, 1
    buffer_atomic_add v9, v10, s[64:67], s77 offen sc1
    s_mov_b64 exec, -1
    s_branch L_parallel_sum__sliding_block__mixer_token_mlp__prompt_kernel_done
L_parallel_sum__sliding_block__mixer_token_mlp__prompt_kernel_ld:
    s_waitcnt lgkmcnt(0)
    s_cmp_lg_u32 s62, 0
    s_cbranch_scc1 L_parallel_sum__sliding_block__mixer_token_mlp__prompt_kernel_llate
    v_lshlrev_b32 v2, 4, v1
    v_lshrrev_b32 v16, 4, v1
    v_and_b32 v17, 15, v1
    s_mul_i32 s27, s50, 16
    s_mov_b32 s3, 4096
    v_add_u32 v18, 0, v16
    v_add_u32 v19, s27, v18
    v_bfe_u32 v3, v19, 2, 1
    v_and_b32 v19, 3, v19
    v_lshlrev_b32 v19, 2, v19
    v_lshl_add_u32 v19, v3, 1, v19
    v_xor_b32 v19, v19, v17
    v_lshlrev_b32 v19, 4, v19
    v_mul_lo_u32 v18, v18, s3
    v_add_u32 v3, v18, v19
    v_add_u32 v18, 4, v16
    v_add_u32 v19, s27, v18
    v_bfe_u32 v4, v19, 2, 1
    v_and_b32 v19, 3, v19
    v_lshlrev_b32 v19, 2, v19
    v_lshl_add_u32 v19, v4, 1, v19
    v_xor_b32 v19, v19, v17
    v_lshlrev_b32 v19, 4, v19
    v_mul_lo_u32 v18, v18, s3
    v_add_u32 v4, v18, v19
    v_subrev_u32 v4, 1024, v4
    v_add_u32 v18, 8, v16
    v_add_u32 v19, s27, v18
    v_bfe_u32 v5, v19, 2, 1
    v_and_b32 v19, 3, v19
    v_lshlrev_b32 v19, 2, v19
    v_lshl_add_u32 v19, v5, 1, v19
    v_xor_b32 v19, v19, v17
    v_lshlrev_b32 v19, 4, v19
    v_mul_lo_u32 v18, v18, s3
    v_add_u32 v5, v18, v19
    v_subrev_u32 v5, 2048, v5
    v_add_u32 v18, 12, v16
    v_add_u32 v19, s27, v18
    v_bfe_u32 v6, v19, 2, 1
    v_and_b32 v19, 3, v19
    v_lshlrev_b32 v19, 2, v19
    v_lshl_add_u32 v19, v6, 1, v19
    v_xor_b32 v19, v19, v17
    v_lshlrev_b32 v19, 4, v19
    v_mul_lo_u32 v18, v18, s3
    v_add_u32 v6, v18, v19
    v_subrev_u32 v6, 3072, v6
    s_mul_i32 s19, s50, 8192
    s_mul_i32 s20, s50, 4096
    s_add_u32 s20, s20, 32768
    s_mov_b32 s8, s30
    s_and_b32 s9, s31, 0xffff
    s_mov_b32 s10, 14680064
    s_mov_b32 s11, 0x20000
    s_mul_i32 s18, s50, 65536
    s_lshl_b32 s40, s39, 8
    s_add_u32 s18, s18, s40
    s_lshl_b32 s40, s57, 18
    s_add_u32 s18, s18, s40
    s_mul_i32 s40, s38, 1835008
    s_lshl_b32 s43, s57, 15
    s_add_u32 s40, s40, s43
    s_add_u32 s40, s40, 20971520
    s_add_u32 s4, s28, s40
    s_addc_u32 s5, s29, 0
    s_and_b32 s5, s5, 0xffff
    s_mov_b32 s6, 0
    s_mov_b32 s7, 0x20000
    s_lshl_b32 s6, s60, 15
    s_lshl_b32 s17, s50, 13
    s_add_u32 m0, s20, 0
    s_nop 0
    buffer_load_dwordx4 v3, s[8:11], s18 offen offset:0 lds
    buffer_load_dwordx4 v4, s[8:11], s18 offen offset:1024 lds
    buffer_load_dwordx4 v5, s[8:11], s18 offen offset:2048 lds
    buffer_load_dwordx4 v6, s[8:11], s18 offen offset:3072 lds
    s_add_u32 s18, s18, 262144
    s_add_u32 m0, s20, 49152
    s_nop 0
    buffer_load_dwordx4 v3, s[8:11], s18 offen offset:0 lds
    buffer_load_dwordx4 v4, s[8:11], s18 offen offset:1024 lds
    buffer_load_dwordx4 v5, s[8:11], s18 offen offset:2048 lds
    buffer_load_dwordx4 v6, s[8:11], s18 offen offset:3072 lds
    s_add_u32 s18, s18, 262144
    s_add_u32 m0, s20, 98304
    s_nop 0
    buffer_load_dwordx4 v3, s[8:11], s18 offen offset:0 lds
    buffer_load_dwordx4 v4, s[8:11], s18 offen offset:1024 lds
    buffer_load_dwordx4 v5, s[8:11], s18 offen offset:2048 lds
    buffer_load_dwordx4 v6, s[8:11], s18 offen offset:3072 lds
    s_add_u32 s18, s18, 262144
    s_cmp_eq_u32 s63, -1
    s_cbranch_scc1 L_parallel_sum__sliding_block__mixer_token_mlp__prompt_kernel_lnosig
    s_waitcnt vmcnt(12)
    s_mov_b64 exec, 1
    v_mov_b32 v11, 159748
    v_mov_b32 v9, 1
    ds_add_rtn_u32 v9, v11, v9
    s_waitcnt lgkmcnt(0)
    v_readfirstlane_b32 s40, v9
    s_mov_b64 exec, -1
    v_mov_b32 v9, 1
    v_lshlrev_b32 v11, 8, v1
    s_cmp_lg_u32 s40, 7
    s_cbranch_scc1 L_parallel_sum__sliding_block__mixer_token_mlp__prompt_kernel_arr2
    s_mov_b64 exec, s[58:59]
    buffer_atomic_add v9, v11, s[64:67], s63 offen sc1
    s_mov_b64 exec, -1
L_parallel_sum__sliding_block__mixer_token_mlp__prompt_kernel_arr2:
L_parallel_sum__sliding_block__mixer_token_mlp__prompt_kernel_lnosig:
    s_barrier
    s_add_u32 m0, s19, 0
    s_nop 0
    buffer_load_dwordx4 v2, s[4:7], s17 offen offset:0 sc1 lds
    buffer_load_dwordx4 v2, s[4:7], s17 offen offset:1024 sc1 lds
    buffer_load_dwordx4 v2, s[4:7], s17 offen offset:2048 sc1 lds
    buffer_load_dwordx4 v2, s[4:7], s17 offen offset:3072 sc1 lds
    s_add_u32 m0, m0, 4096
    s_add_u32 s51, s17, 4096
    buffer_load_dwordx4 v2, s[4:7], s51 offen offset:0 sc1 lds
    buffer_load_dwordx4 v2, s[4:7], s51 offen offset:1024 sc1 lds
    buffer_load_dwordx4 v2, s[4:7], s51 offen offset:2048 sc1 lds
    buffer_load_dwordx4 v2, s[4:7], s51 offen offset:3072 sc1 lds
    s_add_u32 s17, s17, 32768
    s_add_u32 m0, s19, 49152
    s_nop 0
    buffer_load_dwordx4 v2, s[4:7], s17 offen offset:0 sc1 lds
    buffer_load_dwordx4 v2, s[4:7], s17 offen offset:1024 sc1 lds
    buffer_load_dwordx4 v2, s[4:7], s17 offen offset:2048 sc1 lds
    buffer_load_dwordx4 v2, s[4:7], s17 offen offset:3072 sc1 lds
    s_add_u32 m0, m0, 4096
    s_add_u32 s51, s17, 4096
    buffer_load_dwordx4 v2, s[4:7], s51 offen offset:0 sc1 lds
    buffer_load_dwordx4 v2, s[4:7], s51 offen offset:1024 sc1 lds
    buffer_load_dwordx4 v2, s[4:7], s51 offen offset:2048 sc1 lds
    buffer_load_dwordx4 v2, s[4:7], s51 offen offset:3072 sc1 lds
    s_add_u32 s17, s17, 32768
    s_add_u32 m0, s19, 98304
    s_nop 0
    buffer_load_dwordx4 v2, s[4:7], s17 offen offset:0 sc1 lds
    buffer_load_dwordx4 v2, s[4:7], s17 offen offset:1024 sc1 lds
    buffer_load_dwordx4 v2, s[4:7], s17 offen offset:2048 sc1 lds
    buffer_load_dwordx4 v2, s[4:7], s17 offen offset:3072 sc1 lds
    s_add_u32 m0, m0, 4096
    s_add_u32 s51, s17, 4096
    buffer_load_dwordx4 v2, s[4:7], s51 offen offset:0 sc1 lds
    buffer_load_dwordx4 v2, s[4:7], s51 offen offset:1024 sc1 lds
    buffer_load_dwordx4 v2, s[4:7], s51 offen offset:2048 sc1 lds
    buffer_load_dwordx4 v2, s[4:7], s51 offen offset:3072 sc1 lds
    s_add_u32 s17, s17, 32768
    s_mov_b32 s21, 0
    s_sub_u32 s23, s60, 4
    s_waitcnt vmcnt(16)
    s_barrier
    s_waitcnt vmcnt(8)
    s_barrier
    s_add_u32 m0, s20, s21
    s_nop 0
    buffer_load_dwordx4 v3, s[8:11], s18 offen offset:0 lds
    buffer_load_dwordx4 v4, s[8:11], s18 offen offset:1024 lds
    buffer_load_dwordx4 v5, s[8:11], s18 offen offset:2048 lds
    buffer_load_dwordx4 v6, s[8:11], s18 offen offset:3072 lds
    s_add_u32 s18, s18, 262144
    s_add_u32 m0, s19, s21
    s_nop 0
    buffer_load_dwordx4 v2, s[4:7], s17 offen offset:0 sc1 lds
    buffer_load_dwordx4 v2, s[4:7], s17 offen offset:1024 sc1 lds
    buffer_load_dwordx4 v2, s[4:7], s17 offen offset:2048 sc1 lds
    buffer_load_dwordx4 v2, s[4:7], s17 offen offset:3072 sc1 lds
    s_add_u32 m0, m0, 4096
    s_add_u32 s51, s17, 4096
    buffer_load_dwordx4 v2, s[4:7], s51 offen offset:0 sc1 lds
    buffer_load_dwordx4 v2, s[4:7], s51 offen offset:1024 sc1 lds
    buffer_load_dwordx4 v2, s[4:7], s51 offen offset:2048 sc1 lds
    buffer_load_dwordx4 v2, s[4:7], s51 offen offset:3072 sc1 lds
    s_add_u32 s17, s17, 32768
    s_add_u32 s21, s21, 49152
    s_cmp_eq_u32 s21, 147456
    s_cselect_b32 s21, 0, s21
L_parallel_sum__sliding_block__mixer_token_mlp__prompt_kernel_ll:
    s_waitcnt vmcnt(12)
    s_barrier
    s_add_u32 m0, s20, s21
    s_nop 0
    buffer_load_dwordx4 v3, s[8:11], s18 offen offset:0 lds
    buffer_load_dwordx4 v4, s[8:11], s18 offen offset:1024 lds
    buffer_load_dwordx4 v5, s[8:11], s18 offen offset:2048 lds
    buffer_load_dwordx4 v6, s[8:11], s18 offen offset:3072 lds
    s_add_u32 s18, s18, 262144
    s_add_u32 m0, s19, s21
    s_nop 0
    buffer_load_dwordx4 v2, s[4:7], s17 offen offset:0 sc1 lds
    buffer_load_dwordx4 v2, s[4:7], s17 offen offset:1024 sc1 lds
    buffer_load_dwordx4 v2, s[4:7], s17 offen offset:2048 sc1 lds
    buffer_load_dwordx4 v2, s[4:7], s17 offen offset:3072 sc1 lds
    s_add_u32 m0, m0, 4096
    s_add_u32 s51, s17, 4096
    buffer_load_dwordx4 v2, s[4:7], s51 offen offset:0 sc1 lds
    buffer_load_dwordx4 v2, s[4:7], s51 offen offset:1024 sc1 lds
    buffer_load_dwordx4 v2, s[4:7], s51 offen offset:2048 sc1 lds
    buffer_load_dwordx4 v2, s[4:7], s51 offen offset:3072 sc1 lds
    s_add_u32 s17, s17, 32768
    s_add_u32 s21, s21, 49152
    s_cmp_eq_u32 s21, 147456
    s_cselect_b32 s21, 0, s21
    s_sub_u32 s23, s23, 1
    s_cmp_lg_u32 s23, 0
    s_cbranch_scc1 L_parallel_sum__sliding_block__mixer_token_mlp__prompt_kernel_ll
    s_load_dwordx2 s[30:31], s[0:1], 56
    s_load_dwordx2 s[32:33], s[0:1], 0
    s_load_dwordx2 s[34:35], s[0:1], 64
    s_lshl_b32 s71, s39, 2
    s_lshl_b32 s41, s25, 1
    s_add_u32 s71, s71, s41
    s_add_u32 s71, s71, s56
    v_and_b32 v15, 15, v1
    v_lshlrev_b32 v14, 11, v15
    v_bfe_u32 v8, v1, 4, 1
    v_lshl_add_u32 v14, v8, 5, v14
    v_lshrrev_b32 v8, 5, v1
    v_lshl_add_u32 v14, v8, 4, v14
    v_lshlrev_b32 v15, 1, v15
    s_lshl_b32 s41, s71, 6
    s_lshl_b32 s71, s71, 16
    s_lshl_b32 s70, s38, 9
    s_add_u32 s70, s70, s71
    s_lshl_b32 s71, s24, 8
    s_add_u32 s70, s70, s71
    s_add_u32 s71, s70, 32768
    s_lshl_b32 s44, s56, 13
    s_add_u32 s44, s44, s76
    s_xor_b32 s46, s56, 1
    s_lshl_b32 s46, s46, 22
    s_add_u32 s46, s46, s44
    s_add_u32 s44, s44, 8388608
    s_lshl_b32 s40, s50, 14
    v_add_u32 v8, s40, v2
    s_mov_b32 s48, 0xffff0000
    s_waitcnt lgkmcnt(0)
    s_mov_b32 s72, s32
    s_and_b32 s73, s33, 0xffff
    s_mov_b32 s74, 4194304
    s_mov_b32 s75, 0x20000
    buffer_load_dwordx4 v[16:19], v14, s[72:75], s70 offen offset:0
    buffer_load_dwordx4 v[20:23], v14, s[72:75], s70 offen offset:64
    buffer_load_dwordx4 v[24:27], v14, s[72:75], s70 offen offset:128
    buffer_load_dwordx4 v[28:31], v14, s[72:75], s70 offen offset:192
    buffer_load_dwordx4 v[32:35], v14, s[72:75], s71 offen offset:0
    buffer_load_dwordx4 v[36:39], v14, s[72:75], s71 offen offset:64
    buffer_load_dwordx4 v[40:43], v14, s[72:75], s71 offen offset:128
    buffer_load_dwordx4 v[44:47], v14, s[72:75], s71 offen offset:192
    s_mov_b32 s72, s30
    s_and_b32 s73, s31, 0xffff
    s_mov_b32 s74, 4096
    s_mov_b32 s75, 0x20000
    buffer_load_ushort v12, v15, s[72:75], s41 offen
    buffer_load_ushort v13, v15, s[72:75], s41 offen offset:32
    s_mov_b32 s72, s34
    s_and_b32 s73, s35, 0xffff
    s_mov_b32 s74, 4194304
    s_mov_b32 s75, 0x20000
    s_waitcnt vmcnt(22)
    s_barrier
    s_waitcnt vmcnt(0)
    s_barrier
    v_lshlrev_b32 v12, 16, v12
    v_lshlrev_b32 v13, 16, v13
    v_lshlrev_b32 v144, 16, v16
    v_and_b32 v145, s48, v16
    v_lshlrev_b32 v146, 16, v17
    v_and_b32 v147, s48, v17
    v_lshlrev_b32 v148, 16, v18
    v_and_b32 v149, s48, v18
    v_lshlrev_b32 v150, 16, v19
    v_and_b32 v151, s48, v19
    v_lshlrev_b32 v152, 16, v20
    v_and_b32 v153, s48, v20
    v_lshlrev_b32 v154, 16, v21
    v_and_b32 v155, s48, v21
    v_lshlrev_b32 v156, 16, v22
    v_and_b32 v157, s48, v22
    v_lshlrev_b32 v158, 16, v23
    v_and_b32 v159, s48, v23
    v_lshlrev_b32 v160, 16, v24
    v_and_b32 v161, s48, v24
    v_lshlrev_b32 v162, 16, v25
    v_and_b32 v163, s48, v25
    v_lshlrev_b32 v164, 16, v26
    v_and_b32 v165, s48, v26
    v_lshlrev_b32 v166, 16, v27
    v_and_b32 v167, s48, v27
    v_lshlrev_b32 v168, 16, v28
    v_and_b32 v169, s48, v28
    v_lshlrev_b32 v170, 16, v29
    v_and_b32 v171, s48, v29
    v_lshlrev_b32 v172, 16, v30
    v_and_b32 v173, s48, v30
    v_lshlrev_b32 v174, 16, v31
    v_and_b32 v175, s48, v31
    v_lshlrev_b32 v176, 16, v32
    v_and_b32 v177, s48, v32
    v_lshlrev_b32 v178, 16, v33
    v_and_b32 v179, s48, v33
    v_lshlrev_b32 v180, 16, v34
    v_and_b32 v181, s48, v34
    v_lshlrev_b32 v182, 16, v35
    v_and_b32 v183, s48, v35
    v_lshlrev_b32 v184, 16, v36
    v_and_b32 v185, s48, v36
    v_lshlrev_b32 v186, 16, v37
    v_and_b32 v187, s48, v37
    v_lshlrev_b32 v188, 16, v38
    v_and_b32 v189, s48, v38
    v_lshlrev_b32 v190, 16, v39
    v_and_b32 v191, s48, v39
    v_lshlrev_b32 v192, 16, v40
    v_and_b32 v193, s48, v40
    v_lshlrev_b32 v194, 16, v41
    v_and_b32 v195, s48, v41
    v_lshlrev_b32 v196, 16, v42
    v_and_b32 v197, s48, v42
    v_lshlrev_b32 v198, 16, v43
    v_and_b32 v199, s48, v43
    v_lshlrev_b32 v200, 16, v44
    v_and_b32 v201, s48, v44
    v_lshlrev_b32 v202, 16, v45
    v_and_b32 v203, s48, v45
    v_lshlrev_b32 v204, 16, v46
    v_and_b32 v205, s48, v46
    v_lshlrev_b32 v206, 16, v47
    v_and_b32 v207, s48, v47
    v_add_f32 v144, v144, v12
    v_add_f32 v145, v145, v12
    v_add_f32 v146, v146, v12
    v_add_f32 v147, v147, v12
    v_add_f32 v148, v148, v12
    v_add_f32 v149, v149, v12
    v_add_f32 v150, v150, v12
    v_add_f32 v151, v151, v12
    v_add_f32 v152, v152, v12
    v_add_f32 v153, v153, v12
    v_add_f32 v154, v154, v12
    v_add_f32 v155, v155, v12
    v_add_f32 v156, v156, v12
    v_add_f32 v157, v157, v12
    v_add_f32 v158, v158, v12
    v_add_f32 v159, v159, v12
    v_add_f32 v160, v160, v12
    v_add_f32 v161, v161, v12
    v_add_f32 v162, v162, v12
    v_add_f32 v163, v163, v12
    v_add_f32 v164, v164, v12
    v_add_f32 v165, v165, v12
    v_add_f32 v166, v166, v12
    v_add_f32 v167, v167, v12
    v_add_f32 v168, v168, v12
    v_add_f32 v169, v169, v12
    v_add_f32 v170, v170, v12
    v_add_f32 v171, v171, v12
    v_add_f32 v172, v172, v12
    v_add_f32 v173, v173, v12
    v_add_f32 v174, v174, v12
    v_add_f32 v175, v175, v12
    v_add_f32 v176, v176, v13
    v_add_f32 v177, v177, v13
    v_add_f32 v178, v178, v13
    v_add_f32 v179, v179, v13
    v_add_f32 v180, v180, v13
    v_add_f32 v181, v181, v13
    v_add_f32 v182, v182, v13
    v_add_f32 v183, v183, v13
    v_add_f32 v184, v184, v13
    v_add_f32 v185, v185, v13
    v_add_f32 v186, v186, v13
    v_add_f32 v187, v187, v13
    v_add_f32 v188, v188, v13
    v_add_f32 v189, v189, v13
    v_add_f32 v190, v190, v13
    v_add_f32 v191, v191, v13
    v_add_f32 v192, v192, v13
    v_add_f32 v193, v193, v13
    v_add_f32 v194, v194, v13
    v_add_f32 v195, v195, v13
    v_add_f32 v196, v196, v13
    v_add_f32 v197, v197, v13
    v_add_f32 v198, v198, v13
    v_add_f32 v199, v199, v13
    v_add_f32 v200, v200, v13
    v_add_f32 v201, v201, v13
    v_add_f32 v202, v202, v13
    v_add_f32 v203, v203, v13
    v_add_f32 v204, v204, v13
    v_add_f32 v205, v205, v13
    v_add_f32 v206, v206, v13
    v_add_f32 v207, v207, v13
    v_permlane16_swap_b32 v144, v148
    v_permlane16_swap_b32 v145, v149
    v_permlane16_swap_b32 v146, v150
    v_permlane16_swap_b32 v147, v151
    v_permlane16_swap_b32 v152, v156
    v_permlane16_swap_b32 v153, v157
    v_permlane16_swap_b32 v154, v158
    v_permlane16_swap_b32 v155, v159
    v_permlane16_swap_b32 v160, v164
    v_permlane16_swap_b32 v161, v165
    v_permlane16_swap_b32 v162, v166
    v_permlane16_swap_b32 v163, v167
    v_permlane16_swap_b32 v168, v172
    v_permlane16_swap_b32 v169, v173
    v_permlane16_swap_b32 v170, v174
    v_permlane16_swap_b32 v171, v175
    v_permlane16_swap_b32 v176, v180
    v_permlane16_swap_b32 v177, v181
    v_permlane16_swap_b32 v178, v182
    v_permlane16_swap_b32 v179, v183
    v_permlane16_swap_b32 v184, v188
    v_permlane16_swap_b32 v185, v189
    v_permlane16_swap_b32 v186, v190
    v_permlane16_swap_b32 v187, v191
    v_permlane16_swap_b32 v192, v196
    v_permlane16_swap_b32 v193, v197
    v_permlane16_swap_b32 v194, v198
    v_permlane16_swap_b32 v195, v199
    v_permlane16_swap_b32 v200, v204
    v_permlane16_swap_b32 v201, v205
    v_permlane16_swap_b32 v202, v206
    v_permlane16_swap_b32 v203, v207
    s_barrier
    s_mov_b32 s41, 262144
L_parallel_sum__sliding_block__mixer_token_mlp__prompt_kernel_pa:
    buffer_load_dword v9, v10, s[64:67], s77 offen sc1
    s_waitcnt vmcnt(0)
    v_readfirstlane_b32 s40, v9
    s_nop 0
    s_cmp_ge_u32 s40, 2
    s_cbranch_scc1 L_parallel_sum__sliding_block__mixer_token_mlp__prompt_kernel_pa_ok
    s_sleep 1
    s_sub_u32 s41, s41, 1
    s_cmp_lg_u32 s41, 0
    s_cbranch_scc1 L_parallel_sum__sliding_block__mixer_token_mlp__prompt_kernel_pa
L_parallel_sum__sliding_block__mixer_token_mlp__prompt_kernel_pa_ok:
    s_add_u32 s47, s44, 4096
    buffer_load_dwordx4 v[48:51], v2, s[12:15], s44 offen offset:0 sc1
    buffer_load_dwordx4 v[52:55], v2, s[12:15], s44 offen offset:1024 sc1
    buffer_load_dwordx4 v[56:59], v2, s[12:15], s44 offen offset:2048 sc1
    buffer_load_dwordx4 v[60:63], v2, s[12:15], s44 offen offset:3072 sc1
    buffer_load_dwordx4 v[64:67], v2, s[12:15], s47 offen offset:0 sc1
    buffer_load_dwordx4 v[68:71], v2, s[12:15], s47 offen offset:1024 sc1
    buffer_load_dwordx4 v[72:75], v2, s[12:15], s47 offen offset:2048 sc1
    buffer_load_dwordx4 v[76:79], v2, s[12:15], s47 offen offset:3072 sc1
    s_add_u32 s44, s44, 4194304
    s_add_u32 s47, s44, 4096
    buffer_load_dwordx4 v[80:83], v2, s[12:15], s44 offen offset:0 sc1
    buffer_load_dwordx4 v[84:87], v2, s[12:15], s44 offen offset:1024 sc1
    buffer_load_dwordx4 v[88:91], v2, s[12:15], s44 offen offset:2048 sc1
    buffer_load_dwordx4 v[92:95], v2, s[12:15], s44 offen offset:3072 sc1
    buffer_load_dwordx4 v[96:99], v2, s[12:15], s47 offen offset:0 sc1
    buffer_load_dwordx4 v[100:103], v2, s[12:15], s47 offen offset:1024 sc1
    buffer_load_dwordx4 v[104:107], v2, s[12:15], s47 offen offset:2048 sc1
    buffer_load_dwordx4 v[108:111], v2, s[12:15], s47 offen offset:3072 sc1
    s_waitcnt vmcnt(8)
    v_lshlrev_b32 v4, 16, v48
    v_and_b32 v5, s48, v48
    v_add_f32 v144, v144, v4
    v_add_f32 v145, v145, v5
    v_lshlrev_b32 v6, 16, v49
    v_and_b32 v7, s48, v49
    v_add_f32 v146, v146, v6
    v_add_f32 v147, v147, v7
    v_lshlrev_b32 v4, 16, v50
    v_and_b32 v5, s48, v50
    v_add_f32 v148, v148, v4
    v_add_f32 v149, v149, v5
    v_lshlrev_b32 v6, 16, v51
    v_and_b32 v7, s48, v51
    v_add_f32 v150, v150, v6
    v_add_f32 v151, v151, v7
    v_lshlrev_b32 v4, 16, v52
    v_and_b32 v5, s48, v52
    v_add_f32 v152, v152, v4
    v_add_f32 v153, v153, v5
    v_lshlrev_b32 v6, 16, v53
    v_and_b32 v7, s48, v53
    v_add_f32 v154, v154, v6
    v_add_f32 v155, v155, v7
    v_lshlrev_b32 v4, 16, v54
    v_and_b32 v5, s48, v54
    v_add_f32 v156, v156, v4
    v_add_f32 v157, v157, v5
    v_lshlrev_b32 v6, 16, v55
    v_and_b32 v7, s48, v55
    v_add_f32 v158, v158, v6
    v_add_f32 v159, v159, v7
    v_lshlrev_b32 v4, 16, v56
    v_and_b32 v5, s48, v56
    v_add_f32 v160, v160, v4
    v_add_f32 v161, v161, v5
    v_lshlrev_b32 v6, 16, v57
    v_and_b32 v7, s48, v57
    v_add_f32 v162, v162, v6
    v_add_f32 v163, v163, v7
    v_lshlrev_b32 v4, 16, v58
    v_and_b32 v5, s48, v58
    v_add_f32 v164, v164, v4
    v_add_f32 v165, v165, v5
    v_lshlrev_b32 v6, 16, v59
    v_and_b32 v7, s48, v59
    v_add_f32 v166, v166, v6
    v_add_f32 v167, v167, v7
    v_lshlrev_b32 v4, 16, v60
    v_and_b32 v5, s48, v60
    v_add_f32 v168, v168, v4
    v_add_f32 v169, v169, v5
    v_lshlrev_b32 v6, 16, v61
    v_and_b32 v7, s48, v61
    v_add_f32 v170, v170, v6
    v_add_f32 v171, v171, v7
    v_lshlrev_b32 v4, 16, v62
    v_and_b32 v5, s48, v62
    v_add_f32 v172, v172, v4
    v_add_f32 v173, v173, v5
    v_lshlrev_b32 v6, 16, v63
    v_and_b32 v7, s48, v63
    v_add_f32 v174, v174, v6
    v_add_f32 v175, v175, v7
    v_lshlrev_b32 v4, 16, v64
    v_and_b32 v5, s48, v64
    v_add_f32 v176, v176, v4
    v_add_f32 v177, v177, v5
    v_lshlrev_b32 v6, 16, v65
    v_and_b32 v7, s48, v65
    v_add_f32 v178, v178, v6
    v_add_f32 v179, v179, v7
    v_lshlrev_b32 v4, 16, v66
    v_and_b32 v5, s48, v66
    v_add_f32 v180, v180, v4
    v_add_f32 v181, v181, v5
    v_lshlrev_b32 v6, 16, v67
    v_and_b32 v7, s48, v67
    v_add_f32 v182, v182, v6
    v_add_f32 v183, v183, v7
    v_lshlrev_b32 v4, 16, v68
    v_and_b32 v5, s48, v68
    v_add_f32 v184, v184, v4
    v_add_f32 v185, v185, v5
    v_lshlrev_b32 v6, 16, v69
    v_and_b32 v7, s48, v69
    v_add_f32 v186, v186, v6
    v_add_f32 v187, v187, v7
    v_lshlrev_b32 v4, 16, v70
    v_and_b32 v5, s48, v70
    v_add_f32 v188, v188, v4
    v_add_f32 v189, v189, v5
    v_lshlrev_b32 v6, 16, v71
    v_and_b32 v7, s48, v71
    v_add_f32 v190, v190, v6
    v_add_f32 v191, v191, v7
    v_lshlrev_b32 v4, 16, v72
    v_and_b32 v5, s48, v72
    v_add_f32 v192, v192, v4
    v_add_f32 v193, v193, v5
    v_lshlrev_b32 v6, 16, v73
    v_and_b32 v7, s48, v73
    v_add_f32 v194, v194, v6
    v_add_f32 v195, v195, v7
    v_lshlrev_b32 v4, 16, v74
    v_and_b32 v5, s48, v74
    v_add_f32 v196, v196, v4
    v_add_f32 v197, v197, v5
    v_lshlrev_b32 v6, 16, v75
    v_and_b32 v7, s48, v75
    v_add_f32 v198, v198, v6
    v_add_f32 v199, v199, v7
    v_lshlrev_b32 v4, 16, v76
    v_and_b32 v5, s48, v76
    v_add_f32 v200, v200, v4
    v_add_f32 v201, v201, v5
    v_lshlrev_b32 v6, 16, v77
    v_and_b32 v7, s48, v77
    v_add_f32 v202, v202, v6
    v_add_f32 v203, v203, v7
    v_lshlrev_b32 v4, 16, v78
    v_and_b32 v5, s48, v78
    v_add_f32 v204, v204, v4
    v_add_f32 v205, v205, v5
    v_lshlrev_b32 v6, 16, v79
    v_and_b32 v7, s48, v79
    v_add_f32 v206, v206, v6
    v_add_f32 v207, v207, v7
    s_waitcnt vmcnt(0)
    v_lshlrev_b32 v4, 16, v80
    v_and_b32 v5, s48, v80
    v_add_f32 v144, v144, v4
    v_add_f32 v145, v145, v5
    v_lshlrev_b32 v6, 16, v81
    v_and_b32 v7, s48, v81
    v_add_f32 v146, v146, v6
    v_add_f32 v147, v147, v7
    v_lshlrev_b32 v4, 16, v82
    v_and_b32 v5, s48, v82
    v_add_f32 v148, v148, v4
    v_add_f32 v149, v149, v5
    v_lshlrev_b32 v6, 16, v83
    v_and_b32 v7, s48, v83
    v_add_f32 v150, v150, v6
    v_add_f32 v151, v151, v7
    v_lshlrev_b32 v4, 16, v84
    v_and_b32 v5, s48, v84
    v_add_f32 v152, v152, v4
    v_add_f32 v153, v153, v5
    v_lshlrev_b32 v6, 16, v85
    v_and_b32 v7, s48, v85
    v_add_f32 v154, v154, v6
    v_add_f32 v155, v155, v7
    v_lshlrev_b32 v4, 16, v86
    v_and_b32 v5, s48, v86
    v_add_f32 v156, v156, v4
    v_add_f32 v157, v157, v5
    v_lshlrev_b32 v6, 16, v87
    v_and_b32 v7, s48, v87
    v_add_f32 v158, v158, v6
    v_add_f32 v159, v159, v7
    v_lshlrev_b32 v4, 16, v88
    v_and_b32 v5, s48, v88
    v_add_f32 v160, v160, v4
    v_add_f32 v161, v161, v5
    v_lshlrev_b32 v6, 16, v89
    v_and_b32 v7, s48, v89
    v_add_f32 v162, v162, v6
    v_add_f32 v163, v163, v7
    v_lshlrev_b32 v4, 16, v90
    v_and_b32 v5, s48, v90
    v_add_f32 v164, v164, v4
    v_add_f32 v165, v165, v5
    v_lshlrev_b32 v6, 16, v91
    v_and_b32 v7, s48, v91
    v_add_f32 v166, v166, v6
    v_add_f32 v167, v167, v7
    v_lshlrev_b32 v4, 16, v92
    v_and_b32 v5, s48, v92
    v_add_f32 v168, v168, v4
    v_add_f32 v169, v169, v5
    v_lshlrev_b32 v6, 16, v93
    v_and_b32 v7, s48, v93
    v_add_f32 v170, v170, v6
    v_add_f32 v171, v171, v7
    v_lshlrev_b32 v4, 16, v94
    v_and_b32 v5, s48, v94
    v_add_f32 v172, v172, v4
    v_add_f32 v173, v173, v5
    v_lshlrev_b32 v6, 16, v95
    v_and_b32 v7, s48, v95
    v_add_f32 v174, v174, v6
    v_add_f32 v175, v175, v7
    v_lshlrev_b32 v4, 16, v96
    v_and_b32 v5, s48, v96
    v_add_f32 v176, v176, v4
    v_add_f32 v177, v177, v5
    v_lshlrev_b32 v6, 16, v97
    v_and_b32 v7, s48, v97
    v_add_f32 v178, v178, v6
    v_add_f32 v179, v179, v7
    v_lshlrev_b32 v4, 16, v98
    v_and_b32 v5, s48, v98
    v_add_f32 v180, v180, v4
    v_add_f32 v181, v181, v5
    v_lshlrev_b32 v6, 16, v99
    v_and_b32 v7, s48, v99
    v_add_f32 v182, v182, v6
    v_add_f32 v183, v183, v7
    v_lshlrev_b32 v4, 16, v100
    v_and_b32 v5, s48, v100
    v_add_f32 v184, v184, v4
    v_add_f32 v185, v185, v5
    v_lshlrev_b32 v6, 16, v101
    v_and_b32 v7, s48, v101
    v_add_f32 v186, v186, v6
    v_add_f32 v187, v187, v7
    v_lshlrev_b32 v4, 16, v102
    v_and_b32 v5, s48, v102
    v_add_f32 v188, v188, v4
    v_add_f32 v189, v189, v5
    v_lshlrev_b32 v6, 16, v103
    v_and_b32 v7, s48, v103
    v_add_f32 v190, v190, v6
    v_add_f32 v191, v191, v7
    v_lshlrev_b32 v4, 16, v104
    v_and_b32 v5, s48, v104
    v_add_f32 v192, v192, v4
    v_add_f32 v193, v193, v5
    v_lshlrev_b32 v6, 16, v105
    v_and_b32 v7, s48, v105
    v_add_f32 v194, v194, v6
    v_add_f32 v195, v195, v7
    v_lshlrev_b32 v4, 16, v106
    v_and_b32 v5, s48, v106
    v_add_f32 v196, v196, v4
    v_add_f32 v197, v197, v5
    v_lshlrev_b32 v6, 16, v107
    v_and_b32 v7, s48, v107
    v_add_f32 v198, v198, v6
    v_add_f32 v199, v199, v7
    v_lshlrev_b32 v4, 16, v108
    v_and_b32 v5, s48, v108
    v_add_f32 v200, v200, v4
    v_add_f32 v201, v201, v5
    v_lshlrev_b32 v6, 16, v109
    v_and_b32 v7, s48, v109
    v_add_f32 v202, v202, v6
    v_add_f32 v203, v203, v7
    v_lshlrev_b32 v4, 16, v110
    v_and_b32 v5, s48, v110
    v_add_f32 v204, v204, v4
    v_add_f32 v205, v205, v5
    v_lshlrev_b32 v6, 16, v111
    v_and_b32 v7, s48, v111
    v_add_f32 v206, v206, v6
    v_add_f32 v207, v207, v7
    s_add_u32 s47, s46, 4096
    buffer_load_dwordx4 v[112:115], v2, s[12:15], s46 offen offset:0 sc1
    buffer_load_dwordx4 v[116:119], v2, s[12:15], s46 offen offset:1024 sc1
    buffer_load_dwordx4 v[120:123], v2, s[12:15], s46 offen offset:2048 sc1
    buffer_load_dwordx4 v[124:127], v2, s[12:15], s46 offen offset:3072 sc1
    buffer_load_dwordx4 v[128:131], v2, s[12:15], s47 offen offset:0 sc1
    buffer_load_dwordx4 v[132:135], v2, s[12:15], s47 offen offset:1024 sc1
    buffer_load_dwordx4 v[136:139], v2, s[12:15], s47 offen offset:2048 sc1
    buffer_load_dwordx4 v[140:143], v2, s[12:15], s47 offen offset:3072 sc1
    s_barrier
    ds_read_b128 v[48:51], v8 offset:0
    ds_read_b128 v[52:55], v8 offset:1024
    ds_read_b128 v[56:59], v8 offset:2048
    ds_read_b128 v[60:63], v8 offset:3072
    ds_read_b128 v[64:67], v8 offset:4096
    ds_read_b128 v[68:71], v8 offset:5120
    ds_read_b128 v[72:75], v8 offset:6144
    ds_read_b128 v[76:79], v8 offset:7168
    ds_read_b128 v[80:83], v8 offset:8192
    ds_read_b128 v[84:87], v8 offset:9216
    ds_read_b128 v[88:91], v8 offset:10240
    ds_read_b128 v[92:95], v8 offset:11264
    ds_read_b128 v[96:99], v8 offset:12288
    ds_read_b128 v[100:103], v8 offset:13312
    ds_read_b128 v[104:107], v8 offset:14336
    ds_read_b128 v[108:111], v8 offset:15360
    s_waitcnt lgkmcnt(15)
    v_add_f32 v144, v144, v48
    v_add_f32 v145, v145, v49
    v_add_f32 v146, v146, v50
    v_add_f32 v147, v147, v51
    s_waitcnt lgkmcnt(14)
    v_add_f32 v148, v148, v52
    v_add_f32 v149, v149, v53
    v_add_f32 v150, v150, v54
    v_add_f32 v151, v151, v55
    s_waitcnt lgkmcnt(13)
    v_add_f32 v152, v152, v56
    v_add_f32 v153, v153, v57
    v_add_f32 v154, v154, v58
    v_add_f32 v155, v155, v59
    s_waitcnt lgkmcnt(12)
    v_add_f32 v156, v156, v60
    v_add_f32 v157, v157, v61
    v_add_f32 v158, v158, v62
    v_add_f32 v159, v159, v63
    s_waitcnt lgkmcnt(11)
    v_add_f32 v160, v160, v64
    v_add_f32 v161, v161, v65
    v_add_f32 v162, v162, v66
    v_add_f32 v163, v163, v67
    s_waitcnt lgkmcnt(10)
    v_add_f32 v164, v164, v68
    v_add_f32 v165, v165, v69
    v_add_f32 v166, v166, v70
    v_add_f32 v167, v167, v71
    s_waitcnt lgkmcnt(9)
    v_add_f32 v168, v168, v72
    v_add_f32 v169, v169, v73
    v_add_f32 v170, v170, v74
    v_add_f32 v171, v171, v75
    s_waitcnt lgkmcnt(8)
    v_add_f32 v172, v172, v76
    v_add_f32 v173, v173, v77
    v_add_f32 v174, v174, v78
    v_add_f32 v175, v175, v79
    s_waitcnt lgkmcnt(7)
    v_add_f32 v176, v176, v80
    v_add_f32 v177, v177, v81
    v_add_f32 v178, v178, v82
    v_add_f32 v179, v179, v83
    s_waitcnt lgkmcnt(6)
    v_add_f32 v180, v180, v84
    v_add_f32 v181, v181, v85
    v_add_f32 v182, v182, v86
    v_add_f32 v183, v183, v87
    s_waitcnt lgkmcnt(5)
    v_add_f32 v184, v184, v88
    v_add_f32 v185, v185, v89
    v_add_f32 v186, v186, v90
    v_add_f32 v187, v187, v91
    s_waitcnt lgkmcnt(4)
    v_add_f32 v188, v188, v92
    v_add_f32 v189, v189, v93
    v_add_f32 v190, v190, v94
    v_add_f32 v191, v191, v95
    s_waitcnt lgkmcnt(3)
    v_add_f32 v192, v192, v96
    v_add_f32 v193, v193, v97
    v_add_f32 v194, v194, v98
    v_add_f32 v195, v195, v99
    s_waitcnt lgkmcnt(2)
    v_add_f32 v196, v196, v100
    v_add_f32 v197, v197, v101
    v_add_f32 v198, v198, v102
    v_add_f32 v199, v199, v103
    s_waitcnt lgkmcnt(1)
    v_add_f32 v200, v200, v104
    v_add_f32 v201, v201, v105
    v_add_f32 v202, v202, v106
    v_add_f32 v203, v203, v107
    s_waitcnt lgkmcnt(0)
    v_add_f32 v204, v204, v108
    v_add_f32 v205, v205, v109
    v_add_f32 v206, v206, v110
    v_add_f32 v207, v207, v111
    s_mov_b32 s41, 0x40000
L_parallel_sum__sliding_block__mixer_token_mlp__prompt_kernel_pz:
    s_waitcnt vmcnt(0)
    v_max3_u32 v4, v112, v113, v114
    v_max3_u32 v5, v115, v116, v117
    v_max3_u32 v4, v4, v118, v119
    v_max3_u32 v5, v5, v120, v121
    v_max3_u32 v4, v4, v122, v123
    v_max3_u32 v5, v5, v124, v125
    v_max3_u32 v4, v4, v126, v127
    v_max3_u32 v5, v5, v128, v129
    v_max3_u32 v4, v4, v130, v131
    v_max3_u32 v5, v5, v132, v133
    v_max3_u32 v4, v4, v134, v135
    v_max3_u32 v5, v5, v136, v137
    v_max3_u32 v4, v4, v138, v139
    v_max3_u32 v5, v5, v140, v141
    v_max3_u32 v4, v4, v142, v143
    v_max_u32 v4, v4, v5
    v_cmp_eq_u32 vcc, -1, v4
    s_sub_u32 s41, s41, 1
    s_cmp_eq_u32 s41, 0
    s_cbranch_scc1 L_parallel_sum__sliding_block__mixer_token_mlp__prompt_kernel_pz_ok
    s_cbranch_vccz L_parallel_sum__sliding_block__mixer_token_mlp__prompt_kernel_pz_ok
    s_add_u32 s47, s46, 4096
    buffer_load_dwordx4 v[112:115], v2, s[12:15], s46 offen offset:0 sc1
    buffer_load_dwordx4 v[116:119], v2, s[12:15], s46 offen offset:1024 sc1
    buffer_load_dwordx4 v[120:123], v2, s[12:15], s46 offen offset:2048 sc1
    buffer_load_dwordx4 v[124:127], v2, s[12:15], s46 offen offset:3072 sc1
    buffer_load_dwordx4 v[128:131], v2, s[12:15], s47 offen offset:0 sc1
    buffer_load_dwordx4 v[132:135], v2, s[12:15], s47 offen offset:1024 sc1
    buffer_load_dwordx4 v[136:139], v2, s[12:15], s47 offen offset:2048 sc1
    buffer_load_dwordx4 v[140:143], v2, s[12:15], s47 offen offset:3072 sc1
    s_branch L_parallel_sum__sliding_block__mixer_token_mlp__prompt_kernel_pz
L_parallel_sum__sliding_block__mixer_token_mlp__prompt_kernel_pz_ok:
    v_lshlrev_b32 v4, 16, v112
    v_and_b32 v5, s48, v112
    v_add_f32 v4, v144, v4
    v_add_f32 v5, v145, v5
    v_cvt_pk_bf16_f32 v16, v4, v5
    v_lshlrev_b32 v6, 16, v113
    v_and_b32 v7, s48, v113
    v_add_f32 v6, v146, v6
    v_add_f32 v7, v147, v7
    v_cvt_pk_bf16_f32 v17, v6, v7
    v_lshlrev_b32 v4, 16, v114
    v_and_b32 v5, s48, v114
    v_add_f32 v4, v148, v4
    v_add_f32 v5, v149, v5
    v_cvt_pk_bf16_f32 v18, v4, v5
    v_lshlrev_b32 v6, 16, v115
    v_and_b32 v7, s48, v115
    v_add_f32 v6, v150, v6
    v_add_f32 v7, v151, v7
    v_cvt_pk_bf16_f32 v19, v6, v7
    v_permlane16_swap_b32 v16, v18
    s_nop 0
    v_permlane16_swap_b32 v17, v19
    buffer_store_dwordx4 v[16:19], v14, s[72:75], s70 offen offset:0 sc1
    v_lshlrev_b32 v4, 16, v116
    v_and_b32 v5, s48, v116
    v_add_f32 v4, v152, v4
    v_add_f32 v5, v153, v5
    v_cvt_pk_bf16_f32 v20, v4, v5
    v_lshlrev_b32 v6, 16, v117
    v_and_b32 v7, s48, v117
    v_add_f32 v6, v154, v6
    v_add_f32 v7, v155, v7
    v_cvt_pk_bf16_f32 v21, v6, v7
    v_lshlrev_b32 v4, 16, v118
    v_and_b32 v5, s48, v118
    v_add_f32 v4, v156, v4
    v_add_f32 v5, v157, v5
    v_cvt_pk_bf16_f32 v22, v4, v5
    v_lshlrev_b32 v6, 16, v119
    v_and_b32 v7, s48, v119
    v_add_f32 v6, v158, v6
    v_add_f32 v7, v159, v7
    v_cvt_pk_bf16_f32 v23, v6, v7
    v_permlane16_swap_b32 v20, v22
    s_nop 0
    v_permlane16_swap_b32 v21, v23
    buffer_store_dwordx4 v[20:23], v14, s[72:75], s70 offen offset:64 sc1
    v_lshlrev_b32 v4, 16, v120
    v_and_b32 v5, s48, v120
    v_add_f32 v4, v160, v4
    v_add_f32 v5, v161, v5
    v_cvt_pk_bf16_f32 v24, v4, v5
    v_lshlrev_b32 v6, 16, v121
    v_and_b32 v7, s48, v121
    v_add_f32 v6, v162, v6
    v_add_f32 v7, v163, v7
    v_cvt_pk_bf16_f32 v25, v6, v7
    v_lshlrev_b32 v4, 16, v122
    v_and_b32 v5, s48, v122
    v_add_f32 v4, v164, v4
    v_add_f32 v5, v165, v5
    v_cvt_pk_bf16_f32 v26, v4, v5
    v_lshlrev_b32 v6, 16, v123
    v_and_b32 v7, s48, v123
    v_add_f32 v6, v166, v6
    v_add_f32 v7, v167, v7
    v_cvt_pk_bf16_f32 v27, v6, v7
    v_permlane16_swap_b32 v24, v26
    s_nop 0
    v_permlane16_swap_b32 v25, v27
    buffer_store_dwordx4 v[24:27], v14, s[72:75], s70 offen offset:128 sc1
    v_lshlrev_b32 v4, 16, v124
    v_and_b32 v5, s48, v124
    v_add_f32 v4, v168, v4
    v_add_f32 v5, v169, v5
    v_cvt_pk_bf16_f32 v28, v4, v5
    v_lshlrev_b32 v6, 16, v125
    v_and_b32 v7, s48, v125
    v_add_f32 v6, v170, v6
    v_add_f32 v7, v171, v7
    v_cvt_pk_bf16_f32 v29, v6, v7
    v_lshlrev_b32 v4, 16, v126
    v_and_b32 v5, s48, v126
    v_add_f32 v4, v172, v4
    v_add_f32 v5, v173, v5
    v_cvt_pk_bf16_f32 v30, v4, v5
    v_lshlrev_b32 v6, 16, v127
    v_and_b32 v7, s48, v127
    v_add_f32 v6, v174, v6
    v_add_f32 v7, v175, v7
    v_cvt_pk_bf16_f32 v31, v6, v7
    v_permlane16_swap_b32 v28, v30
    s_nop 0
    v_permlane16_swap_b32 v29, v31
    buffer_store_dwordx4 v[28:31], v14, s[72:75], s70 offen offset:192 sc1
    v_lshlrev_b32 v4, 16, v128
    v_and_b32 v5, s48, v128
    v_add_f32 v4, v176, v4
    v_add_f32 v5, v177, v5
    v_cvt_pk_bf16_f32 v32, v4, v5
    v_lshlrev_b32 v6, 16, v129
    v_and_b32 v7, s48, v129
    v_add_f32 v6, v178, v6
    v_add_f32 v7, v179, v7
    v_cvt_pk_bf16_f32 v33, v6, v7
    v_lshlrev_b32 v4, 16, v130
    v_and_b32 v5, s48, v130
    v_add_f32 v4, v180, v4
    v_add_f32 v5, v181, v5
    v_cvt_pk_bf16_f32 v34, v4, v5
    v_lshlrev_b32 v6, 16, v131
    v_and_b32 v7, s48, v131
    v_add_f32 v6, v182, v6
    v_add_f32 v7, v183, v7
    v_cvt_pk_bf16_f32 v35, v6, v7
    v_permlane16_swap_b32 v32, v34
    s_nop 0
    v_permlane16_swap_b32 v33, v35
    buffer_store_dwordx4 v[32:35], v14, s[72:75], s71 offen offset:0 sc1
    v_lshlrev_b32 v4, 16, v132
    v_and_b32 v5, s48, v132
    v_add_f32 v4, v184, v4
    v_add_f32 v5, v185, v5
    v_cvt_pk_bf16_f32 v36, v4, v5
    v_lshlrev_b32 v6, 16, v133
    v_and_b32 v7, s48, v133
    v_add_f32 v6, v186, v6
    v_add_f32 v7, v187, v7
    v_cvt_pk_bf16_f32 v37, v6, v7
    v_lshlrev_b32 v4, 16, v134
    v_and_b32 v5, s48, v134
    v_add_f32 v4, v188, v4
    v_add_f32 v5, v189, v5
    v_cvt_pk_bf16_f32 v38, v4, v5
    v_lshlrev_b32 v6, 16, v135
    v_and_b32 v7, s48, v135
    v_add_f32 v6, v190, v6
    v_add_f32 v7, v191, v7
    v_cvt_pk_bf16_f32 v39, v6, v7
    v_permlane16_swap_b32 v36, v38
    s_nop 0
    v_permlane16_swap_b32 v37, v39
    buffer_store_dwordx4 v[36:39], v14, s[72:75], s71 offen offset:64 sc1
    v_lshlrev_b32 v4, 16, v136
    v_and_b32 v5, s48, v136
    v_add_f32 v4, v192, v4
    v_add_f32 v5, v193, v5
    v_cvt_pk_bf16_f32 v40, v4, v5
    v_lshlrev_b32 v6, 16, v137
    v_and_b32 v7, s48, v137
    v_add_f32 v6, v194, v6
    v_add_f32 v7, v195, v7
    v_cvt_pk_bf16_f32 v41, v6, v7
    v_lshlrev_b32 v4, 16, v138
    v_and_b32 v5, s48, v138
    v_add_f32 v4, v196, v4
    v_add_f32 v5, v197, v5
    v_cvt_pk_bf16_f32 v42, v4, v5
    v_lshlrev_b32 v6, 16, v139
    v_and_b32 v7, s48, v139
    v_add_f32 v6, v198, v6
    v_add_f32 v7, v199, v7
    v_cvt_pk_bf16_f32 v43, v6, v7
    v_permlane16_swap_b32 v40, v42
    s_nop 0
    v_permlane16_swap_b32 v41, v43
    buffer_store_dwordx4 v[40:43], v14, s[72:75], s71 offen offset:128 sc1
    v_lshlrev_b32 v4, 16, v140
    v_and_b32 v5, s48, v140
    v_add_f32 v4, v200, v4
    v_add_f32 v5, v201, v5
    v_cvt_pk_bf16_f32 v44, v4, v5
    v_lshlrev_b32 v6, 16, v141
    v_and_b32 v7, s48, v141
    v_add_f32 v6, v202, v6
    v_add_f32 v7, v203, v7
    v_cvt_pk_bf16_f32 v45, v6, v7
    v_lshlrev_b32 v4, 16, v142
    v_and_b32 v5, s48, v142
    v_add_f32 v4, v204, v4
    v_add_f32 v5, v205, v5
    v_cvt_pk_bf16_f32 v46, v4, v5
    v_lshlrev_b32 v6, 16, v143
    v_and_b32 v7, s48, v143
    v_add_f32 v6, v206, v6
    v_add_f32 v7, v207, v7
    v_cvt_pk_bf16_f32 v47, v6, v7
    v_permlane16_swap_b32 v44, v46
    s_nop 0
    v_permlane16_swap_b32 v45, v47
    buffer_store_dwordx4 v[44:47], v14, s[72:75], s71 offen offset:192 sc1
    s_branch L_parallel_sum__sliding_block__mixer_token_mlp__prompt_kernel_done
L_parallel_sum__sliding_block__mixer_token_mlp__prompt_kernel_llate:
    v_lshlrev_b32 v2, 4, v1
    v_lshrrev_b32 v16, 5, v1
    v_and_b32 v17, 31, v1
    s_mul_i32 s27, s50, 8
    s_mov_b32 s3, 2048
    v_add_u32 v18, 0, v16
    v_add_u32 v19, s27, v18
    v_bfe_u32 v20, v19, 2, 1
    v_and_b32 v19, 3, v19
    v_lshlrev_b32 v19, 2, v19
    v_lshl_add_u32 v19, v20, 1, v19
    v_xor_b32 v19, v19, v17
    v_lshlrev_b32 v19, 4, v19
    v_mul_lo_u32 v18, v18, s3
    v_add_u32 v20, v18, v19
    v_add_u32 v18, 2, v16
    v_add_u32 v19, s27, v18
    v_bfe_u32 v21, v19, 2, 1
    v_and_b32 v19, 3, v19
    v_lshlrev_b32 v19, 2, v19
    v_lshl_add_u32 v19, v21, 1, v19
    v_xor_b32 v19, v19, v17
    v_lshlrev_b32 v19, 4, v19
    v_mul_lo_u32 v18, v18, s3
    v_add_u32 v21, v18, v19
    v_subrev_u32 v21, 1024, v21
    v_add_u32 v18, 4, v16
    v_add_u32 v19, s27, v18
    v_bfe_u32 v22, v19, 2, 1
    v_and_b32 v19, 3, v19
    v_lshlrev_b32 v19, 2, v19
    v_lshl_add_u32 v19, v22, 1, v19
    v_xor_b32 v19, v19, v17
    v_lshlrev_b32 v19, 4, v19
    v_mul_lo_u32 v18, v18, s3
    v_add_u32 v22, v18, v19
    v_subrev_u32 v22, 2048, v22
    v_add_u32 v18, 6, v16
    v_add_u32 v19, s27, v18
    v_bfe_u32 v23, v19, 2, 1
    v_and_b32 v19, 3, v19
    v_lshlrev_b32 v19, 2, v19
    v_lshl_add_u32 v19, v23, 1, v19
    v_xor_b32 v19, v19, v17
    v_lshlrev_b32 v19, 4, v19
    v_mul_lo_u32 v18, v18, s3
    v_add_u32 v23, v18, v19
    v_subrev_u32 v23, 3072, v23
    s_mul_i32 s54, s50, 4096
    s_mul_i32 s55, s50, 4096
    s_add_u32 s55, s55, 16384
    s_lshl_b32 s55, s50, 13
    s_add_u32 s55, s55, 16384
    s_mov_b32 s72, s32
    s_and_b32 s73, s33, 0xffff
    s_mov_b32 s74, 2097152
    s_mov_b32 s75, 0x20000
    s_mul_i32 s53, s50, 32768
    s_lshl_b32 s40, s38, 9
    s_add_u32 s53, s53, s40
    s_lshl_b32 s40, s56, 20
    s_add_u32 s53, s53, s40
    s_mov_b32 s70, 0
    s_mov_b32 s71, 0
    s_mov_b32 s48, 0
    v_and_b32 v24, 7, v1
    v_lshlrev_b32 v24, 7, v24
    s_andn2_b32 s49, s69, 7
    s_lshl_b32 s49, s49, 7
    s_add_u32 s49, s49, 49152
    s_xor_b32 s51, s70, s69
    s_and_b32 s51, s51, 7
    s_lshl_b32 s51, s51, 17
    s_add_u32 s51, s51, s53
    s_add_u32 m0, s55, 0
    s_nop 0
    buffer_load_dwordx4 v20, s[72:75], s51 offen offset:0 lds
    buffer_load_dwordx4 v21, s[72:75], s51 offen offset:1024 lds
    buffer_load_dwordx4 v22, s[72:75], s51 offen offset:2048 lds
    buffer_load_dwordx4 v23, s[72:75], s51 offen offset:3072 lds
    s_add_u32 m0, m0, 4096
    s_add_u32 s51, s51, 16384
    buffer_load_dwordx4 v20, s[72:75], s51 offen offset:0 lds
    buffer_load_dwordx4 v21, s[72:75], s51 offen offset:1024 lds
    buffer_load_dwordx4 v22, s[72:75], s51 offen offset:2048 lds
    buffer_load_dwordx4 v23, s[72:75], s51 offen offset:3072 lds
    s_add_u32 s70, s70, 1
    s_waitcnt vmcnt(8)
    s_mov_b64 exec, 1
    v_mov_b32 v11, 159748
    v_mov_b32 v9, 1
    ds_add_rtn_u32 v9, v11, v9
    s_waitcnt lgkmcnt(0)
    v_readfirstlane_b32 s40, v9
    s_mov_b64 exec, -1
    v_mov_b32 v9, 1
    v_lshlrev_b32 v11, 8, v1
    s_cmp_lg_u32 s40, 7
    s_cbranch_scc1 L_parallel_sum__sliding_block__mixer_token_mlp__prompt_kernel_arr3
    s_mov_b64 exec, s[58:59]
    buffer_atomic_add v9, v11, s[64:67], s63 offen sc1
    s_mov_b64 exec, -1
L_parallel_sum__sliding_block__mixer_token_mlp__prompt_kernel_arr3:
    s_lshl_b32 s40, s39, 2
    s_add_u32 s40, s40, s50
    s_lshl_b32 s40, s40, 16
    s_lshl_b32 s41, s56, 15
    s_add_u32 s40, s40, s41
    s_add_u32 s40, s40, 29360128
    s_add_u32 s44, s28, s40
    s_addc_u32 s45, s29, 0
    s_and_b32 s45, s45, 0xffff
    s_mov_b32 s46, 32768
    s_mov_b32 s47, 0x20000
    s_barrier
    s_and_b32 s40, s69, 7
    s_lshl_b32 s48, 1, s40
    s_xor_b32 s52, s71, s69
    s_and_b32 s52, s52, 7
    s_mov_b32 s41, 0x40000
L_parallel_sum__sliding_block__mixer_token_mlp__prompt_kernel_of1:
    s_lshr_b32 s40, s48, s52
    s_and_b32 s40, s40, 1
    s_cbranch_scc1 L_parallel_sum__sliding_block__mixer_token_mlp__prompt_kernel_of1_ok
    buffer_load_dword v9, v24, s[64:67], s49 offen sc1
    s_waitcnt vmcnt(0)
    v_cmp_ne_u32 vcc, 0, v9
    s_nop 1
    s_and_b32 s48, vcc_lo, 0xff
    s_sub_u32 s41, s41, 1
    s_cmp_lg_u32 s41, 0
    s_cbranch_scc1 L_parallel_sum__sliding_block__mixer_token_mlp__prompt_kernel_of1
L_parallel_sum__sliding_block__mixer_token_mlp__prompt_kernel_of1_ok:
    s_lshl_b32 s52, s52, 12
    s_add_u32 m0, s54, 0
    s_nop 0
    buffer_load_dwordx4 v2, s[44:47], s52 offen offset:0 sc1 lds
    buffer_load_dwordx4 v2, s[44:47], s52 offen offset:1024 sc1 lds
    buffer_load_dwordx4 v2, s[44:47], s52 offen offset:2048 sc1 lds
    buffer_load_dwordx4 v2, s[44:47], s52 offen offset:3072 sc1 lds
    s_add_u32 s71, s71, 1
    s_mov_b32 s21, 0
    s_mov_b32 s23, 4
    buffer_load_dword v9, v24, s[64:67], s49 offen sc1
    s_xor_b32 s51, s70, s69
    s_and_b32 s51, s51, 7
    s_lshl_b32 s51, s51, 17
    s_add_u32 s51, s51, s53
    s_add_u32 m0, s55, 49152
    s_nop 0
    buffer_load_dwordx4 v20, s[72:75], s51 offen offset:0 lds
    buffer_load_dwordx4 v21, s[72:75], s51 offen offset:1024 lds
    buffer_load_dwordx4 v22, s[72:75], s51 offen offset:2048 lds
    buffer_load_dwordx4 v23, s[72:75], s51 offen offset:3072 lds
    s_add_u32 m0, m0, 4096
    s_add_u32 s51, s51, 16384
    buffer_load_dwordx4 v20, s[72:75], s51 offen offset:0 lds
    buffer_load_dwordx4 v21, s[72:75], s51 offen offset:1024 lds
    buffer_load_dwordx4 v22, s[72:75], s51 offen offset:2048 lds
    buffer_load_dwordx4 v23, s[72:75], s51 offen offset:3072 lds
    s_add_u32 s70, s70, 1
    s_xor_b32 s51, s70, s69
    s_and_b32 s51, s51, 7
    s_lshl_b32 s51, s51, 17
    s_add_u32 s51, s51, s53
    s_add_u32 m0, s55, 98304
    s_nop 0
    buffer_load_dwordx4 v20, s[72:75], s51 offen offset:0 lds
    buffer_load_dwordx4 v21, s[72:75], s51 offen offset:1024 lds
    buffer_load_dwordx4 v22, s[72:75], s51 offen offset:2048 lds
    buffer_load_dwordx4 v23, s[72:75], s51 offen offset:3072 lds
    s_add_u32 m0, m0, 4096
    s_add_u32 s51, s51, 16384
    buffer_load_dwordx4 v20, s[72:75], s51 offen offset:0 lds
    buffer_load_dwordx4 v21, s[72:75], s51 offen offset:1024 lds
    buffer_load_dwordx4 v22, s[72:75], s51 offen offset:2048 lds
    buffer_load_dwordx4 v23, s[72:75], s51 offen offset:3072 lds
    s_add_u32 s70, s70, 1
    v_lshlrev_b32 v2, 4, v1
    v_lshrrev_b32 v16, 4, v1
    v_and_b32 v17, 15, v1
    s_mul_i32 s27, s50, 16
    s_mov_b32 s3, 4096
    v_add_u32 v18, 0, v16
    v_add_u32 v19, s27, v18
    v_bfe_u32 v3, v19, 2, 1
    v_and_b32 v19, 3, v19
    v_lshlrev_b32 v19, 2, v19
    v_lshl_add_u32 v19, v3, 1, v19
    v_xor_b32 v19, v19, v17
    v_lshlrev_b32 v19, 4, v19
    v_mul_lo_u32 v18, v18, s3
    v_add_u32 v3, v18, v19
    v_add_u32 v18, 4, v16
    v_add_u32 v19, s27, v18
    v_bfe_u32 v4, v19, 2, 1
    v_and_b32 v19, 3, v19
    v_lshlrev_b32 v19, 2, v19
    v_lshl_add_u32 v19, v4, 1, v19
    v_xor_b32 v19, v19, v17
    v_lshlrev_b32 v19, 4, v19
    v_mul_lo_u32 v18, v18, s3
    v_add_u32 v4, v18, v19
    v_subrev_u32 v4, 1024, v4
    v_add_u32 v18, 8, v16
    v_add_u32 v19, s27, v18
    v_bfe_u32 v5, v19, 2, 1
    v_and_b32 v19, 3, v19
    v_lshlrev_b32 v19, 2, v19
    v_lshl_add_u32 v19, v5, 1, v19
    v_xor_b32 v19, v19, v17
    v_lshlrev_b32 v19, 4, v19
    v_mul_lo_u32 v18, v18, s3
    v_add_u32 v5, v18, v19
    v_subrev_u32 v5, 2048, v5
    v_add_u32 v18, 12, v16
    v_add_u32 v19, s27, v18
    v_bfe_u32 v6, v19, 2, 1
    v_and_b32 v19, 3, v19
    v_lshlrev_b32 v19, 2, v19
    v_lshl_add_u32 v19, v6, 1, v19
    v_xor_b32 v19, v19, v17
    v_lshlrev_b32 v19, 4, v19
    v_mul_lo_u32 v18, v18, s3
    v_add_u32 v6, v18, v19
    v_subrev_u32 v6, 3072, v6
    s_mul_i32 s19, s50, 8192
    s_mul_i32 s20, s50, 4096
    s_add_u32 s20, s20, 32768
    s_mov_b32 s8, s30
    s_and_b32 s9, s31, 0xffff
    s_mov_b32 s10, 14680064
    s_mov_b32 s11, 0x20000
    s_mul_i32 s18, s50, 65536
    s_lshl_b32 s40, s39, 8
    s_add_u32 s18, s18, s40
    s_lshl_b32 s40, s57, 18
    s_add_u32 s18, s18, s40
    s_mul_i32 s40, s38, 1835008
    s_lshl_b32 s43, s57, 15
    s_add_u32 s40, s40, s43
    s_add_u32 s40, s40, 20971520
    s_add_u32 s4, s28, s40
    s_addc_u32 s5, s29, 0
    s_and_b32 s5, s5, 0xffff
    s_mov_b32 s6, 0
    s_mov_b32 s7, 0x20000
    s_lshl_b32 s6, s60, 15
    s_lshl_b32 s17, s50, 13
    s_waitcnt vmcnt(16)
    s_barrier
    v_cmp_ne_u32 vcc, 0, v9
    s_nop 1
    s_and_b32 s48, vcc_lo, 0xff
    s_xor_b32 s52, s71, s69
    s_and_b32 s52, s52, 7
    s_mov_b32 s41, 0x40000
L_parallel_sum__sliding_block__mixer_token_mlp__prompt_kernel_of2:
    s_lshr_b32 s40, s48, s52
    s_and_b32 s40, s40, 1
    s_cbranch_scc1 L_parallel_sum__sliding_block__mixer_token_mlp__prompt_kernel_of2_ok
    buffer_load_dword v9, v24, s[64:67], s49 offen sc1
    s_waitcnt vmcnt(0)
    v_cmp_ne_u32 vcc, 0, v9
    s_nop 1
    s_and_b32 s48, vcc_lo, 0xff
    s_sub_u32 s41, s41, 1
    s_cmp_lg_u32 s41, 0
    s_cbranch_scc1 L_parallel_sum__sliding_block__mixer_token_mlp__prompt_kernel_of2
L_parallel_sum__sliding_block__mixer_token_mlp__prompt_kernel_of2_ok:
    s_lshl_b32 s52, s52, 12
    s_add_u32 m0, s54, 49152
    s_nop 0
    buffer_load_dwordx4 v2, s[44:47], s52 offen offset:0 sc1 lds
    buffer_load_dwordx4 v2, s[44:47], s52 offen offset:1024 sc1 lds
    buffer_load_dwordx4 v2, s[44:47], s52 offen offset:2048 sc1 lds
    buffer_load_dwordx4 v2, s[44:47], s52 offen offset:3072 sc1 lds
    s_add_u32 s71, s71, 1
    s_xor_b32 s52, s71, s69
    s_and_b32 s52, s52, 7
    s_mov_b32 s41, 0x40000
L_parallel_sum__sliding_block__mixer_token_mlp__prompt_kernel_of3:
    s_lshr_b32 s40, s48, s52
    s_and_b32 s40, s40, 1
    s_cbranch_scc1 L_parallel_sum__sliding_block__mixer_token_mlp__prompt_kernel_of3_ok
    buffer_load_dword v9, v24, s[64:67], s49 offen sc1
    s_waitcnt vmcnt(0)
    v_cmp_ne_u32 vcc, 0, v9
    s_nop 1
    s_and_b32 s48, vcc_lo, 0xff
    s_sub_u32 s41, s41, 1
    s_cmp_lg_u32 s41, 0
    s_cbranch_scc1 L_parallel_sum__sliding_block__mixer_token_mlp__prompt_kernel_of3
L_parallel_sum__sliding_block__mixer_token_mlp__prompt_kernel_of3_ok:
    s_lshl_b32 s52, s52, 12
    s_add_u32 m0, s54, 98304
    s_nop 0
    buffer_load_dwordx4 v2, s[44:47], s52 offen offset:0 sc1 lds
    buffer_load_dwordx4 v2, s[44:47], s52 offen offset:1024 sc1 lds
    buffer_load_dwordx4 v2, s[44:47], s52 offen offset:2048 sc1 lds
    buffer_load_dwordx4 v2, s[44:47], s52 offen offset:3072 sc1 lds
    s_add_u32 s71, s71, 1
    s_waitcnt vmcnt(4)
    s_barrier
    s_xor_b32 s51, s70, s69
    s_and_b32 s51, s51, 7
    s_lshl_b32 s51, s51, 17
    s_add_u32 s51, s51, s53
    s_add_u32 m0, s55, s21
    s_nop 0
    buffer_load_dwordx4 v20, s[72:75], s51 offen offset:0 lds
    buffer_load_dwordx4 v21, s[72:75], s51 offen offset:1024 lds
    buffer_load_dwordx4 v22, s[72:75], s51 offen offset:2048 lds
    buffer_load_dwordx4 v23, s[72:75], s51 offen offset:3072 lds
    s_add_u32 m0, m0, 4096
    s_add_u32 s51, s51, 16384
    buffer_load_dwordx4 v20, s[72:75], s51 offen offset:0 lds
    buffer_load_dwordx4 v21, s[72:75], s51 offen offset:1024 lds
    buffer_load_dwordx4 v22, s[72:75], s51 offen offset:2048 lds
    buffer_load_dwordx4 v23, s[72:75], s51 offen offset:3072 lds
    s_add_u32 s70, s70, 1
    s_xor_b32 s52, s71, s69
    s_and_b32 s52, s52, 7
    s_mov_b32 s41, 0x40000
L_parallel_sum__sliding_block__mixer_token_mlp__prompt_kernel_of4:
    s_lshr_b32 s40, s48, s52
    s_and_b32 s40, s40, 1
    s_cbranch_scc1 L_parallel_sum__sliding_block__mixer_token_mlp__prompt_kernel_of4_ok
    buffer_load_dword v9, v24, s[64:67], s49 offen sc1
    s_waitcnt vmcnt(0)
    v_cmp_ne_u32 vcc, 0, v9
    s_nop 1
    s_and_b32 s48, vcc_lo, 0xff
    s_sub_u32 s41, s41, 1
    s_cmp_lg_u32 s41, 0
    s_cbranch_scc1 L_parallel_sum__sliding_block__mixer_token_mlp__prompt_kernel_of4
L_parallel_sum__sliding_block__mixer_token_mlp__prompt_kernel_of4_ok:
    s_lshl_b32 s52, s52, 12
    s_add_u32 m0, s54, s21
    s_nop 0
    buffer_load_dwordx4 v2, s[44:47], s52 offen offset:0 sc1 lds
    buffer_load_dwordx4 v2, s[44:47], s52 offen offset:1024 sc1 lds
    buffer_load_dwordx4 v2, s[44:47], s52 offen offset:2048 sc1 lds
    buffer_load_dwordx4 v2, s[44:47], s52 offen offset:3072 sc1 lds
    s_add_u32 s71, s71, 1
    s_add_u32 s21, s21, 49152
    s_cmp_eq_u32 s21, 147456
    s_cselect_b32 s21, 0, s21
L_parallel_sum__sliding_block__mixer_token_mlp__prompt_kernel_lw:
    s_waitcnt vmcnt(12)
    s_barrier
    s_xor_b32 s51, s70, s69
    s_and_b32 s51, s51, 7
    s_lshl_b32 s51, s51, 17
    s_add_u32 s51, s51, s53
    s_add_u32 m0, s55, s21
    s_nop 0
    buffer_load_dwordx4 v20, s[72:75], s51 offen offset:0 lds
    buffer_load_dwordx4 v21, s[72:75], s51 offen offset:1024 lds
    buffer_load_dwordx4 v22, s[72:75], s51 offen offset:2048 lds
    buffer_load_dwordx4 v23, s[72:75], s51 offen offset:3072 lds
    s_add_u32 m0, m0, 4096
    s_add_u32 s51, s51, 16384
    buffer_load_dwordx4 v20, s[72:75], s51 offen offset:0 lds
    buffer_load_dwordx4 v21, s[72:75], s51 offen offset:1024 lds
    buffer_load_dwordx4 v22, s[72:75], s51 offen offset:2048 lds
    buffer_load_dwordx4 v23, s[72:75], s51 offen offset:3072 lds
    s_add_u32 s70, s70, 1
    s_xor_b32 s52, s71, s69
    s_and_b32 s52, s52, 7
    s_mov_b32 s41, 0x40000
L_parallel_sum__sliding_block__mixer_token_mlp__prompt_kernel_of5:
    s_lshr_b32 s40, s48, s52
    s_and_b32 s40, s40, 1
    s_cbranch_scc1 L_parallel_sum__sliding_block__mixer_token_mlp__prompt_kernel_of5_ok
    buffer_load_dword v9, v24, s[64:67], s49 offen sc1
    s_waitcnt vmcnt(0)
    v_cmp_ne_u32 vcc, 0, v9
    s_nop 1
    s_and_b32 s48, vcc_lo, 0xff
    s_sub_u32 s41, s41, 1
    s_cmp_lg_u32 s41, 0
    s_cbranch_scc1 L_parallel_sum__sliding_block__mixer_token_mlp__prompt_kernel_of5
L_parallel_sum__sliding_block__mixer_token_mlp__prompt_kernel_of5_ok:
    s_lshl_b32 s52, s52, 12
    s_add_u32 m0, s54, s21
    s_nop 0
    buffer_load_dwordx4 v2, s[44:47], s52 offen offset:0 sc1 lds
    buffer_load_dwordx4 v2, s[44:47], s52 offen offset:1024 sc1 lds
    buffer_load_dwordx4 v2, s[44:47], s52 offen offset:2048 sc1 lds
    buffer_load_dwordx4 v2, s[44:47], s52 offen offset:3072 sc1 lds
    s_add_u32 s71, s71, 1
    s_add_u32 s21, s21, 49152
    s_cmp_eq_u32 s21, 147456
    s_cselect_b32 s21, 0, s21
    s_sub_u32 s23, s23, 1
    s_cmp_lg_u32 s23, 0
    s_cbranch_scc1 L_parallel_sum__sliding_block__mixer_token_mlp__prompt_kernel_lw
    s_lshl_b32 s43, s38, 4
    s_lshl_b32 s40, s36, 1
    s_add_u32 s43, s43, s40
    s_add_u32 s43, s43, 1
    s_lshl_b32 s43, s43, 8
    s_add_u32 s43, s43, 32768
    s_waitcnt vmcnt(12)
    s_barrier
    s_add_u32 m0, s20, s21
    s_nop 0
    buffer_load_dwordx4 v3, s[8:11], s18 offen offset:0 lds
    buffer_load_dwordx4 v4, s[8:11], s18 offen offset:1024 lds
    buffer_load_dwordx4 v5, s[8:11], s18 offen offset:2048 lds
    buffer_load_dwordx4 v6, s[8:11], s18 offen offset:3072 lds
    s_add_u32 s18, s18, 262144
    s_mov_b32 s49, s21
    s_add_u32 s21, s21, 49152
    s_cmp_eq_u32 s21, 147456
    s_cselect_b32 s21, 0, s21
    s_waitcnt vmcnt(4)
    s_barrier
    s_add_u32 m0, s20, s21
    s_nop 0
    buffer_load_dwordx4 v3, s[8:11], s18 offen offset:0 lds
    buffer_load_dwordx4 v4, s[8:11], s18 offen offset:1024 lds
    buffer_load_dwordx4 v5, s[8:11], s18 offen offset:2048 lds
    buffer_load_dwordx4 v6, s[8:11], s18 offen offset:3072 lds
    s_add_u32 s18, s18, 262144
    s_mov_b32 s41, 262144
L_parallel_sum__sliding_block__mixer_token_mlp__prompt_kernel_pu2:
    buffer_load_dword v9, v10, s[64:67], s43 offen sc1
    s_waitcnt vmcnt(0)
    v_readfirstlane_b32 s40, v9
    s_nop 0
    s_cmp_ge_u32 s40, 28
    s_cbranch_scc1 L_parallel_sum__sliding_block__mixer_token_mlp__prompt_kernel_pu2_ok
    s_sleep 4
    s_sub_u32 s41, s41, 1
    s_cmp_lg_u32 s41, 0
    s_cbranch_scc1 L_parallel_sum__sliding_block__mixer_token_mlp__prompt_kernel_pu2
L_parallel_sum__sliding_block__mixer_token_mlp__prompt_kernel_pu2_ok:
    s_add_u32 m0, s19, s49
    s_nop 0
    buffer_load_dwordx4 v2, s[4:7], s17 offen offset:0 sc1 lds
    buffer_load_dwordx4 v2, s[4:7], s17 offen offset:1024 sc1 lds
    buffer_load_dwordx4 v2, s[4:7], s17 offen offset:2048 sc1 lds
    buffer_load_dwordx4 v2, s[4:7], s17 offen offset:3072 sc1 lds
    s_add_u32 m0, m0, 4096
    s_add_u32 s51, s17, 4096
    buffer_load_dwordx4 v2, s[4:7], s51 offen offset:0 sc1 lds
    buffer_load_dwordx4 v2, s[4:7], s51 offen offset:1024 sc1 lds
    buffer_load_dwordx4 v2, s[4:7], s51 offen offset:2048 sc1 lds
    buffer_load_dwordx4 v2, s[4:7], s51 offen offset:3072 sc1 lds
    s_add_u32 s17, s17, 32768
    s_add_u32 m0, s19, s21
    s_nop 0
    buffer_load_dwordx4 v2, s[4:7], s17 offen offset:0 sc1 lds
    buffer_load_dwordx4 v2, s[4:7], s17 offen offset:1024 sc1 lds
    buffer_load_dwordx4 v2, s[4:7], s17 offen offset:2048 sc1 lds
    buffer_load_dwordx4 v2, s[4:7], s17 offen offset:3072 sc1 lds
    s_add_u32 m0, m0, 4096
    s_add_u32 s51, s17, 4096
    buffer_load_dwordx4 v2, s[4:7], s51 offen offset:0 sc1 lds
    buffer_load_dwordx4 v2, s[4:7], s51 offen offset:1024 sc1 lds
    buffer_load_dwordx4 v2, s[4:7], s51 offen offset:2048 sc1 lds
    buffer_load_dwordx4 v2, s[4:7], s51 offen offset:3072 sc1 lds
    s_add_u32 s17, s17, 32768
    s_add_u32 s21, s21, 49152
    s_cmp_eq_u32 s21, 147456
    s_cselect_b32 s21, 0, s21
    s_waitcnt vmcnt(8)
    s_barrier
    s_add_u32 m0, s20, s21
    s_nop 0
    buffer_load_dwordx4 v3, s[8:11], s18 offen offset:0 lds
    buffer_load_dwordx4 v4, s[8:11], s18 offen offset:1024 lds
    buffer_load_dwordx4 v5, s[8:11], s18 offen offset:2048 lds
    buffer_load_dwordx4 v6, s[8:11], s18 offen offset:3072 lds
    s_add_u32 s18, s18, 262144
    s_add_u32 m0, s19, s21
    s_nop 0
    buffer_load_dwordx4 v2, s[4:7], s17 offen offset:0 sc1 lds
    buffer_load_dwordx4 v2, s[4:7], s17 offen offset:1024 sc1 lds
    buffer_load_dwordx4 v2, s[4:7], s17 offen offset:2048 sc1 lds
    buffer_load_dwordx4 v2, s[4:7], s17 offen offset:3072 sc1 lds
    s_add_u32 m0, m0, 4096
    s_add_u32 s51, s17, 4096
    buffer_load_dwordx4 v2, s[4:7], s51 offen offset:0 sc1 lds
    buffer_load_dwordx4 v2, s[4:7], s51 offen offset:1024 sc1 lds
    buffer_load_dwordx4 v2, s[4:7], s51 offen offset:2048 sc1 lds
    buffer_load_dwordx4 v2, s[4:7], s51 offen offset:3072 sc1 lds
    s_add_u32 s17, s17, 32768
    s_add_u32 s21, s21, 49152
    s_cmp_eq_u32 s21, 147456
    s_cselect_b32 s21, 0, s21
    s_sub_u32 s23, s60, 3
L_parallel_sum__sliding_block__mixer_token_mlp__prompt_kernel_lm:
    s_waitcnt vmcnt(12)
    s_barrier
    s_add_u32 m0, s20, s21
    s_nop 0
    buffer_load_dwordx4 v3, s[8:11], s18 offen offset:0 lds
    buffer_load_dwordx4 v4, s[8:11], s18 offen offset:1024 lds
    buffer_load_dwordx4 v5, s[8:11], s18 offen offset:2048 lds
    buffer_load_dwordx4 v6, s[8:11], s18 offen offset:3072 lds
    s_add_u32 s18, s18, 262144
    s_add_u32 m0, s19, s21
    s_nop 0
    buffer_load_dwordx4 v2, s[4:7], s17 offen offset:0 sc1 lds
    buffer_load_dwordx4 v2, s[4:7], s17 offen offset:1024 sc1 lds
    buffer_load_dwordx4 v2, s[4:7], s17 offen offset:2048 sc1 lds
    buffer_load_dwordx4 v2, s[4:7], s17 offen offset:3072 sc1 lds
    s_add_u32 m0, m0, 4096
    s_add_u32 s51, s17, 4096
    buffer_load_dwordx4 v2, s[4:7], s51 offen offset:0 sc1 lds
    buffer_load_dwordx4 v2, s[4:7], s51 offen offset:1024 sc1 lds
    buffer_load_dwordx4 v2, s[4:7], s51 offen offset:2048 sc1 lds
    buffer_load_dwordx4 v2, s[4:7], s51 offen offset:3072 sc1 lds
    s_add_u32 s17, s17, 32768
    s_add_u32 s21, s21, 49152
    s_cmp_eq_u32 s21, 147456
    s_cselect_b32 s21, 0, s21
    s_sub_u32 s23, s23, 1
    s_cmp_lg_u32 s23, 0
    s_cbranch_scc1 L_parallel_sum__sliding_block__mixer_token_mlp__prompt_kernel_lm
    s_waitcnt vmcnt(12)
    s_barrier
    s_waitcnt vmcnt(0)
    s_barrier
    s_barrier
L_parallel_sum__sliding_block__mixer_token_mlp__prompt_kernel_done:
L_parallel_sum__sliding_block__mixer_token_mlp__prompt_kernel_end:
    s_endpgm
.section .rodata,"a"
.p2align 6
.amdhsa_kernel parallel_sum__sliding_block__mixer_token_mlp__prompt_kernel
  .amdhsa_next_free_vgpr 256
  .amdhsa_next_free_sgpr 78
  .amdhsa_accum_offset 256
  .amdhsa_group_segment_fixed_size 0
  .amdhsa_kernarg_size 88
  .amdhsa_user_sgpr_count 2
  .amdhsa_user_sgpr_kernarg_segment_ptr 1
  .amdhsa_system_sgpr_workgroup_id_x 1
.end_amdhsa_kernel
```
